```python
import torch

def _softmax(x, axis=-1):
    return torch.softmax(x, dim=axis)
def _gelu(x):
    return torch.nn.functional.gelu(x, approximate="tanh")
def _silu(x):
    return torch.nn.functional.silu(x)
def _sigmoid(x):
    return torch.sigmoid(x)
def _layernorm(x, axis=-1, eps=1e-5):
    m = x.mean(dim=axis, keepdim=True)
    v = x.var(dim=axis, keepdim=True, unbiased=False)
    return (x - m) / torch.sqrt(v + eps)
def _scatter_add(tgt, idx, src, axis=0):
    return tgt.clone().index_add_(axis, idx, src)
def _segment_sum(src, seg, n):
    out = torch.zeros((n,) + src.shape[1:], dtype=src.dtype)
    return out.index_add_(0, seg, src)
def _pad(x, pw):
    flat = tuple(v for pair in reversed(pw) for v in pair)
    return torch.nn.functional.pad(x, flat)

kernel_name = 'gated_mix__sliding_local_dilated__swiglu_ffn__prompt'

def setup_inputs():

    _w = (lambda a: (lambda t: t.to(torch.bfloat16) if t.is_floating_point() else t)(torch.as_tensor(a)))
    def _A_setup():
        B, S, D = 1, 2048, 448
        return {
            "x": _w((lambda *s: torch.randn(*s, dtype=torch.bfloat16) * 0.05)(B, S, D)),
            "wqkv": _w((lambda *s: torch.randn(*s, dtype=torch.bfloat16) * 0.8)(D, 3 * D)),
            "wo": _w((lambda *s: torch.randn(*s, dtype=torch.bfloat16) * 0.05)(D, D)),
        }
    _A_in = _A_setup()

    def _B_setup():
        B, S, D, F = 1, 2048, 448, 1792
        return {
            "x": _w((lambda *s: torch.randn(*s, dtype=torch.bfloat16) * 0.05)(B, S, D)),
            "w_gate": _w((lambda *s: torch.randn(*s, dtype=torch.bfloat16) * 0.2)(D, F)),
            "w_up": _w((lambda *s: torch.randn(*s, dtype=torch.bfloat16) * 0.2)(D, F)),
            "w_down": _w((lambda *s: torch.randn(*s, dtype=torch.bfloat16) * 0.2)(F, D)),
        }
    _B_in = _B_setup()

    return {
        "A_x": _A_in["x"],
        "A_wqkv": _A_in["wqkv"],
        "A_wo": _A_in["wo"],
        "B_x": _B_in["x"],
        "B_w_gate": _B_in["w_gate"],
        "B_w_up": _B_in["w_up"],
        "B_w_down": _B_in["w_down"],
        "gate_w": _w((lambda *s: torch.randn(*s, dtype=torch.bfloat16) * 0.05)(448) * 16.0),
    }

def reference(A_x, A_wqkv, A_wo, B_x, B_w_gate, B_w_up, B_w_down, gate_w):
    def _A_ref(x, wqkv, wo):
        B, S, D = x.shape
        H = 16; Dh = D // H
        W, dil = 8, 2
        qkv = (lambda x, *d: x.permute(*d))((x @ wqkv).reshape(B, S, 3, H, Dh), 2, 0, 3, 1, 4)
        q, k, v = qkv[0], qkv[1], qkv[2]
        scale = Dh ** -0.5
        pos = torch.arange(S)
        off = torch.arange(W) * dil
        idx = pos[:, None] - off[None, :]
        mask = idx >= 0
        idx_c = torch.where(mask, idx, 0).reshape(-1)
        kg = k[:, :, idx_c, :].reshape(B, H, S, W, Dh)
        vg = v[:, :, idx_c, :].reshape(B, H, S, W, Dh)
        logits = torch.einsum("bhsd,bhswd->bhsw", q, kg) * scale
        logits = torch.where(mask[None, None, :, :], logits, -1e9)
        attn = _softmax(logits, axis=-1)
        o = torch.einsum("bhsw,bhswd->bhsd", attn, vg)
        return (lambda x, *d: x.permute(*d))(o, 0, 2, 1, 3).reshape(B, S, D) @ wo

    def _B_ref(x, w_gate, w_up, w_down):
        g = _silu(x @ w_gate)
        u = x @ w_up
        return (g * u) @ w_down

    x = A_x
    g = _sigmoid((x * gate_w).sum(-1, keepdims=True))
    a = _A_ref(x, A_wqkv, A_wo)
    b = _B_ref(x, B_w_gate, B_w_up, B_w_down)
    return g * a + (1 - g) * b
```

```asm
; @launch grid=(256,1,1) block=(256,1,1) lds=163840
.amdgcn_target "amdgcn-amd-amdhsa--gfx950"
.text
.globl gated_mix__sliding_local_dilated__swiglu_ffn__prompt_kernel
.p2align 8
.type gated_mix__sliding_local_dilated__swiglu_ffn__prompt_kernel,@function
gated_mix__sliding_local_dilated__swiglu_ffn__prompt_kernel:
    s_cmp_ge_u32 s2, 256
    s_cbranch_scc1 L_end
    s_load_dwordx4 s[4:7], s[0:1], 0
    s_load_dwordx8 s[12:19], s[0:1], 32
    s_load_dwordx2 s[8:9], s[0:1], 16
    s_load_dwordx4 s[20:23], s[0:1], 64
    s_load_dwordx2 s[24:25], s[0:1], 80
    v_lshrrev_b32 v1, 6, v0
    v_and_b32 v0, 63, v0
    s_bfe_u32 s10, s2, 0x20001
    v_readfirstlane_b32 s3, v1
    s_lshr_b32 s11, s2, 3
    s_and_b32 s27, s2, 1
    s_cmp_lt_u32 s11, 8
    s_cbranch_scc1 L_qkv
    s_lshl_b32 s64, s10, 3
    s_lshr_b32 s26, 0x1d1e2020, s64
    s_and_b32 s26, s26, 0xff
    s_cmp_ge_u32 s11, s26
    s_cbranch_scc1 L_idle
    s_lshr_b32 s26, 0x46301800, s64
    s_and_b32 s26, s26, 0xff
    s_add_u32 s26, s26, s11
    s_sub_u32 s26, s26, 8
    s_mul_i32 s94, s27, 91
    s_add_u32 s94, s94, s26
    s_mul_i32 s11, s27, 7
    s_sub_u32 s10, 49, s11
    s_cmp_ge_u32 s26, s10
    s_cselect_b32 s10, s10, 0
    s_cselect_b32 s64, 7, 0
    s_cselect_b32 s95, s27, 0
    s_cselect_b32 s93, 1, 0
    s_sub_u32 s26, s26, s10
    s_sub_u32 s95, s11, s95
    s_cmp_eq_u32 s93, s27
    s_cselect_b32 s10, 37, 43
    s_cselect_b32 s11, 7, 6
    s_mul_i32 s10, s10, s26
    s_lshr_b32 s10, s10, 8
    s_add_u32 s64, s64, s10
    s_mul_i32 s10, s10, s11
    s_sub_u32 s26, s26, s10
    s_add_u32 s95, s95, s26
L_ffn:
    s_mul_i32 s63, s95, 160
    s_and_b32 s93, s64, 1
    s_add_u32 s27, s95, s64
    s_and_b32 s27, s27, 1
    s_mul_i32 s27, s27, 4
    s_and_b32 s11, s2, 1
    s_mul_i32 s11, s11, 2
    s_add_u32 s27, s27, s11
    s_mul_i32 s11, s27, 147
    s_lshr_b32 s11, s11, 10
    s_mul_i32 s11, s11, 7
    s_sub_u32 s27, s27, s11
    s_lshl_b32 s56, s27, 7
    v_lshrrev_b32 v16, 4, v0
    v_and_b32 v17, 15, v0
    v_lshrrev_b32 v18, 3, v0
    v_and_b32 v19, 7, v0
    s_and_b32 s10, s3, 1
    s_mul_i32 s11, s10, 57344
    s_lshl_b32 s27, s64, 8
    s_add_u32 s11, s11, s27
    s_movk_i32 s27, 3584
    v_mul_u32_u24 v20, s27, v16
    v_add_u32 v20, s11, v20
    v_lshlrev_b32 v21, 2, v16
    v_xor_b32 v21, v21, v17
    s_and_b32 s11, s3, 2
    v_xor_b32 v21, s11, v21
    v_lshl_add_u32 v1, v21, 4, v20
    v_add_u32 v2, 13312, v1
    v_add_u32 v3, 13312, v2
    v_add_u32 v4, 13312, v3
    s_lshl_b32 s69, s3, 12
    s_lshr_b32 s11, s3, 1
    s_sub_u32 s27, 4, s11
    s_cmp_eq_u32 s93, 0
    s_cselect_b32 s11, s11, s27
    s_lshl_b32 s11, s11, 1
    s_add_u32 s11, s11, s10
    s_lshl_b32 s11, s11, 4
    s_add_u32 s11, s11, s63
    s_mul_i32 s11, s11, 896
    s_lshl_b32 s70, s3, 11
    s_add_u32 s70, s70, 65536
    s_movk_i32 s27, 896
    v_mul_u32_u24 v20, s27, v18
    v_xor_b32 v21, v16, v19
    v_lshl_add_u32 v22, v21, 4, v20
    v_add_u32 v5, s11, v22
    v_xor_b32 v23, 64, v22
    s_add_u32 s11, s11, 6144
    v_add_u32 v6, s11, v23
    s_waitcnt lgkmcnt(0)
    s_cmp_lt_u32 s3, 2
    s_cselect_b32 s32, s12, s14
    s_cselect_b32 s33, s13, s15
    s_mov_b32 s34, 1605632
    s_mov_b32 s35, 0x20000
    s_add_u32 m0, s69, 0
    s_mul_i32 s71, s56, 1792
    buffer_load_dwordx4 v1, s[32:35], s71 offen offset:0 lds
    buffer_load_dwordx4 v2, s[32:35], s71 offen offset:1024 lds
    buffer_load_dwordx4 v3, s[32:35], s71 offen offset:2048 lds
    buffer_load_dwordx4 v4, s[32:35], s71 offen offset:3072 lds
    s_mov_b32 s28, s4
    s_mov_b32 s29, s5
    s_mov_b32 s30, 1835008
    s_mov_b32 s31, 0x20000
    s_add_u32 m0, s70, 0
    s_nop 0
    buffer_load_dwordx4 v5, s[28:31], s56 offen offset:0 lds
    buffer_load_dwordx4 v6, s[28:31], s56 offen offset:1024 lds
    v_and_b32 v24, 1, v16
    v_lshrrev_b32 v25, 5, v0
    v_bfe_u32 v20, v0, 2, 2
    v_lshl_add_u32 v27, v25, 3, v20
    v_lshl_add_u32 v20, v20, 1, v24
    s_lshl_b32 s11, s3, 1
    v_xor_b32 v20, s11, v20
    v_lshlrev_b32 v20, 5, v20
    v_lshl_add_u32 v20, v27, 8, v20
    v_lshl_add_u32 v20, v24, 13, v20
    v_and_b32 v27, 3, v0
    v_lshl_add_u32 v9, v27, 3, v20
    v_xor_b32 v10, 32, v9
    v_bfe_u32 v20, v0, 1, 3
    v_xor_b32 v20, v20, v25
    v_lshlrev_b32 v20, 4, v20
    v_and_b32 v27, 31, v0
    v_lshl_add_u32 v20, v27, 7, v20
    v_add_u32 v11, 65536, v20
    v_xor_b32 v12, 32, v11
    v_xor_b32 v13, 64, v11
    v_xor_b32 v14, 96, v11
    s_add_u32 s57, s56, 128
    s_cmp_eq_u32 s57, 896
    s_cselect_b32 s57, 0, s57
    s_add_u32 s58, s57, 128
    s_cmp_eq_u32 s58, 896
    s_cselect_b32 s58, 0, s58
    s_add_u32 s59, s58, 128
    s_cmp_eq_u32 s59, 896
    s_cselect_b32 s59, 0, s59
    s_add_u32 s60, s59, 128
    s_cmp_eq_u32 s60, 896
    s_cselect_b32 s60, 0, s60
    s_add_u32 s61, s60, 128
    s_cmp_eq_u32 s61, 896
    s_cselect_b32 s61, 0, s61
    s_add_u32 s62, s61, 128
    s_cmp_eq_u32 s62, 896
    s_cselect_b32 s62, 0, s62
    s_add_u32 m0, s69, 16384
    s_mul_i32 s71, s56, 1792
    s_add_u32 s71, s71, 114688
    buffer_load_dwordx4 v1, s[32:35], s71 offen offset:0 lds
    buffer_load_dwordx4 v2, s[32:35], s71 offen offset:1024 lds
    buffer_load_dwordx4 v3, s[32:35], s71 offen offset:2048 lds
    buffer_load_dwordx4 v4, s[32:35], s71 offen offset:3072 lds
    s_add_u32 m0, s69, 32768
    s_mul_i32 s71, s57, 1792
    buffer_load_dwordx4 v1, s[32:35], s71 offen offset:0 lds
    buffer_load_dwordx4 v2, s[32:35], s71 offen offset:1024 lds
    buffer_load_dwordx4 v3, s[32:35], s71 offen offset:2048 lds
    buffer_load_dwordx4 v4, s[32:35], s71 offen offset:3072 lds
    s_add_u32 m0, s70, 8192
    s_nop 0
    buffer_load_dwordx4 v5, s[28:31], s57 offen offset:0 lds
    buffer_load_dwordx4 v6, s[28:31], s57 offen offset:1024 lds
    s_waitcnt vmcnt(10) lgkmcnt(0)
    s_barrier
    ds_read_b128 v[40:43], v11 offset:0
    ds_read_b128 v[44:47], v11 offset:4096
    ds_read_b128 v[48:51], v12 offset:0
    ds_read_b128 v[52:55], v12 offset:4096
    ds_read_b64_tr_b16 a[0:1], v9 offset:0
    ds_read_b64_tr_b16 a[2:3], v9 offset:1024
    ds_read_b64_tr_b16 a[4:5], v10 offset:0
    ds_read_b64_tr_b16 a[6:7], v10 offset:1024
    ds_read_b64_tr_b16 a[8:9], v9 offset:4096
    ds_read_b64_tr_b16 a[10:11], v9 offset:5120
    ds_read_b64_tr_b16 a[12:13], v10 offset:4096
    ds_read_b64_tr_b16 a[14:15], v10 offset:5120
    s_add_u32 m0, s69, 49152
    s_mul_i32 s71, s57, 1792
    s_add_u32 s71, s71, 114688
    buffer_load_dwordx4 v1, s[32:35], s71 offen offset:0 lds
    buffer_load_dwordx4 v2, s[32:35], s71 offen offset:1024 lds
    buffer_load_dwordx4 v3, s[32:35], s71 offen offset:2048 lds
    buffer_load_dwordx4 v4, s[32:35], s71 offen offset:3072 lds
    s_add_u32 m0, s70, 16384
    s_nop 0
    buffer_load_dwordx4 v5, s[28:31], s58 offen offset:0 lds
    buffer_load_dwordx4 v6, s[28:31], s58 offen offset:1024 lds
    s_waitcnt vmcnt(12) lgkmcnt(0)
    s_barrier
    v_mfma_f32_32x32x16_bf16 v[72:87], a[0:3], v[40:43], 0
    s_add_u32 m0, s69, 0
    s_mul_i32 s71, s58, 1792
    s_add_u32 s36, s24, 131072
    s_addc_u32 s37, s25, 0
    buffer_load_dwordx4 v1, s[32:35], s71 offen offset:0 lds
    ds_read_b128 v[56:59], v13 offset:0
    ds_read_b128 v[60:63], v13 offset:4096
    v_mfma_f32_32x32x16_bf16 v[88:103], a[4:7], v[40:43], 0
    s_mov_b32 s38, 9568256
    s_mov_b32 s39, 0x20000
    s_mov_b32 s52, s24
    buffer_load_dwordx4 v2, s[32:35], s71 offen offset:1024 lds
    ds_read_b128 v[64:67], v14 offset:0
    ds_read_b128 v[68:71], v14 offset:4096
    v_mfma_f32_32x32x16_bf16 v[120:135], a[4:7], v[44:47], 0
    s_mov_b32 s53, s25
    s_mov_b32 s54, 131072
    s_mov_b32 s55, 0x20000
    buffer_load_dwordx4 v3, s[32:35], s71 offen offset:2048 lds
    ds_read_b64_tr_b16 a[16:17], v9 offset:16384
    ds_read_b64_tr_b16 a[18:19], v9 offset:17408
    v_mfma_f32_32x32x16_bf16 v[104:119], a[0:3], v[44:47], 0
    s_mov_b32 s96, s22
    s_mov_b32 s97, s23
    s_mov_b32 s98, 256
    buffer_load_dwordx4 v4, s[32:35], s71 offen offset:3072 lds
    ds_read_b64_tr_b16 a[20:21], v10 offset:16384
    ds_read_b64_tr_b16 a[22:23], v10 offset:17408
    v_mfma_f32_32x32x16_bf16 v[72:87], a[8:11], v[48:51], v[72:87]
    s_mov_b32 s99, 0x20000
    s_mov_b32 s72, 0xbfb8aa3b
    s_and_b32 s11, s3, 1
    ds_read_b64_tr_b16 a[24:25], v9 offset:20480
    ds_read_b64_tr_b16 a[26:27], v9 offset:21504
    v_mfma_f32_32x32x16_bf16 v[88:103], a[12:15], v[48:51], v[88:103]
    s_lshl_b32 s27, s11, 6
    ds_read_b64_tr_b16 a[28:29], v10 offset:20480
    ds_read_b64_tr_b16 a[30:31], v10 offset:21504
    v_xor_b32 v23, s27, v22
    v_mfma_f32_32x32x16_bf16 v[120:135], a[12:15], v[52:55], v[120:135]
    s_lshl_b32 s10, s3, 3
    s_add_u32 s10, s10, s63
    s_add_u32 s10, s10, 64
    v_mfma_f32_32x32x16_bf16 v[104:119], a[8:11], v[52:55], v[104:119]
    s_mul_i32 s10, s10, 896
    v_add_u32 v8, s10, v23
    s_waitcnt vmcnt(10) lgkmcnt(0)
    s_barrier
    v_mfma_f32_32x32x16_bf16 v[72:87], a[16:19], v[56:59], v[72:87]
    s_add_u32 m0, s69, 16384
    s_mul_i32 s71, s58, 1792
    s_add_u32 s71, s71, 114688
    buffer_load_dwordx4 v1, s[32:35], s71 offen offset:0 lds
    ds_read_b128 v[40:43], v11 offset:8192
    ds_read_b128 v[44:47], v11 offset:12288
    v_mfma_f32_32x32x16_bf16 v[88:103], a[20:23], v[56:59], v[88:103]
    s_lshl_b32 s66, s3, 10
    s_mul_i32 s10, s93, 57344
    s_sub_u32 s68, 28672, s10
    buffer_load_dwordx4 v2, s[32:35], s71 offen offset:1024 lds
    ds_read_b128 v[48:51], v12 offset:8192
    ds_read_b128 v[52:55], v12 offset:12288
    v_mfma_f32_32x32x16_bf16 v[120:135], a[20:23], v[60:63], v[120:135]
    s_lshl_b32 s10, s93, 7
    s_add_u32 s10, s10, s63
    s_lshr_b32 s10, s10, 4
    buffer_load_dwordx4 v3, s[32:35], s71 offen offset:2048 lds
    ds_read_b64_tr_b16 a[32:33], v9 offset:32768
    ds_read_b64_tr_b16 a[34:35], v9 offset:33792
    v_mfma_f32_32x32x16_bf16 v[104:119], a[16:19], v[60:63], v[104:119]
    s_mul_i32 s10, s10, 73
    s_lshl_b32 s11, s64, 2
    s_add_u32 s10, s10, s11
    buffer_load_dwordx4 v4, s[32:35], s71 offen offset:3072 lds
    ds_read_b64_tr_b16 a[36:37], v10 offset:32768
    ds_read_b64_tr_b16 a[38:39], v10 offset:33792
    v_mfma_f32_32x32x16_bf16 v[72:87], a[24:27], v[64:67], v[72:87]
    s_add_u32 m0, s70, 0
    s_add_u32 s10, s10, s3
    s_lshl_b32 s73, s10, 10
    buffer_load_dwordx4 v5, s[28:31], s59 offen offset:0 lds
    ds_read_b64_tr_b16 a[40:41], v9 offset:36864
    ds_read_b64_tr_b16 a[42:43], v9 offset:37888
    v_mfma_f32_32x32x16_bf16 v[88:103], a[28:31], v[64:67], v[88:103]
    s_mul_i32 s10, s93, 299008
    s_sub_u32 s67, 149504, s10
    buffer_load_dwordx4 v6, s[28:31], s59 offen offset:1024 lds
    ds_read_b64_tr_b16 a[44:45], v10 offset:36864
    ds_read_b64_tr_b16 a[46:47], v10 offset:37888
    v_lshlrev_b32 v15, 4, v0
    v_mfma_f32_32x32x16_bf16 v[120:135], a[28:31], v[68:71], v[120:135]
    s_mov_b32 s10, 74752
    v_mul_u32_u24 v20, s10, v24
    v_lshl_add_u32 v20, v25, 8, v20
    v_lshl_add_u32 v26, v17, 4, v20
    v_mfma_f32_32x32x16_bf16 v[104:119], a[24:27], v[68:71], v[104:119]
    s_mul_i32 s74, s94, 147
    s_lshr_b32 s74, s74, 10
    s_mul_i32 s10, s74, 7
    s_waitcnt vmcnt(12) lgkmcnt(0)
    s_barrier
    v_mfma_f32_32x32x16_bf16 v[72:87], a[32:35], v[40:43], v[72:87]
    s_add_u32 m0, s69, 32768
    s_mul_i32 s71, s59, 1792
    s_sub_u32 s75, s94, s10
    buffer_load_dwordx4 v1, s[32:35], s71 offen offset:0 lds
    ds_read_b128 v[56:59], v13 offset:8192
    ds_read_b128 v[60:63], v13 offset:12288
    v_mfma_f32_32x32x16_bf16 v[88:103], a[36:39], v[40:43], v[88:103]
    s_movk_i32 s27, 896
    buffer_load_dwordx4 v2, s[32:35], s71 offen offset:1024 lds
    ds_read_b128 v[64:67], v14 offset:8192
    ds_read_b128 v[68:71], v14 offset:12288
    v_mul_u32_u24 v20, s27, v18
    v_and_b32 v21, 6, v18
    v_xor_b32 v21, v21, v19
    v_mfma_f32_32x32x16_bf16 v[120:135], a[36:39], v[44:47], v[120:135]
    buffer_load_dwordx4 v3, s[32:35], s71 offen offset:2048 lds
    ds_read_b64_tr_b16 a[48:49], v9 offset:49152
    ds_read_b64_tr_b16 a[50:51], v9 offset:50176
    v_lshl_add_u32 v20, v21, 4, v20
    v_mfma_f32_32x32x16_bf16 v[104:119], a[32:35], v[44:47], v[104:119]
    s_lshl_b32 s10, s75, 7
    buffer_load_dwordx4 v4, s[32:35], s71 offen offset:3072 lds
    ds_read_b64_tr_b16 a[52:53], v10 offset:49152
    ds_read_b64_tr_b16 a[54:55], v10 offset:50176
    v_add_u32 v176, s10, v20
    v_add_u32 v177, 6144, v176
    v_add_u32 v178, 6144, v177
    v_mfma_f32_32x32x16_bf16 v[72:87], a[40:43], v[48:51], v[72:87]
    ds_read_b64_tr_b16 a[56:57], v9 offset:53248
    ds_read_b64_tr_b16 a[58:59], v9 offset:54272
    v_add_u32 v179, 6144, v178
    v_mfma_f32_32x32x16_bf16 v[88:103], a[44:47], v[48:51], v[88:103]
    s_mul_i32 s79, s3, 24576
    ds_read_b64_tr_b16 a[60:61], v10 offset:53248
    ds_read_b64_tr_b16 a[62:63], v10 offset:54272
    v_lshrrev_b32 v20, 2, v0
    v_bfe_u32 v21, v0, 3, 2
    v_xor_b32 v21, s3, v21
    v_lshlrev_b32 v21, 5, v21
    v_mfma_f32_32x32x16_bf16 v[120:135], a[44:47], v[52:55], v[120:135]
    v_lshl_add_u32 v21, v20, 7, v21
    v_and_b32 v20, 3, v0
    v_lshl_add_u32 v21, v20, 3, v21
    v_add_u32 v180, s79, v21
    v_xor_b32 v181, 32, v180
    v_xor_b32 v182, 64, v180
    v_mfma_f32_32x32x16_bf16 v[104:119], a[40:43], v[52:55], v[104:119]
    v_xor_b32 v183, 96, v180
    v_mov_b32 v21, v26
    v_lshlrev_b32 v22, 10, v25
    v_lshl_add_u32 v175, v25, 30, v179
    s_waitcnt vmcnt(10) lgkmcnt(0)
    s_barrier
    v_mfma_f32_32x32x16_bf16 v[72:87], a[48:51], v[56:59], v[72:87]
    s_add_u32 m0, s69, 49152
    s_mul_i32 s71, s59, 1792
    s_add_u32 s71, s71, 114688
    buffer_load_dwordx4 v1, s[32:35], s71 offen offset:0 lds
    ds_read_b128 v[40:43], v11 offset:16384
    ds_read_b128 v[44:47], v11 offset:20480
    v_mfma_f32_32x32x16_bf16 v[88:103], a[52:55], v[56:59], v[88:103]
    s_mov_b32 s44, s16
    s_mov_b32 s45, s17
    s_mov_b32 s46, 1605632
    buffer_load_dwordx4 v2, s[32:35], s71 offen offset:1024 lds
    ds_read_b128 v[48:51], v12 offset:16384
    ds_read_b128 v[52:55], v12 offset:20480
    v_mfma_f32_32x32x16_bf16 v[120:135], a[52:55], v[60:63], v[120:135]
    s_mov_b32 s47, 0x20000
    s_mov_b32 s48, s8
    s_mov_b32 s49, s9
    buffer_load_dwordx4 v3, s[32:35], s71 offen offset:2048 lds
    ds_read_b64_tr_b16 a[64:65], v9 offset:0
    ds_read_b64_tr_b16 a[66:67], v9 offset:1024
    v_mfma_f32_32x32x16_bf16 v[104:119], a[48:51], v[60:63], v[104:119]
    s_mov_b32 s50, 401408
    s_mov_b32 s51, 0x20000
    s_mov_b32 s40, s20
    buffer_load_dwordx4 v4, s[32:35], s71 offen offset:3072 lds
    ds_read_b64_tr_b16 a[68:69], v10 offset:0
    ds_read_b64_tr_b16 a[70:71], v10 offset:1024
    v_mfma_f32_32x32x16_bf16 v[72:87], a[56:59], v[64:67], v[72:87]
    s_add_u32 m0, s70, 8192
    s_mov_b32 s41, s21
    s_mov_b32 s42, 1835008
    buffer_load_dwordx4 v5, s[28:31], s60 offen offset:0 lds
    ds_read_b64_tr_b16 a[72:73], v9 offset:4096
    ds_read_b64_tr_b16 a[74:75], v9 offset:5120
    v_mfma_f32_32x32x16_bf16 v[88:103], a[60:63], v[64:67], v[88:103]
    s_mov_b32 s43, 0x20000
    s_and_b32 s12, s74, 1
    s_bfe_u32 s10, s74, 0x10001
    buffer_load_dwordx4 v6, s[28:31], s60 offen offset:1024 lds
    ds_read_b64_tr_b16 a[76:77], v10 offset:4096
    ds_read_b64_tr_b16 a[78:79], v10 offset:5120
    v_mfma_f32_32x32x16_bf16 v[120:135], a[60:63], v[68:71], v[120:135]
    s_mul_i32 s10, s10, 3
    s_add_u32 s13, s75, s10
    s_sub_u32 s10, s13, 7
    v_mfma_f32_32x32x16_bf16 v[104:119], a[56:59], v[68:71], v[104:119]
    s_cmp_ge_u32 s13, 7
    s_cselect_b32 s13, s10, s13
    s_mul_i32 s10, s3, 28672
    s_waitcnt vmcnt(12) lgkmcnt(0)
    s_barrier
    v_mfma_f32_32x32x16_bf16 v[72:87], a[64:67], v[40:43], v[72:87]
    s_add_u32 m0, s69, 0
    s_mul_i32 s71, s60, 1792
    s_mul_i32 s11, s12, 114688
    buffer_load_dwordx4 v1, s[32:35], s71 offen offset:0 lds
    ds_read_b128 v[56:59], v13 offset:16384
    ds_read_b128 v[60:63], v13 offset:20480
    v_mfma_f32_32x32x16_bf16 v[88:103], a[68:71], v[40:43], v[88:103]
    s_add_u32 s14, s10, s11
    s_sub_u32 s10, s10, s11
    s_add_u32 s15, s10, 114688
    buffer_load_dwordx4 v2, s[32:35], s71 offen offset:1024 lds
    ds_read_b128 v[64:67], v14 offset:16384
    ds_read_b128 v[68:71], v14 offset:20480
    v_mfma_f32_32x32x16_bf16 v[120:135], a[68:71], v[44:47], v[120:135]
    s_mul_i32 s76, s74, 373760
    s_lshl_b32 s10, s3, 10
    s_add_u32 s76, s76, s10
    buffer_load_dwordx4 v3, s[32:35], s71 offen offset:2048 lds
    ds_read_b64_tr_b16 a[80:81], v9 offset:16384
    ds_read_b64_tr_b16 a[82:83], v9 offset:17408
    v_mfma_f32_32x32x16_bf16 v[104:119], a[64:67], v[44:47], v[104:119]
    s_lshl_b32 s11, s12, 12
    s_add_u32 s18, s76, s11
    s_sub_u32 s10, s76, s11
    buffer_load_dwordx4 v4, s[32:35], s71 offen offset:3072 lds
    ds_read_b64_tr_b16 a[84:85], v10 offset:16384
    ds_read_b64_tr_b16 a[86:87], v10 offset:17408
    v_mfma_f32_32x32x16_bf16 v[72:87], a[72:75], v[48:51], v[72:87]
    s_add_u32 s19, s10, 4096
    s_mul_i32 s77, s13, 229376
    s_lshl_b32 s78, s13, 13
    ds_read_b64_tr_b16 a[88:89], v9 offset:20480
    ds_read_b64_tr_b16 a[90:91], v9 offset:21504
    v_mfma_f32_32x32x16_bf16 v[88:103], a[76:79], v[48:51], v[88:103]
    s_lshl_b32 s10, s95, 3
    s_add_u32 s10, s10, s3
    s_lshl_b32 s11, s93, 2
    ds_read_b64_tr_b16 a[92:93], v10 offset:20480
    ds_read_b64_tr_b16 a[94:95], v10 offset:21504
    v_mfma_f32_32x32x16_bf16 v[120:135], a[76:79], v[52:55], v[120:135]
    s_add_u32 s26, s10, s11
    s_lshl_b32 s26, s26, 7
    s_add_u32 s26, s26, 81920
    v_mfma_f32_32x32x16_bf16 v[104:119], a[72:75], v[52:55], v[104:119]
    s_xor_b32 s27, s26, 512
    s_add_u32 s27, s27, 13312
    s_lshl_b32 s10, s74, 2
    s_waitcnt vmcnt(10) lgkmcnt(0)
    s_barrier
    v_mfma_f32_32x32x16_bf16 v[72:87], a[80:83], v[56:59], v[72:87]
    s_add_u32 m0, s69, 16384
    s_mul_i32 s71, s60, 1792
    s_add_u32 s71, s71, 114688
    buffer_load_dwordx4 v1, s[32:35], s71 offen offset:0 lds
    ds_read_b128 v[40:43], v11 offset:0
    ds_read_b128 v[44:47], v11 offset:4096
    v_mfma_f32_32x32x16_bf16 v[88:103], a[84:87], v[56:59], v[88:103]
    s_add_u32 s10, s10, s3
    s_lshl_b32 s10, s10, 7
    s_add_u32 s94, s10, 81920
    buffer_load_dwordx4 v2, s[32:35], s71 offen offset:1024 lds
    ds_read_b128 v[48:51], v12 offset:0
    ds_read_b128 v[52:55], v12 offset:4096
    v_mfma_f32_32x32x16_bf16 v[120:135], a[84:87], v[60:63], v[120:135]
    buffer_load_dwordx4 v3, s[32:35], s71 offen offset:2048 lds
    ds_read_b64_tr_b16 a[96:97], v9 offset:32768
    ds_read_b64_tr_b16 a[98:99], v9 offset:33792
    v_mfma_f32_32x32x16_bf16 v[104:119], a[80:83], v[60:63], v[104:119]
    buffer_load_dwordx4 v4, s[32:35], s71 offen offset:3072 lds
    ds_read_b64_tr_b16 a[100:101], v10 offset:32768
    ds_read_b64_tr_b16 a[102:103], v10 offset:33792
    v_mfma_f32_32x32x16_bf16 v[72:87], a[88:91], v[64:67], v[72:87]
    s_add_u32 m0, s70, 16384
    ds_read_b64_tr_b16 a[104:105], v9 offset:36864
    ds_read_b64_tr_b16 a[106:107], v9 offset:37888
    v_mfma_f32_32x32x16_bf16 v[88:103], a[92:95], v[64:67], v[88:103]
    buffer_load_dwordx4 v5, s[28:31], s61 offen offset:0 lds
    ds_read_b64_tr_b16 a[108:109], v10 offset:36864
    ds_read_b64_tr_b16 a[110:111], v10 offset:37888
    v_mfma_f32_32x32x16_bf16 v[120:135], a[92:95], v[68:71], v[120:135]
    buffer_load_dwordx4 v6, s[28:31], s61 offen offset:1024 lds
    v_mfma_f32_32x32x16_bf16 v[104:119], a[88:91], v[68:71], v[104:119]
    s_waitcnt vmcnt(12) lgkmcnt(0)
    s_barrier
    v_mfma_f32_32x32x16_bf16 v[72:87], a[96:99], v[40:43], v[72:87]
    s_add_u32 m0, s69, 32768
    s_mul_i32 s71, s61, 1792
    buffer_load_dwordx4 v1, s[32:35], s71 offen offset:0 lds
    ds_read_b128 v[56:59], v13 offset:0
    ds_read_b128 v[60:63], v13 offset:4096
    v_mfma_f32_32x32x16_bf16 v[88:103], a[100:103], v[40:43], v[88:103]
    buffer_load_dwordx4 v2, s[32:35], s71 offen offset:1024 lds
    ds_read_b128 v[64:67], v14 offset:0
    ds_read_b128 v[68:71], v14 offset:4096
    v_mfma_f32_32x32x16_bf16 v[120:135], a[100:103], v[44:47], v[120:135]
    buffer_load_dwordx4 v3, s[32:35], s71 offen offset:2048 lds
    ds_read_b64_tr_b16 a[112:113], v9 offset:49152
    ds_read_b64_tr_b16 a[114:115], v9 offset:50176
    v_mfma_f32_32x32x16_bf16 v[104:119], a[96:99], v[44:47], v[104:119]
    buffer_load_dwordx4 v4, s[32:35], s71 offen offset:3072 lds
    ds_read_b64_tr_b16 a[116:117], v10 offset:49152
    ds_read_b64_tr_b16 a[118:119], v10 offset:50176
    v_mfma_f32_32x32x16_bf16 v[72:87], a[104:107], v[48:51], v[72:87]
    s_mul_i32 s10, s74, 7
    s_add_u32 s10, s10, s75
    s_lshl_b32 s10, s10, 2
    ds_read_b64_tr_b16 a[120:121], v9 offset:53248
    ds_read_b64_tr_b16 a[122:123], v9 offset:54272
    v_mfma_f32_32x32x16_bf16 v[88:103], a[108:111], v[48:51], v[88:103]
    s_add_u32 s10, s10, s3
    v_lshlrev_b32 v23, 7, v0
    v_mfma_f32_32x32x16_bf16 v[120:135], a[108:111], v[52:55], v[120:135]
    s_mul_i32 s11, s10, 2304
    s_mul_i32 s10, s10, 640
    s_mov_b64 exec, 0x3ffff
    buffer_load_dword a255, v23, s[44:47], s11 offen
    s_mov_b64 exec, 31
    buffer_load_dword a254, v23, s[48:51], s10 offen
    s_mov_b64 exec, -1
    v_mfma_f32_32x32x16_bf16 v[104:119], a[104:107], v[52:55], v[104:119]
    ds_read_b64_tr_b16 a[124:125], v10 offset:53248
    ds_read_b64_tr_b16 a[126:127], v10 offset:54272
    s_waitcnt vmcnt(12) lgkmcnt(0)
    s_barrier
    v_mfma_f32_32x32x16_bf16 v[72:87], a[112:115], v[56:59], v[72:87]
    s_add_u32 m0, s69, 49152
    s_mul_i32 s71, s61, 1792
    s_add_u32 s71, s71, 114688
    buffer_load_dwordx4 v1, s[32:35], s71 offen offset:0 lds
    ds_read_b128 v[40:43], v11 offset:8192
    ds_read_b128 v[44:47], v11 offset:12288
    v_mfma_f32_32x32x16_bf16 v[88:103], a[116:119], v[56:59], v[88:103]
    buffer_load_dwordx4 v2, s[32:35], s71 offen offset:1024 lds
    ds_read_b128 v[48:51], v12 offset:8192
    ds_read_b128 v[52:55], v12 offset:12288
    v_mfma_f32_32x32x16_bf16 v[120:135], a[116:119], v[60:63], v[120:135]
    buffer_load_dwordx4 v3, s[32:35], s71 offen offset:2048 lds
    ds_read_b64_tr_b16 a[128:129], v9 offset:0
    ds_read_b64_tr_b16 a[130:131], v9 offset:1024
    v_mfma_f32_32x32x16_bf16 v[104:119], a[112:115], v[60:63], v[104:119]
    buffer_load_dwordx4 v4, s[32:35], s71 offen offset:3072 lds
    ds_read_b64_tr_b16 a[132:133], v10 offset:0
    ds_read_b64_tr_b16 a[134:135], v10 offset:1024
    v_mfma_f32_32x32x16_bf16 v[72:87], a[120:123], v[64:67], v[72:87]
    s_add_u32 m0, s70, 0
    ds_read_b64_tr_b16 a[136:137], v9 offset:4096
    ds_read_b64_tr_b16 a[138:139], v9 offset:5120
    v_mfma_f32_32x32x16_bf16 v[88:103], a[124:127], v[64:67], v[88:103]
    buffer_load_dwordx4 v5, s[28:31], s62 offen offset:0 lds
    ds_read_b64_tr_b16 a[140:141], v10 offset:4096
    ds_read_b64_tr_b16 a[142:143], v10 offset:5120
    v_mfma_f32_32x32x16_bf16 v[120:135], a[124:127], v[68:71], v[120:135]
    buffer_load_dwordx4 v6, s[28:31], s62 offen offset:1024 lds
    v_mfma_f32_32x32x16_bf16 v[104:119], a[120:123], v[68:71], v[104:119]
    s_waitcnt vmcnt(14) lgkmcnt(0)
    s_barrier
    v_mfma_f32_32x32x16_bf16 v[72:87], a[128:131], v[40:43], v[72:87]
    s_add_u32 m0, s69, 0
    s_mul_i32 s71, s62, 1792
    buffer_load_dwordx4 v1, s[32:35], s71 offen offset:0 lds
    ds_read_b128 v[56:59], v13 offset:8192
    ds_read_b128 v[60:63], v13 offset:12288
    v_mfma_f32_32x32x16_bf16 v[88:103], a[132:135], v[40:43], v[88:103]
    buffer_load_dwordx4 v2, s[32:35], s71 offen offset:1024 lds
    ds_read_b128 v[64:67], v14 offset:8192
    ds_read_b128 v[68:71], v14 offset:12288
    v_mfma_f32_32x32x16_bf16 v[120:135], a[132:135], v[44:47], v[120:135]
    buffer_load_dwordx4 v3, s[32:35], s71 offen offset:2048 lds
    ds_read_b64_tr_b16 a[144:145], v9 offset:16384
    ds_read_b64_tr_b16 a[146:147], v9 offset:17408
    v_mfma_f32_32x32x16_bf16 v[104:119], a[128:131], v[44:47], v[104:119]
    buffer_load_dwordx4 v4, s[32:35], s71 offen offset:3072 lds
    ds_read_b64_tr_b16 a[148:149], v10 offset:16384
    ds_read_b64_tr_b16 a[150:151], v10 offset:17408
    v_mfma_f32_32x32x16_bf16 v[72:87], a[136:139], v[48:51], v[72:87]
    ds_read_b64_tr_b16 a[152:153], v9 offset:20480
    ds_read_b64_tr_b16 a[154:155], v9 offset:21504
    v_mfma_f32_32x32x16_bf16 v[88:103], a[140:143], v[48:51], v[88:103]
    ds_read_b64_tr_b16 a[156:157], v10 offset:20480
    ds_read_b64_tr_b16 a[158:159], v10 offset:21504
    v_mfma_f32_32x32x16_bf16 v[120:135], a[140:143], v[52:55], v[120:135]
    v_mfma_f32_32x32x16_bf16 v[104:119], a[136:139], v[52:55], v[104:119]
    s_waitcnt vmcnt(12) lgkmcnt(0)
    s_barrier
    v_mfma_f32_32x32x16_bf16 v[72:87], a[144:147], v[56:59], v[72:87]
    s_add_u32 m0, s69, 16384
    s_mul_i32 s71, s62, 1792
    s_add_u32 s71, s71, 114688
    buffer_load_dwordx4 v1, s[32:35], s71 offen offset:0 lds
    ds_read_b128 v[40:43], v11 offset:16384
    ds_read_b128 v[44:47], v11 offset:20480
    v_mfma_f32_32x32x16_bf16 v[88:103], a[148:151], v[56:59], v[88:103]
    buffer_load_dwordx4 v2, s[32:35], s71 offen offset:1024 lds
    ds_read_b128 v[48:51], v12 offset:16384
    ds_read_b128 v[52:55], v12 offset:20480
    v_mfma_f32_32x32x16_bf16 v[120:135], a[148:151], v[60:63], v[120:135]
    buffer_load_dwordx4 v3, s[32:35], s71 offen offset:2048 lds
    ds_read_b64_tr_b16 a[160:161], v9 offset:32768
    ds_read_b64_tr_b16 a[162:163], v9 offset:33792
    v_mfma_f32_32x32x16_bf16 v[104:119], a[144:147], v[60:63], v[104:119]
    buffer_load_dwordx4 v4, s[32:35], s71 offen offset:3072 lds
    ds_read_b64_tr_b16 a[164:165], v10 offset:32768
    ds_read_b64_tr_b16 a[166:167], v10 offset:33792
    v_mfma_f32_32x32x16_bf16 v[72:87], a[152:155], v[64:67], v[72:87]
    ds_read_b64_tr_b16 a[168:169], v9 offset:36864
    ds_read_b64_tr_b16 a[170:171], v9 offset:37888
    v_mfma_f32_32x32x16_bf16 v[88:103], a[156:159], v[64:67], v[88:103]
    ds_read_b64_tr_b16 a[172:173], v10 offset:36864
    ds_read_b64_tr_b16 a[174:175], v10 offset:37888
    v_mfma_f32_32x32x16_bf16 v[120:135], a[156:159], v[68:71], v[120:135]
    v_mfma_f32_32x32x16_bf16 v[104:119], a[152:155], v[68:71], v[104:119]
    s_waitcnt vmcnt(10) lgkmcnt(0)
    s_barrier
    v_mfma_f32_32x32x16_bf16 v[72:87], a[160:163], v[40:43], v[72:87]
    s_add_u32 m0, s66, 102400
    ds_read_b128 v[56:59], v13 offset:16384
    ds_read_b128 v[60:63], v13 offset:20480
    v_mfma_f32_32x32x16_bf16 v[88:103], a[164:167], v[40:43], v[88:103]
    buffer_load_dwordx4 v8, s[28:31], s56 offen lds
    ds_read_b128 v[64:67], v14 offset:16384
    ds_read_b128 v[68:71], v14 offset:20480
    v_mfma_f32_32x32x16_bf16 v[120:135], a[164:167], v[44:47], v[120:135]
    s_add_u32 m0, m0, 4096
    ds_read_b64_tr_b16 a[176:177], v9 offset:49152
    ds_read_b64_tr_b16 a[178:179], v9 offset:50176
    v_mfma_f32_32x32x16_bf16 v[104:119], a[160:163], v[44:47], v[104:119]
    buffer_load_dwordx4 v8, s[28:31], s57 offen lds
    ds_read_b64_tr_b16 a[180:181], v10 offset:49152
    ds_read_b64_tr_b16 a[182:183], v10 offset:50176
    v_mfma_f32_32x32x16_bf16 v[72:87], a[168:171], v[48:51], v[72:87]
    s_add_u32 m0, m0, 4096
    ds_read_b64_tr_b16 a[184:185], v9 offset:53248
    ds_read_b64_tr_b16 a[186:187], v9 offset:54272
    v_mfma_f32_32x32x16_bf16 v[88:103], a[172:175], v[48:51], v[88:103]
    buffer_load_dwordx4 v8, s[28:31], s58 offen lds
    ds_read_b64_tr_b16 a[188:189], v10 offset:53248
    ds_read_b64_tr_b16 a[190:191], v10 offset:54272
    v_mfma_f32_32x32x16_bf16 v[120:135], a[172:175], v[52:55], v[120:135]
    s_add_u32 m0, m0, 4096
    v_mfma_f32_32x32x16_bf16 v[104:119], a[168:171], v[52:55], v[104:119]
    buffer_load_dwordx4 v8, s[28:31], s59 offen lds
    s_waitcnt vmcnt(8) lgkmcnt(0)
    s_barrier
    v_mfma_f32_32x32x16_bf16 v[72:87], a[176:179], v[56:59], v[72:87]
    s_add_u32 m0, m0, 4096
    ds_read_b128 v[40:43], v11 offset:0
    ds_read_b128 v[44:47], v11 offset:4096
    v_mfma_f32_32x32x16_bf16 v[88:103], a[180:183], v[56:59], v[88:103]
    buffer_load_dwordx4 v8, s[28:31], s60 offen lds
    ds_read_b128 v[48:51], v12 offset:0
    ds_read_b128 v[52:55], v12 offset:4096
    v_mfma_f32_32x32x16_bf16 v[120:135], a[180:183], v[60:63], v[120:135]
    s_add_u32 m0, m0, 4096
    ds_read_b64_tr_b16 a[192:193], v9 offset:0
    ds_read_b64_tr_b16 a[194:195], v9 offset:1024
    v_mfma_f32_32x32x16_bf16 v[104:119], a[176:179], v[60:63], v[104:119]
    buffer_load_dwordx4 v8, s[28:31], s61 offen lds
    ds_read_b64_tr_b16 a[196:197], v10 offset:0
    ds_read_b64_tr_b16 a[198:199], v10 offset:1024
    v_mfma_f32_32x32x16_bf16 v[72:87], a[184:187], v[64:67], v[72:87]
    s_add_u32 m0, m0, 4096
    ds_read_b64_tr_b16 a[200:201], v9 offset:4096
    ds_read_b64_tr_b16 a[202:203], v9 offset:5120
    v_mfma_f32_32x32x16_bf16 v[88:103], a[188:191], v[64:67], v[88:103]
    buffer_load_dwordx4 v8, s[28:31], s62 offen lds
    ds_read_b64_tr_b16 a[204:205], v10 offset:4096
    ds_read_b64_tr_b16 a[206:207], v10 offset:5120
    v_mfma_f32_32x32x16_bf16 v[120:135], a[188:191], v[68:71], v[120:135]
    s_add_u32 m0, s66, 131072
    v_add_u32 v8, s68, v8
    v_mfma_f32_32x32x16_bf16 v[104:119], a[184:187], v[68:71], v[104:119]
    buffer_load_dwordx4 v8, s[28:31], s56 offen lds
    s_waitcnt vmcnt(8) lgkmcnt(0)
    s_barrier
    v_mfma_f32_32x32x16_bf16 v[72:87], a[192:195], v[40:43], v[72:87]
    s_add_u32 m0, m0, 4096
    ds_read_b128 v[56:59], v13 offset:0
    ds_read_b128 v[60:63], v13 offset:4096
    v_mfma_f32_32x32x16_bf16 v[88:103], a[196:199], v[40:43], v[88:103]
    buffer_load_dwordx4 v8, s[28:31], s57 offen lds
    ds_read_b128 v[64:67], v14 offset:0
    ds_read_b128 v[68:71], v14 offset:4096
    v_mfma_f32_32x32x16_bf16 v[120:135], a[196:199], v[44:47], v[120:135]
    s_add_u32 m0, m0, 4096
    ds_read_b64_tr_b16 a[208:209], v9 offset:16384
    ds_read_b64_tr_b16 a[210:211], v9 offset:17408
    v_mfma_f32_32x32x16_bf16 v[104:119], a[192:195], v[44:47], v[104:119]
    buffer_load_dwordx4 v8, s[28:31], s58 offen lds
    ds_read_b64_tr_b16 a[212:213], v10 offset:16384
    ds_read_b64_tr_b16 a[214:215], v10 offset:17408
    v_mfma_f32_32x32x16_bf16 v[72:87], a[200:203], v[48:51], v[72:87]
    s_add_u32 m0, m0, 4096
    ds_read_b64_tr_b16 a[216:217], v9 offset:20480
    ds_read_b64_tr_b16 a[218:219], v9 offset:21504
    v_mfma_f32_32x32x16_bf16 v[88:103], a[204:207], v[48:51], v[88:103]
    buffer_load_dwordx4 v8, s[28:31], s59 offen lds
    ds_read_b64_tr_b16 a[220:221], v10 offset:20480
    ds_read_b64_tr_b16 a[222:223], v10 offset:21504
    v_mfma_f32_32x32x16_bf16 v[120:135], a[204:207], v[52:55], v[120:135]
    s_add_u32 m0, m0, 4096
    v_mfma_f32_32x32x16_bf16 v[104:119], a[200:203], v[52:55], v[104:119]
    buffer_load_dwordx4 v8, s[28:31], s60 offen lds
    s_add_u32 m0, m0, 4096
    s_nop 0
    buffer_load_dwordx4 v8, s[28:31], s61 offen lds
    s_add_u32 m0, m0, 4096
    s_nop 0
    buffer_load_dwordx4 v8, s[28:31], s62 offen lds
    s_waitcnt vmcnt(7) lgkmcnt(0)
    s_barrier
    v_add_u32 v11, 36864, v11
    v_add_u32 v12, 36864, v12
    v_add_u32 v13, 36864, v13
    v_add_u32 v14, 36864, v14
    v_mfma_f32_32x32x16_bf16 v[72:87], a[208:211], v[56:59], v[72:87]
    ds_read_b128 v[24:27], v11 offset:0
    ds_read_b128 v[28:31], v12 offset:0
    v_mfma_f32_32x32x16_bf16 v[88:103], a[212:215], v[56:59], v[88:103]
    ds_read_b128 v[32:35], v13 offset:0
    ds_read_b128 v[36:39], v14 offset:0
    v_mfma_f32_32x32x16_bf16 v[120:135], a[212:215], v[60:63], v[120:135]
    ds_read_b128 v[40:43], v11 offset:4096
    ds_read_b128 v[44:47], v12 offset:4096
    v_mfma_f32_32x32x16_bf16 v[104:119], a[208:211], v[60:63], v[104:119]
    ds_read_b128 v[48:51], v13 offset:4096
    ds_read_b128 v[52:55], v14 offset:4096
    v_mfma_f32_32x32x16_bf16 v[72:87], a[216:219], v[64:67], v[72:87]
    v_mfma_f32_32x32x16_bf16 v[88:103], a[220:223], v[64:67], v[88:103]
    v_mfma_f32_32x32x16_bf16 v[120:135], a[220:223], v[68:71], v[120:135]
    v_mfma_f32_32x32x16_bf16 v[104:119], a[216:219], v[68:71], v[104:119]
    s_waitcnt lgkmcnt(4)
    v_mfma_f32_32x32x16_bf16 v[136:151], a[0:3], v[24:27], 0
    s_add_u32 m0, s79, 0
    s_mul_i32 s71, s3, 100352
    ds_read_b128 v[56:59], v11 offset:8192
    buffer_load_dwordx4 v176, s[48:51], s71 offen offset:0 lds
    v_mfma_f32_32x32x16_bf16 v[152:167], a[4:7], v[24:27], 0
    ds_read_b128 v[60:63], v12 offset:8192
    v_mfma_f32_32x32x16_bf16 v[136:151], a[8:11], v[28:31], v[136:151]
    buffer_load_dwordx4 v177, s[48:51], s71 offen offset:1024 lds
    v_mul_f32 v16, s72, v72
    v_mul_f32 v17, s72, v73
    v_exp_f32 v16, v16
    v_mul_f32 v72, v72, v80
    v_mfma_f32_32x32x16_bf16 v[152:167], a[12:15], v[28:31], v[152:167]
    ds_read_b128 v[64:67], v13 offset:8192
    v_exp_f32 v17, v17
    v_mul_f32 v73, v73, v81
    v_add_f32 v16, 1.0, v16
    v_add_f32 v17, 1.0, v17
    v_mfma_f32_32x32x16_bf16 v[136:151], a[16:19], v[32:35], v[136:151]
    buffer_load_dwordx4 v178, s[48:51], s71 offen offset:2048 lds
    v_rcp_f32 v16, v16
    v_rcp_f32 v17, v17
    v_mul_f32 v18, s72, v74
    v_mfma_f32_32x32x16_bf16 v[152:167], a[20:23], v[32:35], v[152:167]
    ds_read_b128 v[68:71], v14 offset:8192
    v_mul_f32 v72, v72, v16
    v_mul_f32 v73, v73, v17
    v_cvt_pk_bf16_f32 v72, v72, v73
    v_mul_f32 v19, s72, v75
    v_mul_f32 v74, v74, v82
    v_mfma_f32_32x32x16_bf16 v[136:151], a[24:27], v[36:39], v[136:151]
    buffer_load_dwordx4 v175, s[48:51], s71 offen offset:3072 lds
    v_exp_f32 v18, v18
    v_exp_f32 v19, v19
    v_mul_f32 v75, v75, v83
    v_mfma_f32_32x32x16_bf16 v[152:167], a[28:31], v[36:39], v[152:167]
    s_add_u32 m0, s79, 4096
    s_add_u32 s71, s71, 25088
    v_add_f32 v18, 1.0, v18
    v_add_f32 v19, 1.0, v19
    v_rcp_f32 v18, v18
    v_mul_f32 v16, s72, v76
    s_waitcnt lgkmcnt(4)
    v_mfma_f32_32x32x16_bf16 v[136:151], a[32:35], v[40:43], v[136:151]
    ds_read_b128 v[24:27], v11 offset:12288
    buffer_load_dwordx4 v176, s[48:51], s71 offen offset:0 lds
    v_rcp_f32 v19, v19
    v_mul_f32 v74, v74, v18
    v_mul_f32 v17, s72, v77
    v_mfma_f32_32x32x16_bf16 v[152:167], a[36:39], v[40:43], v[152:167]
    ds_read_b128 v[28:31], v12 offset:12288
    v_mul_f32 v75, v75, v19
    v_cvt_pk_bf16_f32 v73, v74, v75
    v_exp_f32 v16, v16
    v_mul_f32 v76, v76, v84
    v_mfma_f32_32x32x16_bf16 v[136:151], a[40:43], v[44:47], v[136:151]
    buffer_load_dwordx4 v177, s[48:51], s71 offen offset:1024 lds
    v_exp_f32 v17, v17
    v_mul_f32 v77, v77, v85
    v_add_f32 v16, 1.0, v16
    v_add_f32 v17, 1.0, v17
    v_mfma_f32_32x32x16_bf16 v[152:167], a[44:47], v[44:47], v[152:167]
    ds_read_b128 v[32:35], v13 offset:12288
    v_rcp_f32 v16, v16
    v_rcp_f32 v17, v17
    v_mul_f32 v18, s72, v78
    v_mfma_f32_32x32x16_bf16 v[136:151], a[48:51], v[48:51], v[136:151]
    buffer_load_dwordx4 v178, s[48:51], s71 offen offset:2048 lds
    v_mul_f32 v76, v76, v16
    v_mul_f32 v77, v77, v17
    v_cvt_pk_bf16_f32 v74, v76, v77
    v_mul_f32 v19, s72, v79
    v_mul_f32 v78, v78, v86
    v_mfma_f32_32x32x16_bf16 v[152:167], a[52:55], v[48:51], v[152:167]
    ds_read_b128 v[36:39], v14 offset:12288
    v_exp_f32 v18, v18
    v_exp_f32 v19, v19
    v_mul_f32 v79, v79, v87
    v_mfma_f32_32x32x16_bf16 v[136:151], a[56:59], v[52:55], v[136:151]
    buffer_load_dwordx4 v175, s[48:51], s71 offen offset:3072 lds
    v_add_f32 v18, 1.0, v18
    v_add_f32 v19, 1.0, v19
    v_rcp_f32 v18, v18
    v_mul_f32 v16, s72, v88
    v_mfma_f32_32x32x16_bf16 v[152:167], a[60:63], v[52:55], v[152:167]
    s_add_u32 m0, s79, 8192
    s_add_u32 s71, s71, 25088
    v_rcp_f32 v19, v19
    v_mul_f32 v78, v78, v18
    v_mul_f32 v17, s72, v89
    v_mul_f32 v88, v88, v96
    s_waitcnt lgkmcnt(4)
    v_mfma_f32_32x32x16_bf16 v[136:151], a[64:67], v[56:59], v[136:151]
    ds_read_b128 v[40:43], v11 offset:16384
    buffer_load_dwordx4 v176, s[48:51], s71 offen offset:0 lds
    v_mul_f32 v79, v79, v19
    v_cvt_pk_bf16_f32 v75, v78, v79
    v_exp_f32 v16, v16
    v_mfma_f32_32x32x16_bf16 v[152:167], a[68:71], v[56:59], v[152:167]
    ds_read_b128 v[44:47], v12 offset:16384
    buffer_store_dwordx4 v[72:75], v21, s[36:39], s73 offen offset:0 sc1
    v_exp_f32 v17, v17
    v_mul_f32 v89, v89, v97
    v_add_f32 v16, 1.0, v16
    v_mfma_f32_32x32x16_bf16 v[136:151], a[72:75], v[60:63], v[136:151]
    buffer_load_dwordx4 v177, s[48:51], s71 offen offset:1024 lds
    v_add_f32 v17, 1.0, v17
    v_rcp_f32 v16, v16
    v_rcp_f32 v17, v17
    v_mfma_f32_32x32x16_bf16 v[152:167], a[76:79], v[60:63], v[152:167]
    ds_read_b128 v[48:51], v13 offset:16384
    v_mul_f32 v88, v88, v16
    v_mul_f32 v89, v89, v17
    v_cvt_pk_bf16_f32 v88, v88, v89
    v_mul_f32 v18, s72, v90
    v_mul_f32 v19, s72, v91
    v_mfma_f32_32x32x16_bf16 v[136:151], a[80:83], v[64:67], v[136:151]
    buffer_load_dwordx4 v178, s[48:51], s71 offen offset:2048 lds
    v_exp_f32 v18, v18
    v_exp_f32 v19, v19
    v_mul_f32 v90, v90, v98
    v_mfma_f32_32x32x16_bf16 v[152:167], a[84:87], v[64:67], v[152:167]
    ds_read_b128 v[52:55], v14 offset:16384
    v_mul_f32 v91, v91, v99
    v_add_f32 v18, 1.0, v18
    v_add_f32 v19, 1.0, v19
    v_rcp_f32 v18, v18
    v_mfma_f32_32x32x16_bf16 v[136:151], a[88:91], v[68:71], v[136:151]
    buffer_load_dwordx4 v175, s[48:51], s71 offen offset:3072 lds
    v_rcp_f32 v19, v19
    v_mul_f32 v90, v90, v18
    v_mul_f32 v16, s72, v92
    v_mul_f32 v17, s72, v93
    v_mfma_f32_32x32x16_bf16 v[152:167], a[92:95], v[68:71], v[152:167]
    s_add_u32 m0, s79, 12288
    s_add_u32 s71, s71, 25088
    v_mul_f32 v91, v91, v19
    v_cvt_pk_bf16_f32 v89, v90, v91
    v_exp_f32 v16, v16
    v_mul_f32 v92, v92, v100
    s_waitcnt lgkmcnt(4)
    v_mfma_f32_32x32x16_bf16 v[136:151], a[96:99], v[24:27], v[136:151]
    ds_read_b128 v[56:59], v11 offset:20480
    buffer_load_dwordx4 v176, s[48:51], s71 offen offset:0 lds
    v_exp_f32 v17, v17
    v_mul_f32 v93, v93, v101
    v_add_f32 v16, 1.0, v16
    v_mfma_f32_32x32x16_bf16 v[152:167], a[100:103], v[24:27], v[152:167]
    ds_read_b128 v[60:63], v12 offset:20480
    v_add_f32 v17, 1.0, v17
    v_rcp_f32 v16, v16
    v_rcp_f32 v17, v17
    v_mfma_f32_32x32x16_bf16 v[136:151], a[104:107], v[28:31], v[136:151]
    buffer_load_dwordx4 v177, s[48:51], s71 offen offset:1024 lds
    v_mul_f32 v92, v92, v16
    v_mul_f32 v93, v93, v17
    v_cvt_pk_bf16_f32 v90, v92, v93
    v_mul_f32 v18, s72, v94
    v_mul_f32 v19, s72, v95
    v_mfma_f32_32x32x16_bf16 v[152:167], a[108:111], v[28:31], v[152:167]
    ds_read_b128 v[64:67], v13 offset:20480
    v_exp_f32 v18, v18
    v_exp_f32 v19, v19
    v_mul_f32 v94, v94, v102
    v_mfma_f32_32x32x16_bf16 v[136:151], a[112:115], v[32:35], v[136:151]
    buffer_load_dwordx4 v178, s[48:51], s71 offen offset:2048 lds
    v_mul_f32 v95, v95, v103
    v_add_f32 v18, 1.0, v18
    v_add_f32 v19, 1.0, v19
    v_rcp_f32 v18, v18
    v_mfma_f32_32x32x16_bf16 v[152:167], a[116:119], v[32:35], v[152:167]
    ds_read_b128 v[68:71], v14 offset:20480
    v_rcp_f32 v19, v19
    v_mul_f32 v94, v94, v18
    v_mul_f32 v16, s72, v104
    v_mul_f32 v17, s72, v105
    v_mfma_f32_32x32x16_bf16 v[136:151], a[120:123], v[36:39], v[136:151]
    buffer_load_dwordx4 v175, s[48:51], s71 offen offset:3072 lds
    v_mul_f32 v95, v95, v19
    v_cvt_pk_bf16_f32 v91, v94, v95
    v_exp_f32 v16, v16
    v_mul_f32 v104, v104, v112
    v_mfma_f32_32x32x16_bf16 v[152:167], a[124:127], v[36:39], v[152:167]
    s_add_u32 m0, s79, 16384
    s_add_u32 s71, s77, s14
    buffer_store_dwordx4 v[88:91], v21, s[36:39], s73 offen offset:512 sc1
    v_exp_f32 v17, v17
    v_mul_f32 v105, v105, v113
    v_add_f32 v16, 1.0, v16
    s_waitcnt lgkmcnt(4)
    v_mfma_f32_32x32x16_bf16 v[136:151], a[128:131], v[40:43], v[136:151]
    s_add_u32 s73, s73, s67
    ds_read_b128 v[24:27], v11 offset:24576
    buffer_load_dwordx4 v176, s[44:47], s71 offen offset:0 lds
    v_add_f32 v17, 1.0, v17
    v_rcp_f32 v16, v16
    v_mul_f32 v18, s72, v106
    v_mfma_f32_32x32x16_bf16 v[152:167], a[132:135], v[40:43], v[152:167]
    ds_read_b128 v[28:31], v12 offset:24576
    v_rcp_f32 v17, v17
    v_mul_f32 v104, v104, v16
    v_mul_f32 v19, s72, v107
    v_mul_f32 v106, v106, v114
    v_mfma_f32_32x32x16_bf16 v[136:151], a[136:139], v[44:47], v[136:151]
    buffer_load_dwordx4 v177, s[44:47], s71 offen offset:1024 lds
    v_mul_f32 v105, v105, v17
    v_cvt_pk_bf16_f32 v104, v104, v105
    v_exp_f32 v18, v18
    v_mul_f32 v107, v107, v115
    v_mfma_f32_32x32x16_bf16 v[152:167], a[140:143], v[44:47], v[152:167]
    ds_read_b128 v[32:35], v13 offset:24576
    v_exp_f32 v19, v19
    v_add_f32 v18, 1.0, v18
    v_rcp_f32 v18, v18
    v_mfma_f32_32x32x16_bf16 v[136:151], a[144:147], v[48:51], v[136:151]
    buffer_load_dwordx4 v178, s[44:47], s71 offen offset:2048 lds
    v_add_f32 v19, 1.0, v19
    v_rcp_f32 v19, v19
    v_mul_f32 v106, v106, v18
    v_mul_f32 v16, s72, v108
    v_mfma_f32_32x32x16_bf16 v[152:167], a[148:151], v[48:51], v[152:167]
    ds_read_b128 v[36:39], v14 offset:24576
    v_mul_f32 v107, v107, v19
    v_cvt_pk_bf16_f32 v105, v106, v107
    v_mul_f32 v17, s72, v109
    v_exp_f32 v16, v16
    v_mfma_f32_32x32x16_bf16 v[136:151], a[152:155], v[52:55], v[136:151]
    buffer_load_dwordx4 v179, s[44:47], s71 offen offset:3072 lds
    v_exp_f32 v17, v17
    v_mul_f32 v108, v108, v116
    v_mul_f32 v109, v109, v117
    v_add_f32 v16, 1.0, v16
    v_mfma_f32_32x32x16_bf16 v[152:167], a[156:159], v[52:55], v[152:167]
    s_add_u32 m0, s79, 20480
    s_add_u32 s77, s77, 229376
    s_cmp_eq_u32 s77, 1605632
    s_cselect_b32 s77, 0, s77
    v_add_f32 v17, 1.0, v17
    v_rcp_f32 v16, v16
    s_waitcnt vmcnt(22)
    s_barrier
    s_waitcnt lgkmcnt(4)
    v_mfma_f32_32x32x16_bf16 v[136:151], a[160:163], v[56:59], v[136:151]
    s_add_u32 s71, s77, s14
    ds_read_b128 v[40:43], v11 offset:28672
    buffer_load_dwordx4 v176, s[44:47], s71 offen offset:0 lds
    v_rcp_f32 v17, v17
    v_mul_f32 v108, v108, v16
    v_mul_f32 v18, s72, v110
    v_mfma_f32_32x32x16_bf16 v[152:167], a[164:167], v[56:59], v[152:167]
    ds_read_b128 v[44:47], v12 offset:28672
    v_mul_f32 v109, v109, v17
    v_cvt_pk_bf16_f32 v106, v108, v109
    v_mul_f32 v19, s72, v111
    v_exp_f32 v18, v18
    v_mfma_f32_32x32x16_bf16 v[136:151], a[168:171], v[60:63], v[136:151]
    buffer_load_dwordx4 v177, s[44:47], s71 offen offset:1024 lds
    v_exp_f32 v19, v19
    v_mul_f32 v110, v110, v118
    v_mul_f32 v111, v111, v119
    v_add_f32 v18, 1.0, v18
    v_mfma_f32_32x32x16_bf16 v[152:167], a[172:175], v[60:63], v[152:167]
    ds_read_b128 v[48:51], v13 offset:28672
    v_add_f32 v19, 1.0, v19
    v_rcp_f32 v18, v18
    v_rcp_f32 v19, v19
    v_mfma_f32_32x32x16_bf16 v[136:151], a[176:179], v[64:67], v[136:151]
    buffer_load_dwordx4 v178, s[44:47], s71 offen offset:2048 lds
    v_mul_f32 v110, v110, v18
    v_mul_f32 v111, v111, v19
    v_cvt_pk_bf16_f32 v107, v110, v111
    v_mul_f32 v16, s72, v120
    v_mul_f32 v17, s72, v121
    v_mfma_f32_32x32x16_bf16 v[152:167], a[180:183], v[64:67], v[152:167]
    ds_read_b128 v[52:55], v14 offset:28672
    buffer_store_dwordx4 v[104:107], v21, s[36:39], s73 offen offset:0 sc1
    v_exp_f32 v16, v16
    v_exp_f32 v17, v17
    v_mfma_f32_32x32x16_bf16 v[136:151], a[184:187], v[68:71], v[136:151]
    buffer_load_dwordx4 v179, s[44:47], s71 offen offset:3072 lds
    v_mul_f32 v120, v120, v128
    v_mul_f32 v121, v121, v129
    v_add_f32 v16, 1.0, v16
    v_add_f32 v17, 1.0, v17
    v_mul_f32 v18, s72, v122
    v_mfma_f32_32x32x16_bf16 v[152:167], a[188:191], v[68:71], v[152:167]
    v_rcp_f32 v16, v16
    v_rcp_f32 v17, v17
    v_mul_f32 v19, s72, v123
    v_mul_f32 v122, v122, v130
    s_waitcnt lgkmcnt(4)
    v_mfma_f32_32x32x16_bf16 v[136:151], a[192:195], v[24:27], v[136:151]
    ds_read_b128 v[56:59], v11 offset:32768
    v_mul_f32 v120, v120, v16
    v_mul_f32 v121, v121, v17
    v_cvt_pk_bf16_f32 v120, v120, v121
    v_exp_f32 v18, v18
    v_mfma_f32_32x32x16_bf16 v[152:167], a[196:199], v[24:27], v[152:167]
    ds_read_b128 v[60:63], v12 offset:32768
    v_exp_f32 v19, v19
    v_mul_f32 v123, v123, v131
    v_add_f32 v18, 1.0, v18
    v_add_f32 v19, 1.0, v19
    v_mfma_f32_32x32x16_bf16 v[136:151], a[200:203], v[28:31], v[136:151]
    v_rcp_f32 v18, v18
    v_rcp_f32 v19, v19
    v_mul_f32 v16, s72, v124
    v_mul_f32 v17, s72, v125
    v_mfma_f32_32x32x16_bf16 v[152:167], a[204:207], v[28:31], v[152:167]
    ds_read_b128 v[64:67], v13 offset:32768
    v_mul_f32 v122, v122, v18
    v_mul_f32 v123, v123, v19
    v_cvt_pk_bf16_f32 v121, v122, v123
    v_exp_f32 v16, v16
    v_mfma_f32_32x32x16_bf16 v[136:151], a[208:211], v[32:35], v[136:151]
    v_exp_f32 v17, v17
    v_mul_f32 v124, v124, v132
    v_mul_f32 v125, v125, v133
    v_add_f32 v16, 1.0, v16
    v_add_f32 v17, 1.0, v17
    v_mfma_f32_32x32x16_bf16 v[152:167], a[212:215], v[32:35], v[152:167]
    ds_read_b128 v[68:71], v14 offset:32768
    v_rcp_f32 v16, v16
    v_rcp_f32 v17, v17
    v_mul_f32 v18, s72, v126
    v_mfma_f32_32x32x16_bf16 v[136:151], a[216:219], v[36:39], v[136:151]
    v_mul_f32 v124, v124, v16
    v_mul_f32 v125, v125, v17
    v_cvt_pk_bf16_f32 v122, v124, v125
    v_mul_f32 v19, s72, v127
    v_exp_f32 v18, v18
    v_mfma_f32_32x32x16_bf16 v[152:167], a[220:223], v[36:39], v[152:167]
    v_exp_f32 v19, v19
    v_mul_f32 v126, v126, v134
    v_mul_f32 v127, v127, v135
    v_add_f32 v18, 1.0, v18
    v_add_f32 v19, 1.0, v19
    v_rcp_f32 v18, v18
    v_rcp_f32 v19, v19
    v_mul_f32 v126, v126, v18
    v_mul_f32 v127, v127, v19
    v_cvt_pk_bf16_f32 v123, v126, v127
    buffer_store_dwordx4 v[120:123], v21, s[36:39], s73 offen offset:512 sc1
    s_add_u32 s73, s73, s67
    s_barrier
    s_waitcnt lgkmcnt(4)
    v_mfma_f32_32x32x16_bf16 v[72:87], a[0:3], v[40:43], 0
    s_add_u32 m0, s66, 102400
    ds_read_b128 v[24:27], v11 offset:36864
    v_add_u32 v8, s68, v8
    v_mfma_f32_32x32x16_bf16 v[88:103], a[4:7], v[40:43], 0
    ds_read_b128 v[28:31], v12 offset:36864
    buffer_load_dwordx4 v8, s[28:31], s56 offen lds
    v_mfma_f32_32x32x16_bf16 v[72:87], a[8:11], v[44:47], v[72:87]
    s_add_u32 m0, m0, 4096
    v_mfma_f32_32x32x16_bf16 v[88:103], a[12:15], v[44:47], v[88:103]
    ds_read_b128 v[32:35], v13 offset:36864
    buffer_load_dwordx4 v8, s[28:31], s57 offen lds
    v_mfma_f32_32x32x16_bf16 v[72:87], a[16:19], v[48:51], v[72:87]
    s_add_u32 m0, m0, 4096
    v_mul_f32 v16, s72, v136
    v_mul_f32 v17, s72, v137
    v_exp_f32 v16, v16
    v_exp_f32 v17, v17
    v_mfma_f32_32x32x16_bf16 v[88:103], a[20:23], v[48:51], v[88:103]
    ds_read_b128 v[36:39], v14 offset:36864
    buffer_load_dwordx4 v8, s[28:31], s58 offen lds
    v_mul_f32 v136, v136, v144
    v_mul_f32 v137, v137, v145
    v_add_f32 v16, 1.0, v16
    v_add_f32 v17, 1.0, v17
    v_mfma_f32_32x32x16_bf16 v[72:87], a[24:27], v[52:55], v[72:87]
    s_add_u32 m0, m0, 4096
    v_rcp_f32 v16, v16
    v_rcp_f32 v17, v17
    v_mul_f32 v18, s72, v138
    v_mul_f32 v19, s72, v139
    v_mfma_f32_32x32x16_bf16 v[88:103], a[28:31], v[52:55], v[88:103]
    buffer_load_dwordx4 v8, s[28:31], s59 offen lds
    v_mul_f32 v136, v136, v16
    v_mul_f32 v137, v137, v17
    v_cvt_pk_bf16_f32 v136, v136, v137
    v_exp_f32 v18, v18
    s_waitcnt lgkmcnt(4)
    v_mfma_f32_32x32x16_bf16 v[72:87], a[32:35], v[56:59], v[72:87]
    s_add_u32 m0, m0, 4096
    ds_read_b128 v[40:43], v11 offset:40960
    v_exp_f32 v19, v19
    v_mul_f32 v138, v138, v146
    v_mul_f32 v139, v139, v147
    v_add_f32 v18, 1.0, v18
    v_mfma_f32_32x32x16_bf16 v[88:103], a[36:39], v[56:59], v[88:103]
    ds_read_b128 v[44:47], v12 offset:40960
    buffer_load_dwordx4 v8, s[28:31], s60 offen lds
    v_add_f32 v19, 1.0, v19
    v_rcp_f32 v18, v18
    v_mul_f32 v16, s72, v140
    v_mfma_f32_32x32x16_bf16 v[72:87], a[40:43], v[60:63], v[72:87]
    s_add_u32 m0, m0, 4096
    v_rcp_f32 v19, v19
    v_mul_f32 v138, v138, v18
    v_mul_f32 v17, s72, v141
    v_exp_f32 v16, v16
    v_mfma_f32_32x32x16_bf16 v[88:103], a[44:47], v[60:63], v[88:103]
    ds_read_b128 v[48:51], v13 offset:40960
    buffer_load_dwordx4 v8, s[28:31], s61 offen lds
    v_mul_f32 v139, v139, v19
    v_cvt_pk_bf16_f32 v137, v138, v139
    v_exp_f32 v17, v17
    v_mfma_f32_32x32x16_bf16 v[72:87], a[48:51], v[64:67], v[72:87]
    s_add_u32 m0, m0, 4096
    v_mul_f32 v140, v140, v148
    v_mul_f32 v141, v141, v149
    v_add_f32 v16, 1.0, v16
    v_add_f32 v17, 1.0, v17
    v_rcp_f32 v16, v16
    v_mfma_f32_32x32x16_bf16 v[88:103], a[52:55], v[64:67], v[88:103]
    ds_read_b128 v[52:55], v14 offset:40960
    buffer_load_dwordx4 v8, s[28:31], s62 offen lds
    v_rcp_f32 v17, v17
    v_mul_f32 v140, v140, v16
    v_mul_f32 v18, s72, v142
    v_mfma_f32_32x32x16_bf16 v[72:87], a[56:59], v[68:71], v[72:87]
    s_waitcnt vmcnt(31)
    ds_read_b64_tr_b16 a[224:225], v180 offset:0
    ds_read_b64_tr_b16 a[226:227], v180 offset:2048
    v_mul_f32 v141, v141, v17
    v_cvt_pk_bf16_f32 v138, v140, v141
    v_mul_f32 v19, s72, v143
    v_mul_f32 v142, v142, v150
    v_mfma_f32_32x32x16_bf16 v[88:103], a[60:63], v[68:71], v[88:103]
    ds_read_b64_tr_b16 a[228:229], v181 offset:0
    ds_read_b64_tr_b16 a[230:231], v181 offset:2048
    v_exp_f32 v18, v18
    v_exp_f32 v19, v19
    s_waitcnt lgkmcnt(8)
    v_mfma_f32_32x32x16_bf16 v[72:87], a[64:67], v[24:27], v[72:87]
    ds_read_b128 v[56:59], v11 offset:45056
    ds_read_b64_tr_b16 a[232:233], v182 offset:0
    v_mul_f32 v143, v143, v151
    v_add_f32 v18, 1.0, v18
    v_add_f32 v19, 1.0, v19
    v_mul_f32 v16, s72, v152
    v_mfma_f32_32x32x16_bf16 v[88:103], a[68:71], v[24:27], v[88:103]
    ds_read_b128 v[60:63], v12 offset:45056
    ds_read_b64_tr_b16 a[234:235], v182 offset:2048
    v_rcp_f32 v18, v18
    v_rcp_f32 v19, v19
    v_mfma_f32_32x32x16_bf16 v[72:87], a[72:75], v[28:31], v[72:87]
    ds_read_b64_tr_b16 a[236:237], v183 offset:0
    ds_read_b64_tr_b16 a[238:239], v183 offset:2048
    v_mul_f32 v142, v142, v18
    v_mul_f32 v143, v143, v19
    v_cvt_pk_bf16_f32 v139, v142, v143
    v_mul_f32 v17, s72, v153
    v_mfma_f32_32x32x16_bf16 v[88:103], a[76:79], v[28:31], v[88:103]
    s_waitcnt vmcnt(27)
    ds_read_b128 v[64:67], v13 offset:45056
    ds_read_b64_tr_b16 a[240:241], v180 offset:4096
    buffer_store_dwordx4 v[136:139], v21, s[36:39], s73 offen offset:0 sc1
    v_exp_f32 v16, v16
    v_mul_f32 v152, v152, v160
    v_mfma_f32_32x32x16_bf16 v[72:87], a[80:83], v[32:35], v[72:87]
    ds_read_b64_tr_b16 a[242:243], v180 offset:6144
    ds_read_b64_tr_b16 a[244:245], v181 offset:4096
    v_exp_f32 v17, v17
    v_mul_f32 v153, v153, v161
    v_add_f32 v16, 1.0, v16
    v_mfma_f32_32x32x16_bf16 v[88:103], a[84:87], v[32:35], v[88:103]
    ds_read_b128 v[68:71], v14 offset:45056
    ds_read_b64_tr_b16 a[246:247], v181 offset:6144
    v_add_f32 v17, 1.0, v17
    v_rcp_f32 v16, v16
    v_mul_f32 v18, s72, v154
    v_mfma_f32_32x32x16_bf16 v[72:87], a[88:91], v[36:39], v[72:87]
    ds_read_b64_tr_b16 a[248:249], v182 offset:4096
    ds_read_b64_tr_b16 a[250:251], v182 offset:6144
    v_rcp_f32 v17, v17
    v_mul_f32 v152, v152, v16
    v_mul_f32 v19, s72, v155
    v_mfma_f32_32x32x16_bf16 v[88:103], a[92:95], v[36:39], v[88:103]
    ds_read_b64_tr_b16 a[252:253], v183 offset:4096
    ds_read_b64_tr_b16 a[254:255], v183 offset:6144
    v_mul_f32 v153, v153, v17
    v_cvt_pk_bf16_f32 v152, v152, v153
    v_exp_f32 v18, v18
    buffer_load_dword v20, off, s[96:99], 0 sc1
    s_waitcnt lgkmcnt(15)
    v_mfma_f32_32x32x16_bf16 v[72:87], a[96:99], v[40:43], v[72:87]
    s_waitcnt lgkmcnt(10)
    s_add_u32 m0, s79, 0
    s_add_u32 s77, s77, 229376
    ds_read_b128 v[24:27], v11 offset:49152
    v_exp_f32 v19, v19
    v_mul_f32 v154, v154, v162
    v_mfma_f32_32x32x16_bf16 v[88:103], a[100:103], v[40:43], v[88:103]
    s_cmp_eq_u32 s77, 1605632
    s_cselect_b32 s77, 0, s77
    s_add_u32 s71, s77, s14
    ds_read_b128 v[28:31], v12 offset:49152
    buffer_load_dwordx4 v176, s[44:47], s71 offen offset:0 lds
    v_mul_f32 v155, v155, v163
    v_add_f32 v18, 1.0, v18
    v_mfma_f32_32x32x16_bf16 v[72:87], a[104:107], v[44:47], v[72:87]
    v_add_f32 v19, 1.0, v19
    v_rcp_f32 v18, v18
    v_rcp_f32 v19, v19
    v_mul_f32 v16, s72, v156
    v_mfma_f32_32x32x16_bf16 v[88:103], a[108:111], v[44:47], v[88:103]
    ds_read_b128 v[32:35], v13 offset:49152
    buffer_load_dwordx4 v177, s[44:47], s71 offen offset:1024 lds
    v_mul_f32 v154, v154, v18
    v_mul_f32 v155, v155, v19
    v_cvt_pk_bf16_f32 v153, v154, v155
    v_mul_f32 v17, s72, v157
    v_mfma_f32_32x32x16_bf16 v[72:87], a[112:115], v[48:51], v[72:87]
    v_exp_f32 v16, v16
    v_exp_f32 v17, v17
    v_mul_f32 v156, v156, v164
    v_mul_f32 v157, v157, v165
    v_mfma_f32_32x32x16_bf16 v[88:103], a[116:119], v[48:51], v[88:103]
    ds_read_b128 v[36:39], v14 offset:49152
    buffer_load_dwordx4 v178, s[44:47], s71 offen offset:2048 lds
    v_add_f32 v16, 1.0, v16
    v_add_f32 v17, 1.0, v17
    v_rcp_f32 v16, v16
    v_mfma_f32_32x32x16_bf16 v[72:87], a[120:123], v[52:55], v[72:87]
    v_rcp_f32 v17, v17
    v_mul_f32 v156, v156, v16
    v_mul_f32 v18, s72, v158
    v_mul_f32 v19, s72, v159
    v_mul_f32 v158, v158, v166
    v_mfma_f32_32x32x16_bf16 v[88:103], a[124:127], v[52:55], v[88:103]
    buffer_load_dwordx4 v179, s[44:47], s71 offen offset:3072 lds
    v_mul_f32 v157, v157, v17
    v_cvt_pk_bf16_f32 v154, v156, v157
    v_exp_f32 v18, v18
    v_mul_f32 v159, v159, v167
    s_waitcnt lgkmcnt(9)
    v_mfma_f32_32x32x16_bf16 v[72:87], a[128:131], v[56:59], v[72:87]
    s_waitcnt vmcnt(28)
    ds_read_b128 v[40:43], v11 offset:53248
    ds_read_b64_tr_b16 v[184:185], v180 offset:8192
    v_exp_f32 v19, v19
    v_add_f32 v18, 1.0, v18
    v_mfma_f32_32x32x16_bf16 v[88:103], a[132:135], v[56:59], v[88:103]
    ds_read_b128 v[44:47], v12 offset:53248
    ds_read_b64_tr_b16 v[186:187], v180 offset:10240
    v_add_f32 v19, 1.0, v19
    v_rcp_f32 v18, v18
    v_mfma_f32_32x32x16_bf16 v[72:87], a[136:139], v[60:63], v[72:87]
    ds_read_b64_tr_b16 v[188:189], v181 offset:8192
    ds_read_b64_tr_b16 v[190:191], v181 offset:10240
    v_rcp_f32 v19, v19
    v_mul_f32 v158, v158, v18
    v_mfma_f32_32x32x16_bf16 v[88:103], a[140:143], v[60:63], v[88:103]
    ds_read_b128 v[48:51], v13 offset:53248
    ds_read_b64_tr_b16 v[192:193], v182 offset:8192
    v_mul_f32 v159, v159, v19
    v_cvt_pk_bf16_f32 v155, v158, v159
    v_mfma_f32_32x32x16_bf16 v[72:87], a[144:147], v[64:67], v[72:87]
    ds_read_b64_tr_b16 v[194:195], v182 offset:10240
    ds_read_b64_tr_b16 v[196:197], v183 offset:8192
    buffer_store_dwordx4 v[152:155], v21, s[36:39], s73 offen offset:512 sc1
    v_mfma_f32_32x32x16_bf16 v[88:103], a[148:151], v[64:67], v[88:103]
    s_add_u32 s73, s73, s67
    ds_read_b128 v[52:55], v14 offset:53248
    ds_read_b64_tr_b16 v[198:199], v183 offset:10240
    v_mfma_f32_32x32x16_bf16 v[72:87], a[152:155], v[68:71], v[72:87]
    s_waitcnt lgkmcnt(15)
    s_add_u32 m0, s79, 4096
    s_add_u32 s77, s77, 229376
    v_mfma_f32_32x32x16_bf16 v[88:103], a[156:159], v[68:71], v[88:103]
    s_cmp_eq_u32 s77, 1605632
    s_cselect_b32 s77, 0, s77
    s_add_u32 s71, s77, s14
    buffer_load_dwordx4 v176, s[44:47], s71 offen offset:0 lds
    s_waitcnt vmcnt(8)
    s_barrier
    s_waitcnt lgkmcnt(12)
    v_mfma_f32_32x32x16_bf16 v[72:87], a[160:163], v[24:27], v[72:87]
    ds_read_b128 v[56:59], v11 offset:0
    v_mfma_f32_32x32x16_bf16 v[88:103], a[164:167], v[24:27], v[88:103]
    ds_read_b128 v[60:63], v12 offset:0
    buffer_load_dwordx4 v177, s[44:47], s71 offen offset:1024 lds
    v_mfma_f32_32x32x16_bf16 v[72:87], a[168:171], v[28:31], v[72:87]
    v_mfma_f32_32x32x16_bf16 v[88:103], a[172:175], v[28:31], v[88:103]
    ds_read_b128 v[64:67], v13 offset:0
    buffer_load_dwordx4 v178, s[44:47], s71 offen offset:2048 lds
    v_mfma_f32_32x32x16_bf16 v[72:87], a[176:179], v[32:35], v[72:87]
    v_mfma_f32_32x32x16_bf16 v[88:103], a[180:183], v[32:35], v[88:103]
    ds_read_b128 v[68:71], v14 offset:0
    buffer_load_dwordx4 v179, s[44:47], s71 offen offset:3072 lds
    v_mfma_f32_32x32x16_bf16 v[72:87], a[184:187], v[36:39], v[72:87]
    ds_read_b64_tr_b16 v[200:201], v180 offset:12288
    ds_read_b64_tr_b16 v[202:203], v180 offset:14336
    v_mfma_f32_32x32x16_bf16 v[88:103], a[188:191], v[36:39], v[88:103]
    ds_read_b64_tr_b16 v[204:205], v181 offset:12288
    ds_read_b64_tr_b16 v[206:207], v181 offset:14336
    s_waitcnt lgkmcnt(9)
    v_mfma_f32_32x32x16_bf16 v[72:87], a[192:195], v[40:43], v[72:87]
    ds_read_b128 v[24:27], v11 offset:4096
    ds_read_b64_tr_b16 v[208:209], v182 offset:12288
    v_mfma_f32_32x32x16_bf16 v[88:103], a[196:199], v[40:43], v[88:103]
    ds_read_b128 v[28:31], v12 offset:4096
    ds_read_b64_tr_b16 v[210:211], v182 offset:14336
    v_mfma_f32_32x32x16_bf16 v[72:87], a[200:203], v[44:47], v[72:87]
    ds_read_b64_tr_b16 v[212:213], v183 offset:12288
    ds_read_b64_tr_b16 v[214:215], v183 offset:14336
    v_mfma_f32_32x32x16_bf16 v[88:103], a[204:207], v[44:47], v[88:103]
    s_waitcnt lgkmcnt(14)
    s_add_u32 m0, s79, 8192
    s_add_u32 s77, s77, 229376
    ds_read_b128 v[32:35], v13 offset:4096
    v_mfma_f32_32x32x16_bf16 v[72:87], a[208:211], v[48:51], v[72:87]
    s_cmp_eq_u32 s77, 1605632
    s_cselect_b32 s77, 0, s77
    s_add_u32 s71, s77, s14
    buffer_load_dwordx4 v176, s[44:47], s71 offen offset:0 lds
    v_mfma_f32_32x32x16_bf16 v[88:103], a[212:215], v[48:51], v[88:103]
    ds_read_b128 v[36:39], v14 offset:4096
    v_mfma_f32_32x32x16_bf16 v[72:87], a[216:219], v[52:55], v[72:87]
    buffer_load_dwordx4 v177, s[44:47], s71 offen offset:1024 lds
    v_mfma_f32_32x32x16_bf16 v[88:103], a[220:223], v[52:55], v[88:103]
    s_barrier
    s_waitcnt lgkmcnt(12)
    v_mfma_f32_32x32x16_bf16 v[104:119], a[0:3], v[56:59], 0
    ds_read_b128 v[40:43], v11 offset:8192
    buffer_load_dwordx4 v178, s[44:47], s71 offen offset:2048 lds
    v_mfma_f32_32x32x16_bf16 v[120:135], a[4:7], v[56:59], 0
    ds_read_b128 v[44:47], v12 offset:8192
    v_mfma_f32_32x32x16_bf16 v[104:119], a[8:11], v[60:63], v[104:119]
    buffer_load_dwordx4 v179, s[44:47], s71 offen offset:3072 lds
    v_mfma_f32_32x32x16_bf16 v[120:135], a[12:15], v[60:63], v[120:135]
    s_waitcnt lgkmcnt(4)
    s_add_u32 m0, s79, 12288
    s_add_u32 s77, s77, 229376
    ds_read_b128 v[48:51], v13 offset:8192
    v_mfma_f32_32x32x16_bf16 v[104:119], a[16:19], v[64:67], v[104:119]
    s_cmp_eq_u32 s77, 1605632
    s_cselect_b32 s77, 0, s77
    s_add_u32 s71, s77, s14
    buffer_load_dwordx4 v176, s[44:47], s71 offen offset:0 lds
    v_mul_f32 v16, s72, v72
    v_mul_f32 v17, s72, v73
    v_mul_f32 v72, v72, v80
    s_waitcnt vmcnt(9)
    v_readfirstlane_b32 s10, v20
    v_mov_b32 v7, 1
    s_mov_b32 s9, 0x100000
    s_nop 0
    s_cmp_lt_u32 s10, 1
    s_cbranch_scc1 L_slow_h
L_back_h:
    s_mov_b64 exec, 1
    buffer_atomic_add v7, off, s[52:55], s26 sc1
    s_mov_b64 exec, -1
    v_mfma_f32_32x32x16_bf16 v[120:135], a[20:23], v[64:67], v[120:135]
    ds_read_b128 v[52:55], v14 offset:8192
    v_exp_f32 v16, v16
    v_exp_f32 v17, v17
    v_mul_f32 v73, v73, v81
    v_mfma_f32_32x32x16_bf16 v[104:119], a[24:27], v[68:71], v[104:119]
    buffer_load_dwordx4 v177, s[44:47], s71 offen offset:1024 lds
    v_add_f32 v16, 1.0, v16
    v_add_f32 v17, 1.0, v17
    v_rcp_f32 v16, v16
    v_mul_f32 v18, s72, v74
    v_mfma_f32_32x32x16_bf16 v[120:135], a[28:31], v[68:71], v[120:135]
    v_rcp_f32 v17, v17
    v_mul_f32 v72, v72, v16
    v_mul_f32 v19, s72, v75
    v_exp_f32 v18, v18
    s_waitcnt lgkmcnt(4)
    v_mfma_f32_32x32x16_bf16 v[104:119], a[32:35], v[24:27], v[104:119]
    ds_read_b128 v[56:59], v11 offset:12288
    buffer_load_dwordx4 v178, s[44:47], s71 offen offset:2048 lds
    v_mul_f32 v73, v73, v17
    v_cvt_pk_bf16_f32 v72, v72, v73
    v_exp_f32 v19, v19
    v_mfma_f32_32x32x16_bf16 v[120:135], a[36:39], v[24:27], v[120:135]
    ds_read_b128 v[60:63], v12 offset:12288
    v_mul_f32 v74, v74, v82
    v_mul_f32 v75, v75, v83
    v_add_f32 v18, 1.0, v18
    v_add_f32 v19, 1.0, v19
    v_mul_f32 v16, s72, v76
    v_mfma_f32_32x32x16_bf16 v[104:119], a[40:43], v[28:31], v[104:119]
    buffer_load_dwordx4 v179, s[44:47], s71 offen offset:3072 lds
    v_add_u32 v180, v22, v180
    v_add_u32 v181, v22, v181
    v_add_u32 v182, v22, v182
    v_add_u32 v183, v22, v183
    v_mul_f32 v17, s72, v77
    v_mfma_f32_32x32x16_bf16 v[120:135], a[44:47], v[28:31], v[120:135]
    s_add_u32 m0, s69, 131072
    s_add_u32 s71, s77, s15
    ds_read_b128 v[64:67], v13 offset:12288
    ds_read_b64_tr_b16 a[0:1], v180 offset:16384
    v_rcp_f32 v18, v18
    v_mfma_f32_32x32x16_bf16 v[104:119], a[48:51], v[32:35], v[104:119]
    buffer_load_dwordx4 v176, s[44:47], s71 offen offset:0 lds
    ds_read_b64_tr_b16 a[2:3], v180 offset:17408
    ds_read_b64_tr_b16 a[4:5], v181 offset:16384
    v_rcp_f32 v19, v19
    v_mul_f32 v74, v74, v18
    v_mfma_f32_32x32x16_bf16 v[120:135], a[52:55], v[32:35], v[120:135]
    ds_read_b128 v[68:71], v14 offset:12288
    ds_read_b64_tr_b16 a[6:7], v181 offset:17408
    v_mul_f32 v75, v75, v19
    v_cvt_pk_bf16_f32 v73, v74, v75
    v_exp_f32 v16, v16
    v_mfma_f32_32x32x16_bf16 v[104:119], a[56:59], v[36:39], v[104:119]
    buffer_load_dwordx4 v177, s[44:47], s71 offen offset:1024 lds
    ds_read_b64_tr_b16 a[8:9], v182 offset:16384
    ds_read_b64_tr_b16 a[10:11], v182 offset:17408
    v_exp_f32 v17, v17
    v_mul_f32 v76, v76, v84
    v_mfma_f32_32x32x16_bf16 v[120:135], a[60:63], v[36:39], v[120:135]
    ds_read_b64_tr_b16 a[12:13], v183 offset:16384
    ds_read_b64_tr_b16 a[14:15], v183 offset:17408
    v_mul_f32 v77, v77, v85
    v_add_f32 v16, 1.0, v16
    v_add_f32 v17, 1.0, v17
    v_mul_f32 v18, s72, v78
    s_waitcnt lgkmcnt(12)
    v_mfma_f32_32x32x16_bf16 v[104:119], a[64:67], v[40:43], v[104:119]
    ds_read_b128 v[24:27], v11 offset:16384
    buffer_load_dwordx4 v178, s[44:47], s71 offen offset:2048 lds
    ds_read_b64_tr_b16 a[16:17], v180 offset:20480
    v_rcp_f32 v16, v16
    v_mul_f32 v19, s72, v79
    v_mfma_f32_32x32x16_bf16 v[120:135], a[68:71], v[40:43], v[120:135]
    ds_read_b128 v[28:31], v12 offset:16384
    ds_read_b64_tr_b16 a[18:19], v180 offset:21504
    v_rcp_f32 v17, v17
    v_mul_f32 v76, v76, v16
    v_mul_f32 v78, v78, v86
    v_mfma_f32_32x32x16_bf16 v[104:119], a[72:75], v[44:47], v[104:119]
    buffer_load_dwordx4 v179, s[44:47], s71 offen offset:3072 lds
    ds_read_b64_tr_b16 a[20:21], v181 offset:20480
    ds_read_b64_tr_b16 a[22:23], v181 offset:21504
    v_mul_f32 v77, v77, v17
    v_cvt_pk_bf16_f32 v74, v76, v77
    v_mul_f32 v79, v79, v87
    v_mfma_f32_32x32x16_bf16 v[120:135], a[76:79], v[44:47], v[120:135]
    s_waitcnt lgkmcnt(6)
    s_add_u32 m0, s79, 16384
    s_add_u32 s77, s77, 229376
    ds_read_b128 v[32:35], v13 offset:16384
    ds_read_b64_tr_b16 a[24:25], v182 offset:20480
    v_exp_f32 v18, v18
    v_mfma_f32_32x32x16_bf16 v[104:119], a[80:83], v[48:51], v[104:119]
    s_cmp_eq_u32 s77, 1605632
    s_cselect_b32 s77, 0, s77
    s_add_u32 s71, s77, s14
    buffer_load_dwordx4 v176, s[44:47], s71 offen offset:0 lds
    ds_read_b64_tr_b16 a[26:27], v182 offset:21504
    ds_read_b64_tr_b16 a[28:29], v183 offset:20480
    v_add_f32 v18, 1.0, v18
    v_mfma_f32_32x32x16_bf16 v[120:135], a[84:87], v[48:51], v[120:135]
    ds_read_b128 v[36:39], v14 offset:16384
    ds_read_b64_tr_b16 a[30:31], v183 offset:21504
    v_exp_f32 v19, v19
    v_rcp_f32 v18, v18
    v_mfma_f32_32x32x16_bf16 v[104:119], a[88:91], v[52:55], v[104:119]
    buffer_load_dwordx4 v177, s[44:47], s71 offen offset:1024 lds
    ds_read_b64_tr_b16 a[32:33], v180 offset:0
    ds_read_b64_tr_b16 a[34:35], v180 offset:1024
    v_add_f32 v19, 1.0, v19
    v_rcp_f32 v19, v19
    v_mfma_f32_32x32x16_bf16 v[120:135], a[92:95], v[52:55], v[120:135]
    ds_read_b64_tr_b16 a[36:37], v181 offset:0
    ds_read_b64_tr_b16 a[38:39], v181 offset:1024
    v_mul_f32 v78, v78, v18
    v_mul_f32 v79, v79, v19
    v_cvt_pk_bf16_f32 v75, v78, v79
    v_mul_f32 v16, s72, v88
    v_mfma_f32_32x32x16_bf16 v[104:119], a[96:99], v[56:59], v[104:119]
    ds_read_b128 v[40:43], v11 offset:20480
    buffer_load_dwordx4 v178, s[44:47], s71 offen offset:2048 lds
    ds_read_b64_tr_b16 a[40:41], v182 offset:0
    v_mul_f32 v17, s72, v89
    v_exp_f32 v16, v16
    v_mfma_f32_32x32x16_bf16 v[120:135], a[100:103], v[56:59], v[120:135]
    ds_read_b128 v[44:47], v12 offset:20480
    ds_read_b64_tr_b16 a[42:43], v182 offset:1024
    buffer_store_dwordx4 v[72:75], v21, s[36:39], s73 offen offset:0 sc1
    v_exp_f32 v17, v17
    v_mul_f32 v88, v88, v96
    v_mfma_f32_32x32x16_bf16 v[104:119], a[104:107], v[60:63], v[104:119]
    buffer_load_dwordx4 v179, s[44:47], s71 offen offset:3072 lds
    ds_read_b64_tr_b16 a[44:45], v183 offset:0
    ds_read_b64_tr_b16 a[46:47], v183 offset:1024
    v_mul_f32 v89, v89, v97
    v_add_f32 v16, 1.0, v16
    v_add_f32 v17, 1.0, v17
    v_mfma_f32_32x32x16_bf16 v[120:135], a[108:111], v[60:63], v[120:135]
    s_add_u32 m0, s69, 147456
    s_add_u32 s71, s77, s15
    s_waitcnt vmcnt(18)
    ds_read_b128 v[48:51], v13 offset:20480
    ds_read_b64_tr_b16 a[48:49], v180 offset:4096
    v_rcp_f32 v16, v16
    v_mfma_f32_32x32x16_bf16 v[104:119], a[112:115], v[64:67], v[104:119]
    buffer_load_dwordx4 v176, s[44:47], s71 offen offset:0 lds
    ds_read_b64_tr_b16 a[50:51], v180 offset:5120
    ds_read_b64_tr_b16 a[52:53], v181 offset:4096
    v_rcp_f32 v17, v17
    v_mul_f32 v88, v88, v16
    v_mfma_f32_32x32x16_bf16 v[120:135], a[116:119], v[64:67], v[120:135]
    ds_read_b128 v[52:55], v14 offset:20480
    ds_read_b64_tr_b16 a[54:55], v181 offset:5120
    v_mul_f32 v89, v89, v17
    v_cvt_pk_bf16_f32 v88, v88, v89
    v_mul_f32 v18, s72, v90
    v_mul_f32 v19, s72, v91
    v_mfma_f32_32x32x16_bf16 v[104:119], a[120:123], v[68:71], v[104:119]
    buffer_load_dwordx4 v177, s[44:47], s71 offen offset:1024 lds
    ds_read_b64_tr_b16 a[56:57], v182 offset:4096
    ds_read_b64_tr_b16 a[58:59], v182 offset:5120
    v_exp_f32 v18, v18
    v_mul_f32 v90, v90, v98
    v_mfma_f32_32x32x16_bf16 v[120:135], a[124:127], v[68:71], v[120:135]
    ds_read_b64_tr_b16 a[60:61], v183 offset:4096
    ds_read_b64_tr_b16 a[62:63], v183 offset:5120
    v_exp_f32 v19, v19
    v_mul_f32 v91, v91, v99
    v_add_f32 v18, 1.0, v18
    s_waitcnt lgkmcnt(15)
    v_mfma_f32_32x32x16_bf16 v[104:119], a[128:131], v[24:27], v[104:119]
    s_waitcnt vmcnt(16)
    ds_read_b128 v[56:59], v11 offset:24576
    buffer_load_dwordx4 v178, s[44:47], s71 offen offset:2048 lds
    ds_read_b64_tr_b16 a[64:65], v180 offset:8192
    v_add_f32 v19, 1.0, v19
    v_rcp_f32 v18, v18
    v_mfma_f32_32x32x16_bf16 v[120:135], a[132:135], v[24:27], v[120:135]
    ds_read_b128 v[60:63], v12 offset:24576
    ds_read_b64_tr_b16 a[66:67], v180 offset:9216
    v_rcp_f32 v19, v19
    v_mul_f32 v90, v90, v18
    v_mul_f32 v16, s72, v92
    v_mfma_f32_32x32x16_bf16 v[104:119], a[136:139], v[28:31], v[104:119]
    buffer_load_dwordx4 v179, s[44:47], s71 offen offset:3072 lds
    ds_read_b64_tr_b16 a[68:69], v181 offset:8192
    ds_read_b64_tr_b16 a[70:71], v181 offset:9216
    v_mul_f32 v91, v91, v19
    v_cvt_pk_bf16_f32 v89, v90, v91
    v_mul_f32 v17, s72, v93
    v_mfma_f32_32x32x16_bf16 v[120:135], a[140:143], v[28:31], v[120:135]
    s_add_u32 m0, s79, 20480
    s_add_u32 s77, s77, 229376
    ds_read_b128 v[64:67], v13 offset:24576
    ds_read_b64_tr_b16 a[72:73], v182 offset:8192
    v_exp_f32 v16, v16
    v_mfma_f32_32x32x16_bf16 v[104:119], a[144:147], v[32:35], v[104:119]
    s_cmp_eq_u32 s77, 1605632
    s_cselect_b32 s77, 0, s77
    s_add_u32 s71, s77, s15
    buffer_load_dwordx4 v176, s[44:47], s71 offen offset:0 lds
    ds_read_b64_tr_b16 a[74:75], v182 offset:9216
    ds_read_b64_tr_b16 a[76:77], v183 offset:8192
    v_mul_f32 v92, v92, v100
    v_mfma_f32_32x32x16_bf16 v[120:135], a[148:151], v[32:35], v[120:135]
    ds_read_b128 v[68:71], v14 offset:24576
    ds_read_b64_tr_b16 a[78:79], v183 offset:9216
    v_exp_f32 v17, v17
    v_mul_f32 v93, v93, v101
    v_add_f32 v16, 1.0, v16
    v_mfma_f32_32x32x16_bf16 v[104:119], a[152:155], v[36:39], v[104:119]
    s_waitcnt vmcnt(14)
    buffer_load_dwordx4 v177, s[44:47], s71 offen offset:1024 lds
    ds_read_b64_tr_b16 a[80:81], v180 offset:12288
    ds_read_b64_tr_b16 a[82:83], v180 offset:13312
    v_add_f32 v17, 1.0, v17
    v_rcp_f32 v16, v16
    v_mfma_f32_32x32x16_bf16 v[120:135], a[156:159], v[36:39], v[120:135]
    ds_read_b64_tr_b16 a[84:85], v181 offset:12288
    ds_read_b64_tr_b16 a[86:87], v181 offset:13312
    v_rcp_f32 v17, v17
    v_mul_f32 v92, v92, v16
    v_mul_f32 v18, s72, v94
    s_waitcnt lgkmcnt(15)
    v_mfma_f32_32x32x16_bf16 v[104:119], a[160:163], v[40:43], v[104:119]
    buffer_load_dwordx4 v178, s[44:47], s71 offen offset:2048 lds
    ds_read_b64_tr_b16 a[88:89], v182 offset:12288
    ds_read_b64_tr_b16 a[90:91], v182 offset:13312
    v_mul_f32 v93, v93, v17
    v_cvt_pk_bf16_f32 v90, v92, v93
    v_mul_f32 v19, s72, v95
    v_mfma_f32_32x32x16_bf16 v[120:135], a[164:167], v[40:43], v[120:135]
    ds_read_b64_tr_b16 a[92:93], v183 offset:12288
    ds_read_b64_tr_b16 a[94:95], v183 offset:13312
    v_exp_f32 v18, v18
    v_exp_f32 v19, v19
    v_mfma_f32_32x32x16_bf16 v[104:119], a[168:171], v[44:47], v[104:119]
    buffer_load_dwordx4 v179, s[44:47], s71 offen offset:3072 lds
    v_mul_f32 v94, v94, v102
    v_mul_f32 v95, v95, v103
    v_add_f32 v18, 1.0, v18
    v_add_f32 v19, 1.0, v19
    v_mfma_f32_32x32x16_bf16 v[120:135], a[172:175], v[44:47], v[120:135]
    s_add_u32 m0, s79, 0
    s_add_u32 s77, s77, 229376
    v_rcp_f32 v18, v18
    v_rcp_f32 v19, v19
    v_mfma_f32_32x32x16_bf16 v[104:119], a[176:179], v[48:51], v[104:119]
    s_cmp_eq_u32 s77, 1605632
    s_cselect_b32 s77, 0, s77
    s_add_u32 s71, s77, s15
    buffer_load_dwordx4 v176, s[44:47], s71 offen offset:0 lds
    v_mul_f32 v94, v94, v18
    v_mul_f32 v95, v95, v19
    v_cvt_pk_bf16_f32 v91, v94, v95
    v_mfma_f32_32x32x16_bf16 v[120:135], a[180:183], v[48:51], v[120:135]
    buffer_store_dwordx4 v[88:91], v21, s[36:39], s73 offen offset:512 sc1
    v_mfma_f32_32x32x16_bf16 v[104:119], a[184:187], v[52:55], v[104:119]
    s_add_u32 s73, s73, s67
    buffer_load_dwordx4 v177, s[44:47], s71 offen offset:1024 lds
    v_mfma_f32_32x32x16_bf16 v[120:135], a[188:191], v[52:55], v[120:135]
    s_waitcnt lgkmcnt(9)
    v_mfma_f32_32x32x16_bf16 v[104:119], a[192:195], v[56:59], v[104:119]
    buffer_load_dwordx4 v178, s[44:47], s71 offen offset:2048 lds
    v_mfma_f32_32x32x16_bf16 v[120:135], a[196:199], v[56:59], v[120:135]
    v_mfma_f32_32x32x16_bf16 v[104:119], a[200:203], v[60:63], v[104:119]
    buffer_load_dwordx4 v179, s[44:47], s71 offen offset:3072 lds
    v_mfma_f32_32x32x16_bf16 v[120:135], a[204:207], v[60:63], v[120:135]
    s_add_u32 m0, s79, 4096
    s_add_u32 s77, s77, 229376
    v_mfma_f32_32x32x16_bf16 v[104:119], a[208:211], v[64:67], v[104:119]
    s_cmp_eq_u32 s77, 1605632
    s_cselect_b32 s77, 0, s77
    s_add_u32 s71, s77, s15
    buffer_load_dwordx4 v176, s[44:47], s71 offen offset:0 lds
    v_mfma_f32_32x32x16_bf16 v[120:135], a[212:215], v[64:67], v[120:135]
    v_mfma_f32_32x32x16_bf16 v[104:119], a[216:219], v[68:71], v[104:119]
    buffer_load_dwordx4 v177, s[44:47], s71 offen offset:1024 lds
    v_mfma_f32_32x32x16_bf16 v[120:135], a[220:223], v[68:71], v[120:135]
    buffer_load_dword v6, off, s[52:55], s94 sc1
    s_nop 9
    v_pk_mul_f32 v[16:17], s[72:73], v[104:105] op_sel:[0,0] op_sel_hi:[0,1]
    v_exp_f32 v16, v16
    v_exp_f32 v17, v17
    v_pk_mul_f32 v[104:105], v[104:105], v[112:113] op_sel:[0,0] op_sel_hi:[1,1]
    v_pk_add_f32 v[16:17], 1.0, v[16:17] op_sel:[0,0] op_sel_hi:[0,1]
    v_rcp_f32 v16, v16
    v_rcp_f32 v17, v17
    v_pk_mul_f32 v[18:19], s[72:73], v[106:107] op_sel:[0,0] op_sel_hi:[0,1]
    v_pk_mul_f32 v[104:105], v[104:105], v[16:17] op_sel:[0,0] op_sel_hi:[1,1]
    v_cvt_pk_bf16_f32 v104, v104, v105
    v_exp_f32 v18, v18
    v_exp_f32 v19, v19
    v_pk_mul_f32 v[106:107], v[106:107], v[114:115] op_sel:[0,0] op_sel_hi:[1,1]
    v_pk_add_f32 v[18:19], 1.0, v[18:19] op_sel:[0,0] op_sel_hi:[0,1]
    v_rcp_f32 v18, v18
    v_rcp_f32 v19, v19
    v_pk_mul_f32 v[16:17], s[72:73], v[108:109] op_sel:[0,0] op_sel_hi:[0,1]
    v_pk_mul_f32 v[106:107], v[106:107], v[18:19] op_sel:[0,0] op_sel_hi:[1,1]
    v_cvt_pk_bf16_f32 v105, v106, v107
    v_exp_f32 v16, v16
    v_exp_f32 v17, v17
    v_pk_mul_f32 v[108:109], v[108:109], v[116:117] op_sel:[0,0] op_sel_hi:[1,1]
    v_pk_add_f32 v[16:17], 1.0, v[16:17] op_sel:[0,0] op_sel_hi:[0,1]
    v_rcp_f32 v16, v16
    v_rcp_f32 v17, v17
    v_pk_mul_f32 v[18:19], s[72:73], v[110:111] op_sel:[0,0] op_sel_hi:[0,1]
    v_pk_mul_f32 v[108:109], v[108:109], v[16:17] op_sel:[0,0] op_sel_hi:[1,1]
    v_cvt_pk_bf16_f32 v106, v108, v109
    v_exp_f32 v18, v18
    v_exp_f32 v19, v19
    v_pk_mul_f32 v[110:111], v[110:111], v[118:119] op_sel:[0,0] op_sel_hi:[1,1]
    v_pk_add_f32 v[18:19], 1.0, v[18:19] op_sel:[0,0] op_sel_hi:[0,1]
    v_rcp_f32 v18, v18
    v_rcp_f32 v19, v19
    s_nop 0
    v_pk_mul_f32 v[110:111], v[110:111], v[18:19] op_sel:[0,0] op_sel_hi:[1,1]
    v_cvt_pk_bf16_f32 v107, v110, v111
    buffer_store_dwordx4 v[104:107], v21, s[36:39], s73 offen offset:0 sc1
    v_pk_mul_f32 v[16:17], s[72:73], v[120:121] op_sel:[0,0] op_sel_hi:[0,1]
    v_exp_f32 v16, v16
    v_exp_f32 v17, v17
    v_pk_mul_f32 v[120:121], v[120:121], v[128:129] op_sel:[0,0] op_sel_hi:[1,1]
    v_pk_add_f32 v[16:17], 1.0, v[16:17] op_sel:[0,0] op_sel_hi:[0,1]
    v_rcp_f32 v16, v16
    v_rcp_f32 v17, v17
    v_pk_mul_f32 v[18:19], s[72:73], v[122:123] op_sel:[0,0] op_sel_hi:[0,1]
    v_pk_mul_f32 v[120:121], v[120:121], v[16:17] op_sel:[0,0] op_sel_hi:[1,1]
    v_cvt_pk_bf16_f32 v120, v120, v121
    v_exp_f32 v18, v18
    v_exp_f32 v19, v19
    v_pk_mul_f32 v[122:123], v[122:123], v[130:131] op_sel:[0,0] op_sel_hi:[1,1]
    v_pk_add_f32 v[18:19], 1.0, v[18:19] op_sel:[0,0] op_sel_hi:[0,1]
    v_rcp_f32 v18, v18
    v_rcp_f32 v19, v19
    v_pk_mul_f32 v[16:17], s[72:73], v[124:125] op_sel:[0,0] op_sel_hi:[0,1]
    v_pk_mul_f32 v[122:123], v[122:123], v[18:19] op_sel:[0,0] op_sel_hi:[1,1]
    v_cvt_pk_bf16_f32 v121, v122, v123
    v_exp_f32 v16, v16
    v_exp_f32 v17, v17
    v_pk_mul_f32 v[124:125], v[124:125], v[132:133] op_sel:[0,0] op_sel_hi:[1,1]
    v_pk_add_f32 v[16:17], 1.0, v[16:17] op_sel:[0,0] op_sel_hi:[0,1]
    v_rcp_f32 v16, v16
    v_rcp_f32 v17, v17
    v_pk_mul_f32 v[18:19], s[72:73], v[126:127] op_sel:[0,0] op_sel_hi:[0,1]
    v_pk_mul_f32 v[124:125], v[124:125], v[16:17] op_sel:[0,0] op_sel_hi:[1,1]
    v_cvt_pk_bf16_f32 v122, v124, v125
    v_exp_f32 v18, v18
    v_exp_f32 v19, v19
    v_pk_mul_f32 v[126:127], v[126:127], v[134:135] op_sel:[0,0] op_sel_hi:[1,1]
    v_pk_add_f32 v[18:19], 1.0, v[18:19] op_sel:[0,0] op_sel_hi:[0,1]
    v_rcp_f32 v18, v18
    v_rcp_f32 v19, v19
    s_nop 0
    v_pk_mul_f32 v[126:127], v[126:127], v[18:19] op_sel:[0,0] op_sel_hi:[1,1]
    v_cvt_pk_bf16_f32 v123, v126, v127
    buffer_store_dwordx4 v[120:123], v21, s[36:39], s73 offen offset:512 sc1
    buffer_load_dwordx4 v178, s[44:47], s71 offen offset:2048 lds
    buffer_load_dwordx4 v179, s[44:47], s71 offen offset:3072 lds
    s_waitcnt lgkmcnt(8)
    s_add_u32 m0, s79, 8192
    s_add_u32 s77, s77, 229376
    s_cmp_eq_u32 s77, 1605632
    s_cselect_b32 s77, 0, s77
    s_add_u32 s71, s77, s15
    buffer_load_dwordx4 v176, s[44:47], s71 offen offset:0 lds
    buffer_load_dwordx4 v177, s[44:47], s71 offen offset:1024 lds
    buffer_load_dwordx4 v178, s[44:47], s71 offen offset:2048 lds
    buffer_load_dwordx4 v179, s[44:47], s71 offen offset:3072 lds
    s_waitcnt lgkmcnt(0)
    s_add_u32 m0, s79, 12288
    s_add_u32 s77, s77, 229376
    s_cmp_eq_u32 s77, 1605632
    s_cselect_b32 s77, 0, s77
    s_add_u32 s71, s77, s15
    buffer_load_dwordx4 v176, s[44:47], s71 offen offset:0 lds
    buffer_load_dwordx4 v177, s[44:47], s71 offen offset:1024 lds
    buffer_load_dwordx4 v178, s[44:47], s71 offen offset:2048 lds
    buffer_load_dwordx4 v179, s[44:47], s71 offen offset:3072 lds
    s_waitcnt vmcnt(12)
    v_cmp_gt_u32 vcc, 7, v6
    s_mov_b32 s9, 0x100000
    s_cbranch_vccnz L_poll_e
L_got_e:
    s_add_u32 s65, s78, s18
    buffer_load_dwordx4 v[216:219], v15, s[36:39], s65 offen sc1
    s_add_u32 s65, s65, 74752
    buffer_load_dwordx4 v[220:223], v15, s[36:39], s65 offen sc1
    s_add_u32 s65, s65, 74752
    buffer_load_dwordx4 v[224:227], v15, s[36:39], s65 offen sc1
    s_add_u32 s65, s65, 74752
    buffer_load_dwordx4 v[228:231], v15, s[36:39], s65 offen sc1
    s_add_u32 s65, s65, 74752
    buffer_load_dwordx4 v[232:235], v15, s[36:39], s65 offen sc1
    s_waitcnt vmcnt(15)
    s_mov_b64 exec, 1
    buffer_atomic_add v7, off, s[52:55], s27 sc1
    s_mov_b64 exec, -1
    s_add_u32 s94, s94, 13312
    s_add_u32 s78, s78, 8192
    s_cmp_eq_u32 s78, 57344
    s_cselect_b32 s78, 0, s78
    s_add_u32 s65, s78, s18
    buffer_load_dwordx4 v[236:239], v15, s[36:39], s65 offen sc1
    s_add_u32 s65, s65, 74752
    buffer_load_dwordx4 v[240:243], v15, s[36:39], s65 offen sc1
    s_add_u32 s65, s65, 74752
    buffer_load_dwordx4 v[244:247], v15, s[36:39], s65 offen sc1
    s_add_u32 s65, s65, 74752
    buffer_load_dwordx4 v[248:251], v15, s[36:39], s65 offen sc1
    s_add_u32 s65, s65, 74752
    buffer_load_dwordx4 v[252:255], v15, s[36:39], s65 offen sc1
    s_add_u32 s78, s78, 8192
    s_cmp_eq_u32 s78, 57344
    s_cselect_b32 s78, 0, s78
    s_add_u32 s65, s78, s18
    buffer_load_dwordx4 v[96:99], v15, s[36:39], s65 offen sc1
    s_add_u32 s65, s65, 74752
    buffer_load_dwordx4 v[100:103], v15, s[36:39], s65 offen sc1
    s_add_u32 s65, s65, 74752
    buffer_load_dwordx4 v[104:107], v15, s[36:39], s65 offen sc1
    s_add_u32 s65, s65, 74752
    buffer_load_dwordx4 v[108:111], v15, s[36:39], s65 offen sc1
    s_add_u32 s65, s65, 74752
    buffer_load_dwordx4 v[112:115], v15, s[36:39], s65 offen sc1
    s_add_u32 s78, s78, 8192
    s_cmp_eq_u32 s78, 57344
    s_cselect_b32 s78, 0, s78
    s_add_u32 s65, s78, s18
    buffer_load_dwordx4 v[116:119], v15, s[36:39], s65 offen sc1
    ds_read_b64_tr_b16 a[96:97], v180 offset:16384
    ds_read_b64_tr_b16 a[98:99], v180 offset:17408
    ds_read_b64_tr_b16 a[100:101], v181 offset:16384
    ds_read_b64_tr_b16 a[102:103], v181 offset:17408
    ds_read_b64_tr_b16 a[104:105], v182 offset:16384
    ds_read_b64_tr_b16 a[106:107], v182 offset:17408
    ds_read_b64_tr_b16 a[108:109], v183 offset:16384
    ds_read_b64_tr_b16 a[110:111], v183 offset:17408
    ds_read_b64_tr_b16 a[112:113], v180 offset:20480
    ds_read_b64_tr_b16 a[114:115], v180 offset:21504
    ds_read_b64_tr_b16 a[116:117], v181 offset:20480
    ds_read_b64_tr_b16 a[118:119], v181 offset:21504
    ds_read_b64_tr_b16 a[120:121], v182 offset:20480
    ds_read_b64_tr_b16 a[122:123], v182 offset:21504
    ds_read_b64_tr_b16 a[124:125], v183 offset:20480
    ds_read_b64_tr_b16 a[126:127], v183 offset:21504
    s_waitcnt vmcnt(16)
    v_mfma_f32_16x16x32_bf16 v[16:19], a[0:3], v[216:219], 0
    s_add_u32 s65, s65, 74752
    buffer_load_dwordx4 v[120:123], v15, s[36:39], s65 offen sc1
    v_mfma_f32_16x16x32_bf16 v[20:23], a[4:7], v[216:219], 0
    ds_read_b64_tr_b16 a[128:129], v180 offset:0
    v_mfma_f32_16x16x32_bf16 v[24:27], a[8:11], v[216:219], 0
    ds_read_b64_tr_b16 a[130:131], v180 offset:1024
    v_mfma_f32_16x16x32_bf16 v[28:31], a[12:15], v[216:219], 0
    ds_read_b64_tr_b16 a[132:133], v181 offset:0
    s_waitcnt vmcnt(16)
    v_mfma_f32_16x16x32_bf16 v[44:47], a[12:15], v[220:223], 0
    s_add_u32 s65, s65, 74752
    buffer_load_dwordx4 v[124:127], v15, s[36:39], s65 offen sc1
    ds_read_b64_tr_b16 a[134:135], v181 offset:1024
    v_mfma_f32_16x16x32_bf16 v[40:43], a[8:11], v[220:223], 0
    ds_read_b64_tr_b16 a[136:137], v182 offset:0
    v_mfma_f32_16x16x32_bf16 v[36:39], a[4:7], v[220:223], 0
    ds_read_b64_tr_b16 a[138:139], v182 offset:1024
    v_mfma_f32_16x16x32_bf16 v[32:35], a[0:3], v[220:223], 0
    ds_read_b64_tr_b16 a[140:141], v183 offset:0
    s_waitcnt vmcnt(16)
    v_mfma_f32_16x16x32_bf16 v[48:51], a[0:3], v[224:227], 0
    s_add_u32 s65, s65, 74752
    buffer_load_dwordx4 v[128:131], v15, s[36:39], s65 offen sc1
    ds_read_b64_tr_b16 a[142:143], v183 offset:1024
    v_mfma_f32_16x16x32_bf16 v[52:55], a[4:7], v[224:227], 0
    v_mfma_f32_16x16x32_bf16 v[56:59], a[8:11], v[224:227], 0
    v_mfma_f32_16x16x32_bf16 v[60:63], a[12:15], v[224:227], 0
    s_waitcnt vmcnt(16)
    v_mfma_f32_16x16x32_bf16 v[76:79], a[12:15], v[228:231], 0
    s_add_u32 s65, s65, 74752
    buffer_load_dwordx4 v[132:135], v15, s[36:39], s65 offen sc1
    v_mfma_f32_16x16x32_bf16 v[72:75], a[8:11], v[228:231], 0
    v_mfma_f32_16x16x32_bf16 v[68:71], a[4:7], v[228:231], 0
    v_mfma_f32_16x16x32_bf16 v[64:67], a[0:3], v[228:231], 0
    s_waitcnt vmcnt(16)
    v_mfma_f32_16x16x32_bf16 v[80:83], a[0:3], v[232:235], 0
    s_add_u32 s78, s78, 8192
    v_mfma_f32_16x16x32_bf16 v[84:87], a[4:7], v[232:235], 0
    s_cmp_eq_u32 s78, 57344
    s_cselect_b32 s78, 0, s78
    v_mfma_f32_16x16x32_bf16 v[88:91], a[8:11], v[232:235], 0
    s_add_u32 s65, s78, s18
    buffer_load_dwordx4 v[136:139], v15, s[36:39], s65 offen sc1
    v_mfma_f32_16x16x32_bf16 v[92:95], a[12:15], v[232:235], 0
    s_waitcnt vmcnt(15)
    v_mfma_f32_16x16x32_bf16 v[16:19], a[16:19], v[236:239], v[16:19]
    s_add_u32 s65, s65, 74752
    buffer_load_dwordx4 v[140:143], v15, s[36:39], s65 offen sc1
    v_mfma_f32_16x16x32_bf16 v[20:23], a[20:23], v[236:239], v[20:23]
    ds_read_b64_tr_b16 a[144:145], v180 offset:4096
    v_mfma_f32_16x16x32_bf16 v[24:27], a[24:27], v[236:239], v[24:27]
    ds_read_b64_tr_b16 a[146:147], v180 offset:5120
    v_mfma_f32_16x16x32_bf16 v[28:31], a[28:31], v[236:239], v[28:31]
    ds_read_b64_tr_b16 a[148:149], v181 offset:4096
    s_waitcnt vmcnt(15)
    v_mfma_f32_16x16x32_bf16 v[44:47], a[28:31], v[240:243], v[44:47]
    s_add_u32 s65, s65, 74752
    buffer_load_dwordx4 v[144:147], v15, s[36:39], s65 offen sc1
    ds_read_b64_tr_b16 a[150:151], v181 offset:5120
    v_mfma_f32_16x16x32_bf16 v[40:43], a[24:27], v[240:243], v[40:43]
    ds_read_b64_tr_b16 a[152:153], v182 offset:4096
    v_mfma_f32_16x16x32_bf16 v[36:39], a[20:23], v[240:243], v[36:39]
    ds_read_b64_tr_b16 a[154:155], v182 offset:5120
    v_mfma_f32_16x16x32_bf16 v[32:35], a[16:19], v[240:243], v[32:35]
    ds_read_b64_tr_b16 a[156:157], v183 offset:4096
    s_waitcnt vmcnt(15)
    v_mfma_f32_16x16x32_bf16 v[48:51], a[16:19], v[244:247], v[48:51]
    s_add_u32 s65, s65, 74752
    buffer_load_dwordx4 v[148:151], v15, s[36:39], s65 offen sc1
    ds_read_b64_tr_b16 a[158:159], v183 offset:5120
    v_mfma_f32_16x16x32_bf16 v[52:55], a[20:23], v[244:247], v[52:55]
    v_mfma_f32_16x16x32_bf16 v[56:59], a[24:27], v[244:247], v[56:59]
    v_mfma_f32_16x16x32_bf16 v[60:63], a[28:31], v[244:247], v[60:63]
    s_waitcnt vmcnt(15)
    v_mfma_f32_16x16x32_bf16 v[76:79], a[28:31], v[248:251], v[76:79]
    s_add_u32 s65, s65, 74752
    buffer_load_dwordx4 v[152:155], v15, s[36:39], s65 offen sc1
    v_mfma_f32_16x16x32_bf16 v[72:75], a[24:27], v[248:251], v[72:75]
    v_mfma_f32_16x16x32_bf16 v[68:71], a[20:23], v[248:251], v[68:71]
    v_mfma_f32_16x16x32_bf16 v[64:67], a[16:19], v[248:251], v[64:67]
    s_waitcnt vmcnt(15)
    v_mfma_f32_16x16x32_bf16 v[80:83], a[16:19], v[252:255], v[80:83]
    s_add_u32 s78, s78, 8192
    v_mfma_f32_16x16x32_bf16 v[84:87], a[20:23], v[252:255], v[84:87]
    s_cmp_eq_u32 s78, 57344
    s_cselect_b32 s78, 0, s78
    v_mfma_f32_16x16x32_bf16 v[88:91], a[24:27], v[252:255], v[88:91]
    s_add_u32 s65, s78, s18
    buffer_load_dwordx4 v[156:159], v15, s[36:39], s65 offen sc1
    v_mfma_f32_16x16x32_bf16 v[92:95], a[28:31], v[252:255], v[92:95]
    s_waitcnt vmcnt(15)
    v_mfma_f32_16x16x32_bf16 v[16:19], a[32:35], v[96:99], v[16:19]
    s_add_u32 s65, s65, 74752
    buffer_load_dwordx4 v[160:163], v15, s[36:39], s65 offen sc1
    v_mfma_f32_16x16x32_bf16 v[20:23], a[36:39], v[96:99], v[20:23]
    ds_read_b64_tr_b16 a[160:161], v180 offset:8192
    v_mfma_f32_16x16x32_bf16 v[24:27], a[40:43], v[96:99], v[24:27]
    ds_read_b64_tr_b16 a[162:163], v180 offset:9216
    v_mfma_f32_16x16x32_bf16 v[28:31], a[44:47], v[96:99], v[28:31]
    ds_read_b64_tr_b16 a[164:165], v181 offset:8192
    s_waitcnt vmcnt(15)
    v_mfma_f32_16x16x32_bf16 v[44:47], a[44:47], v[100:103], v[44:47]
    s_add_u32 s65, s65, 74752
    buffer_load_dwordx4 v[164:167], v15, s[36:39], s65 offen sc1
    ds_read_b64_tr_b16 a[166:167], v181 offset:9216
    v_mfma_f32_16x16x32_bf16 v[40:43], a[40:43], v[100:103], v[40:43]
    ds_read_b64_tr_b16 a[168:169], v182 offset:8192
    v_mfma_f32_16x16x32_bf16 v[36:39], a[36:39], v[100:103], v[36:39]
    ds_read_b64_tr_b16 a[170:171], v182 offset:9216
    v_mfma_f32_16x16x32_bf16 v[32:35], a[32:35], v[100:103], v[32:35]
    ds_read_b64_tr_b16 a[172:173], v183 offset:8192
    s_waitcnt vmcnt(15)
    v_mfma_f32_16x16x32_bf16 v[48:51], a[32:35], v[104:107], v[48:51]
    s_add_u32 s65, s65, 74752
    buffer_load_dwordx4 v[168:171], v15, s[36:39], s65 offen sc1
    ds_read_b64_tr_b16 a[174:175], v183 offset:9216
    v_mfma_f32_16x16x32_bf16 v[52:55], a[36:39], v[104:107], v[52:55]
    v_mfma_f32_16x16x32_bf16 v[56:59], a[40:43], v[104:107], v[56:59]
    v_mfma_f32_16x16x32_bf16 v[60:63], a[44:47], v[104:107], v[60:63]
    s_waitcnt vmcnt(15)
    v_mfma_f32_16x16x32_bf16 v[76:79], a[44:47], v[108:111], v[76:79]
    s_add_u32 s65, s65, 74752
    buffer_load_dwordx4 v[172:175], v15, s[36:39], s65 offen sc1
    v_mfma_f32_16x16x32_bf16 v[72:75], a[40:43], v[108:111], v[72:75]
    v_mfma_f32_16x16x32_bf16 v[68:71], a[36:39], v[108:111], v[68:71]
    v_mfma_f32_16x16x32_bf16 v[64:67], a[32:35], v[108:111], v[64:67]
    s_waitcnt vmcnt(15)
    v_mfma_f32_16x16x32_bf16 v[80:83], a[32:35], v[112:115], v[80:83]
    buffer_load_dword v6, off, s[52:55], s94 sc1
    v_mfma_f32_16x16x32_bf16 v[84:87], a[36:39], v[112:115], v[84:87]
    s_add_u32 s78, s78, 8192
    v_mfma_f32_16x16x32_bf16 v[88:91], a[40:43], v[112:115], v[88:91]
    s_cmp_eq_u32 s78, 57344
    s_cselect_b32 s78, 0, s78
    v_mfma_f32_16x16x32_bf16 v[92:95], a[44:47], v[112:115], v[92:95]
    s_add_u32 s65, s78, s18
    buffer_load_dwordx4 v[216:219], v15, s[36:39], s65 offen sc1
    s_waitcnt vmcnt(16)
    v_mfma_f32_16x16x32_bf16 v[16:19], a[48:51], v[116:119], v[16:19]
    s_add_u32 s65, s65, 74752
    v_mfma_f32_16x16x32_bf16 v[20:23], a[52:55], v[116:119], v[20:23]
    buffer_load_dwordx4 v[220:223], v15, s[36:39], s65 offen sc1
    ds_read_b64_tr_b16 a[176:177], v180 offset:12288
    v_mfma_f32_16x16x32_bf16 v[24:27], a[56:59], v[116:119], v[24:27]
    ds_read_b64_tr_b16 a[178:179], v180 offset:13312
    v_mfma_f32_16x16x32_bf16 v[28:31], a[60:63], v[116:119], v[28:31]
    ds_read_b64_tr_b16 a[180:181], v181 offset:12288
    s_waitcnt vmcnt(16)
    v_mfma_f32_16x16x32_bf16 v[44:47], a[60:63], v[120:123], v[44:47]
    s_add_u32 s65, s65, 74752
    buffer_load_dwordx4 v[224:227], v15, s[36:39], s65 offen sc1
    ds_read_b64_tr_b16 a[182:183], v181 offset:13312
    v_mfma_f32_16x16x32_bf16 v[40:43], a[56:59], v[120:123], v[40:43]
    ds_read_b64_tr_b16 a[184:185], v182 offset:12288
    v_mfma_f32_16x16x32_bf16 v[36:39], a[52:55], v[120:123], v[36:39]
    ds_read_b64_tr_b16 a[186:187], v182 offset:13312
    v_mfma_f32_16x16x32_bf16 v[32:35], a[48:51], v[120:123], v[32:35]
    ds_read_b64_tr_b16 a[188:189], v183 offset:12288
    s_waitcnt vmcnt(16)
    v_mfma_f32_16x16x32_bf16 v[48:51], a[48:51], v[124:127], v[48:51]
    s_add_u32 s65, s65, 74752
    buffer_load_dwordx4 v[228:231], v15, s[36:39], s65 offen sc1
    ds_read_b64_tr_b16 a[190:191], v183 offset:13312
    v_mfma_f32_16x16x32_bf16 v[52:55], a[52:55], v[124:127], v[52:55]
    v_mfma_f32_16x16x32_bf16 v[56:59], a[56:59], v[124:127], v[56:59]
    v_mfma_f32_16x16x32_bf16 v[60:63], a[60:63], v[124:127], v[60:63]
    s_waitcnt vmcnt(16)
    v_mfma_f32_16x16x32_bf16 v[76:79], a[60:63], v[128:131], v[76:79]
    s_add_u32 s65, s65, 74752
    buffer_load_dwordx4 v[232:235], v15, s[36:39], s65 offen sc1
    v_mfma_f32_16x16x32_bf16 v[72:75], a[56:59], v[128:131], v[72:75]
    v_mfma_f32_16x16x32_bf16 v[68:71], a[52:55], v[128:131], v[68:71]
    v_mfma_f32_16x16x32_bf16 v[64:67], a[48:51], v[128:131], v[64:67]
    s_waitcnt vmcnt(5)
    v_cmp_gt_u32 vcc, 7, v6
    s_mov_b32 s9, 0x100000
    s_cbranch_vccnz L_poll_l
L_got_l:
    v_mfma_f32_16x16x32_bf16 v[80:83], a[48:51], v[132:135], v[80:83]
    s_add_u32 s78, s78, 8192
    v_mfma_f32_16x16x32_bf16 v[84:87], a[52:55], v[132:135], v[84:87]
    s_cmp_eq_u32 s78, 57344
    s_cselect_b32 s78, 0, s78
    v_mfma_f32_16x16x32_bf16 v[88:91], a[56:59], v[132:135], v[88:91]
    s_add_u32 s65, s78, s19
    buffer_load_dwordx4 v[236:239], v15, s[36:39], s65 offen sc1
    v_mfma_f32_16x16x32_bf16 v[92:95], a[60:63], v[132:135], v[92:95]
    v_mfma_f32_16x16x32_bf16 v[16:19], a[64:67], v[136:139], v[16:19]
    s_add_u32 s65, s65, 74752
    buffer_load_dwordx4 v[240:243], v15, s[36:39], s65 offen sc1
    v_mfma_f32_16x16x32_bf16 v[20:23], a[68:71], v[136:139], v[20:23]
    s_mul_i32 s10, s74, 80
    v_mfma_f32_16x16x32_bf16 v[24:27], a[72:75], v[136:139], v[24:27]
    s_add_u32 s11, s10, 79
    v_mfma_f32_16x16x32_bf16 v[28:31], a[76:79], v[136:139], v[28:31]
    s_lshr_b32 s10, s10, 7
    v_mfma_f32_16x16x32_bf16 v[44:47], a[76:79], v[140:143], v[44:47]
    s_add_u32 s65, s65, 74752
    buffer_load_dwordx4 v[244:247], v15, s[36:39], s65 offen sc1
    v_mfma_f32_16x16x32_bf16 v[40:43], a[72:75], v[140:143], v[40:43]
    s_lshr_b32 s11, s11, 7
    v_mfma_f32_16x16x32_bf16 v[36:39], a[68:71], v[140:143], v[36:39]
    s_min_u32 s11, s11, 15
    v_mfma_f32_16x16x32_bf16 v[32:35], a[64:67], v[140:143], v[32:35]
    s_lshl_b32 s10, s10, 9
    v_mfma_f32_16x16x32_bf16 v[48:51], a[64:67], v[144:147], v[48:51]
    s_add_u32 s65, s65, 74752
    buffer_load_dwordx4 v[248:251], v15, s[36:39], s65 offen sc1
    v_mfma_f32_16x16x32_bf16 v[52:55], a[68:71], v[144:147], v[52:55]
    s_lshl_b32 s11, s11, 9
    v_mov_b32 v14, s11
    v_writelane_b32 v14, s10, 0
    v_mfma_f32_16x16x32_bf16 v[56:59], a[72:75], v[144:147], v[56:59]
    s_lshl_b32 s27, s3, 7
    v_mfma_f32_16x16x32_bf16 v[60:63], a[76:79], v[144:147], v[60:63]
    s_add_u32 s27, s27, 108544
    v_mfma_f32_16x16x32_bf16 v[76:79], a[76:79], v[148:151], v[76:79]
    s_add_u32 s65, s65, 74752
    buffer_load_dwordx4 v[252:255], v15, s[36:39], s65 offen sc1
    v_mfma_f32_16x16x32_bf16 v[72:75], a[72:75], v[148:151], v[72:75]
    s_mul_i32 s10, s3, 15360
    v_mfma_f32_16x16x32_bf16 v[68:71], a[68:71], v[148:151], v[68:71]
    s_add_u32 s10, s10, 98304
    v_add_u32 v4, s10, v15
    v_mfma_f32_16x16x32_bf16 v[64:67], a[64:67], v[148:151], v[64:67]
    s_xor_b32 s10, s3, 1
    v_mfma_f32_16x16x32_bf16 v[80:83], a[64:67], v[152:155], v[80:83]
    s_add_u32 s78, s78, 8192
    v_mfma_f32_16x16x32_bf16 v[84:87], a[68:71], v[152:155], v[84:87]
    s_cmp_eq_u32 s78, 57344
    s_cselect_b32 s78, 0, s78
    v_mfma_f32_16x16x32_bf16 v[88:91], a[72:75], v[152:155], v[88:91]
    s_add_u32 s65, s78, s19
    buffer_load_dwordx4 v[96:99], v15, s[36:39], s65 offen sc1
    v_mfma_f32_16x16x32_bf16 v[92:95], a[76:79], v[152:155], v[92:95]
    s_mul_i32 s10, s10, 15360
    s_add_u32 s10, s10, 98304
    v_add_u32 v1, s10, v15
    s_xor_b32 s10, s3, 2
    s_mul_i32 s10, s10, 15360
    v_mfma_f32_16x16x32_bf16 v[16:19], a[80:83], v[156:159], v[16:19]
    s_add_u32 s65, s65, 74752
    buffer_load_dwordx4 v[100:103], v15, s[36:39], s65 offen sc1
    v_mfma_f32_16x16x32_bf16 v[20:23], a[84:87], v[156:159], v[20:23]
    s_add_u32 s10, s10, 103424
    v_add_u32 v2, s10, v15
    v_mfma_f32_16x16x32_bf16 v[24:27], a[88:91], v[156:159], v[24:27]
    s_xor_b32 s10, s3, 3
    v_mfma_f32_16x16x32_bf16 v[28:31], a[92:95], v[156:159], v[28:31]
    s_mul_i32 s10, s10, 15360
    v_mfma_f32_16x16x32_bf16 v[44:47], a[92:95], v[160:163], v[44:47]
    s_add_u32 s65, s65, 74752
    buffer_load_dwordx4 v[104:107], v15, s[36:39], s65 offen sc1
    v_mfma_f32_16x16x32_bf16 v[40:43], a[88:91], v[160:163], v[40:43]
    s_add_u32 s10, s10, 108544
    v_add_u32 v3, s10, v15
    v_and_b32 v13, 15, v0
    v_mfma_f32_16x16x32_bf16 v[36:39], a[84:87], v[160:163], v[36:39]
    v_lshrrev_b32 v179, 5, v0
    v_mfma_f32_16x16x32_bf16 v[32:35], a[80:83], v[160:163], v[32:35]
    s_lshl_b32 s10, s3, 1
    v_add_u32 v179, s10, v179
    v_and_b32 v8, 7, v0
    v_mfma_f32_16x16x32_bf16 v[48:51], a[80:83], v[164:167], v[48:51]
    s_add_u32 s65, s65, 74752
    buffer_load_dwordx4 v[108:111], v15, s[36:39], s65 offen sc1
    v_xor_b32 v179, v179, v8
    v_mfma_f32_16x16x32_bf16 v[52:55], a[84:87], v[164:167], v[52:55]
    v_lshlrev_b32 v179, 4, v179
    v_lshl_add_u32 v179, v13, 7, v179
    v_mfma_f32_16x16x32_bf16 v[56:59], a[88:91], v[164:167], v[56:59]
    v_bfe_u32 v178, v0, 4, 1
    v_lshl_add_u32 v176, v178, 3, v179
    v_mfma_f32_16x16x32_bf16 v[60:63], a[92:95], v[164:167], v[60:63]
    s_mul_i32 s10, s3, 20
    v_lshrrev_b32 v5, 3, v0
    v_add_u32 v5, s10, v5
    v_mfma_f32_16x16x32_bf16 v[76:79], a[92:95], v[168:171], v[76:79]
    s_add_u32 s65, s65, 74752
    buffer_load_dwordx4 v[112:115], v15, s[36:39], s65 offen sc1
    v_xor_b32 v177, v5, v8
    v_mfma_f32_16x16x32_bf16 v[72:75], a[88:91], v[168:171], v[72:75]
    v_mfma_f32_16x16x32_bf16 v[68:71], a[84:87], v[168:171], v[68:71]
    v_mfma_f32_16x16x32_bf16 v[64:67], a[80:83], v[168:171], v[64:67]
    v_mfma_f32_16x16x32_bf16 v[80:83], a[80:83], v[172:175], v[80:83]
    s_add_u32 s78, s78, 8192
    v_mfma_f32_16x16x32_bf16 v[84:87], a[84:87], v[172:175], v[84:87]
    s_cmp_eq_u32 s78, 57344
    s_cselect_b32 s78, 0, s78
    v_mfma_f32_16x16x32_bf16 v[88:91], a[88:91], v[172:175], v[88:91]
    s_add_u32 s65, s78, s19
    buffer_load_dwordx4 v[116:119], v15, s[36:39], s65 offen sc1
    v_mfma_f32_16x16x32_bf16 v[92:95], a[92:95], v[172:175], v[92:95]
    s_waitcnt vmcnt(15) lgkmcnt(15)
    v_mfma_f32_16x16x32_bf16 v[16:19], a[96:99], v[216:219], v[16:19]
    s_add_u32 s65, s65, 74752
    buffer_load_dwordx4 v[120:123], v15, s[36:39], s65 offen sc1
    v_and_b32 v177, 7, v177
    v_mfma_f32_16x16x32_bf16 v[20:23], a[100:103], v[216:219], v[20:23]
    v_lshlrev_b32 v177, 4, v177
    v_lshl_add_u32 v177, v5, 7, v177
    v_mfma_f32_16x16x32_bf16 v[24:27], a[104:107], v[216:219], v[24:27]
    s_movk_i32 s11, 896
    v_mul_u32_u24 v5, s11, v5
    v_lshl_add_u32 v5, v8, 4, v5
    v_mfma_f32_16x16x32_bf16 v[28:31], a[108:111], v[216:219], v[28:31]
    s_mul_i32 s10, s74, 71680
    s_waitcnt vmcnt(15)
    v_mfma_f32_16x16x32_bf16 v[44:47], a[108:111], v[220:223], v[44:47]
    s_add_u32 s65, s65, 74752
    buffer_load_dwordx4 v[124:127], v15, s[36:39], s65 offen sc1
    v_mfma_f32_16x16x32_bf16 v[40:43], a[104:107], v[220:223], v[40:43]
    s_lshl_b32 s11, s75, 7
    v_mfma_f32_16x16x32_bf16 v[36:39], a[100:103], v[220:223], v[36:39]
    s_add_u32 s10, s10, s11
    v_add_u32 v5, s10, v5
    v_lshlrev_b32 v13, 2, v13
    v_mfma_f32_16x16x32_bf16 v[32:35], a[96:99], v[220:223], v[32:35]
    s_mul_i32 s26, s74, 320
    s_waitcnt vmcnt(15)
    v_mfma_f32_16x16x32_bf16 v[48:51], a[96:99], v[224:227], v[48:51]
    s_add_u32 s65, s65, 74752
    buffer_load_dwordx4 v[128:131], v15, s[36:39], s65 offen sc1
    v_mfma_f32_16x16x32_bf16 v[52:55], a[100:103], v[224:227], v[52:55]
    v_mfma_f32_16x16x32_bf16 v[56:59], a[104:107], v[224:227], v[56:59]
    v_mfma_f32_16x16x32_bf16 v[60:63], a[108:111], v[224:227], v[60:63]
    s_waitcnt vmcnt(15)
    v_mfma_f32_16x16x32_bf16 v[76:79], a[108:111], v[228:231], v[76:79]
    s_add_u32 s65, s65, 74752
    buffer_load_dwordx4 v[132:135], v15, s[36:39], s65 offen sc1
    v_mfma_f32_16x16x32_bf16 v[72:75], a[104:107], v[228:231], v[72:75]
    v_mfma_f32_16x16x32_bf16 v[68:71], a[100:103], v[228:231], v[68:71]
    v_mfma_f32_16x16x32_bf16 v[64:67], a[96:99], v[228:231], v[64:67]
    s_waitcnt vmcnt(15)
    v_mfma_f32_16x16x32_bf16 v[80:83], a[96:99], v[232:235], v[80:83]
    s_add_u32 s78, s78, 8192
    v_mfma_f32_16x16x32_bf16 v[84:87], a[100:103], v[232:235], v[84:87]
    s_cmp_eq_u32 s78, 57344
    s_cselect_b32 s78, 0, s78
    v_mfma_f32_16x16x32_bf16 v[88:91], a[104:107], v[232:235], v[88:91]
    s_add_u32 s65, s78, s19
    buffer_load_dwordx4 v[136:139], v15, s[36:39], s65 offen sc1
    v_mfma_f32_16x16x32_bf16 v[92:95], a[108:111], v[232:235], v[92:95]
    s_waitcnt vmcnt(15)
    v_mfma_f32_16x16x32_bf16 v[16:19], a[112:115], v[236:239], v[16:19]
    s_add_u32 s65, s65, 74752
    buffer_load_dwordx4 v[140:143], v15, s[36:39], s65 offen sc1
    v_mfma_f32_16x16x32_bf16 v[20:23], a[116:119], v[236:239], v[20:23]
    v_mfma_f32_16x16x32_bf16 v[24:27], a[120:123], v[236:239], v[24:27]
    v_mfma_f32_16x16x32_bf16 v[28:31], a[124:127], v[236:239], v[28:31]
    s_waitcnt vmcnt(15)
    v_mfma_f32_16x16x32_bf16 v[44:47], a[124:127], v[240:243], v[44:47]
    s_add_u32 s65, s65, 74752
    buffer_load_dwordx4 v[144:147], v15, s[36:39], s65 offen sc1
    v_mfma_f32_16x16x32_bf16 v[40:43], a[120:123], v[240:243], v[40:43]
    v_mfma_f32_16x16x32_bf16 v[36:39], a[116:119], v[240:243], v[36:39]
    v_mfma_f32_16x16x32_bf16 v[32:35], a[112:115], v[240:243], v[32:35]
    s_waitcnt vmcnt(15)
    v_mfma_f32_16x16x32_bf16 v[48:51], a[112:115], v[244:247], v[48:51]
    s_add_u32 s65, s65, 74752
    buffer_load_dwordx4 v[148:151], v15, s[36:39], s65 offen sc1
    v_mfma_f32_16x16x32_bf16 v[52:55], a[116:119], v[244:247], v[52:55]
    v_mfma_f32_16x16x32_bf16 v[56:59], a[120:123], v[244:247], v[56:59]
    v_mfma_f32_16x16x32_bf16 v[60:63], a[124:127], v[244:247], v[60:63]
    s_waitcnt vmcnt(15)
    v_mfma_f32_16x16x32_bf16 v[76:79], a[124:127], v[248:251], v[76:79]
    s_add_u32 s65, s65, 74752
    buffer_load_dwordx4 v[152:155], v15, s[36:39], s65 offen sc1
    v_mfma_f32_16x16x32_bf16 v[72:75], a[120:123], v[248:251], v[72:75]
    v_mfma_f32_16x16x32_bf16 v[68:71], a[116:119], v[248:251], v[68:71]
    v_mfma_f32_16x16x32_bf16 v[64:67], a[112:115], v[248:251], v[64:67]
    s_waitcnt vmcnt(15)
    v_mfma_f32_16x16x32_bf16 v[80:83], a[112:115], v[252:255], v[80:83]
    s_add_u32 s78, s78, 8192
    v_mfma_f32_16x16x32_bf16 v[84:87], a[116:119], v[252:255], v[84:87]
    s_cmp_eq_u32 s78, 57344
    s_cselect_b32 s78, 0, s78
    v_mfma_f32_16x16x32_bf16 v[88:91], a[120:123], v[252:255], v[88:91]
    s_add_u32 s65, s78, s19
    buffer_load_dwordx4 v[156:159], v15, s[36:39], s65 offen sc1
    v_mfma_f32_16x16x32_bf16 v[92:95], a[124:127], v[252:255], v[92:95]
    s_waitcnt vmcnt(15)
    v_mfma_f32_16x16x32_bf16 v[16:19], a[128:131], v[96:99], v[16:19]
    s_add_u32 s65, s65, 74752
    buffer_load_dwordx4 v[160:163], v15, s[36:39], s65 offen sc1
    v_mfma_f32_16x16x32_bf16 v[20:23], a[132:135], v[96:99], v[20:23]
    v_mfma_f32_16x16x32_bf16 v[24:27], a[136:139], v[96:99], v[24:27]
    s_mul_i32 s10, s3, 20480
    v_mfma_f32_16x16x32_bf16 v[28:31], a[140:143], v[96:99], v[28:31]
    s_sub_u32 s10, 131072, s10
    v_add_u32 v180, s10, v180
    v_add_u32 v181, s10, v181
    s_waitcnt vmcnt(15)
    v_mfma_f32_16x16x32_bf16 v[44:47], a[140:143], v[100:103], v[44:47]
    s_add_u32 s65, s65, 74752
    buffer_load_dwordx4 v[164:167], v15, s[36:39], s65 offen sc1
    v_add_u32 v182, s10, v182
    v_mfma_f32_16x16x32_bf16 v[40:43], a[136:139], v[100:103], v[40:43]
    v_add_u32 v183, s10, v183
    v_mfma_f32_16x16x32_bf16 v[36:39], a[132:135], v[100:103], v[36:39]
    ds_read_b64_tr_b16 a[192:193], v180 offset:0
    v_mfma_f32_16x16x32_bf16 v[32:35], a[128:131], v[100:103], v[32:35]
    ds_read_b64_tr_b16 a[194:195], v180 offset:1024
    s_waitcnt vmcnt(15)
    v_mfma_f32_16x16x32_bf16 v[48:51], a[128:131], v[104:107], v[48:51]
    s_add_u32 s65, s65, 74752
    buffer_load_dwordx4 v[168:171], v15, s[36:39], s65 offen sc1
    ds_read_b64_tr_b16 a[196:197], v181 offset:0
    v_mfma_f32_16x16x32_bf16 v[52:55], a[132:135], v[104:107], v[52:55]
    ds_read_b64_tr_b16 a[198:199], v181 offset:1024
    v_mfma_f32_16x16x32_bf16 v[56:59], a[136:139], v[104:107], v[56:59]
    ds_read_b64_tr_b16 a[200:201], v182 offset:0
    v_mfma_f32_16x16x32_bf16 v[60:63], a[140:143], v[104:107], v[60:63]
    ds_read_b64_tr_b16 a[202:203], v182 offset:1024
    s_waitcnt vmcnt(15)
    v_mfma_f32_16x16x32_bf16 v[76:79], a[140:143], v[108:111], v[76:79]
    s_add_u32 s65, s65, 74752
    buffer_load_dwordx4 v[172:175], v15, s[36:39], s65 offen sc1
    ds_read_b64_tr_b16 a[204:205], v183 offset:0
    v_mfma_f32_16x16x32_bf16 v[72:75], a[136:139], v[108:111], v[72:75]
    ds_read_b64_tr_b16 a[206:207], v183 offset:1024
    v_mfma_f32_16x16x32_bf16 v[68:71], a[132:135], v[108:111], v[68:71]
    v_mfma_f32_16x16x32_bf16 v[64:67], a[128:131], v[108:111], v[64:67]
    s_waitcnt vmcnt(15)
    v_mfma_f32_16x16x32_bf16 v[80:83], a[128:131], v[112:115], v[80:83]
    s_add_u32 s78, s78, 8192
    v_mfma_f32_16x16x32_bf16 v[84:87], a[132:135], v[112:115], v[84:87]
    s_cmp_eq_u32 s78, 57344
    s_cselect_b32 s78, 0, s78
    v_mfma_f32_16x16x32_bf16 v[88:91], a[136:139], v[112:115], v[88:91]
    s_add_u32 s65, s78, s19
    buffer_load_dwordx4 v[216:219], v15, s[36:39], s65 offen sc1
    v_mfma_f32_16x16x32_bf16 v[92:95], a[140:143], v[112:115], v[92:95]
    s_waitcnt vmcnt(15)
    v_mfma_f32_16x16x32_bf16 v[16:19], a[144:147], v[116:119], v[16:19]
    s_add_u32 s65, s65, 74752
    buffer_load_dwordx4 v[220:223], v15, s[36:39], s65 offen sc1
    v_mfma_f32_16x16x32_bf16 v[20:23], a[148:151], v[116:119], v[20:23]
    ds_read_b64_tr_b16 a[208:209], v180 offset:16384
    v_mfma_f32_16x16x32_bf16 v[24:27], a[152:155], v[116:119], v[24:27]
    ds_read_b64_tr_b16 a[210:211], v180 offset:17408
    v_mfma_f32_16x16x32_bf16 v[28:31], a[156:159], v[116:119], v[28:31]
    ds_read_b64_tr_b16 a[212:213], v181 offset:16384
    s_waitcnt vmcnt(15)
    v_mfma_f32_16x16x32_bf16 v[44:47], a[156:159], v[120:123], v[44:47]
    s_add_u32 s65, s65, 74752
    buffer_load_dwordx4 v[224:227], v15, s[36:39], s65 offen sc1
    ds_read_b64_tr_b16 a[214:215], v181 offset:17408
    v_mfma_f32_16x16x32_bf16 v[40:43], a[152:155], v[120:123], v[40:43]
    ds_read_b64_tr_b16 a[216:217], v182 offset:16384
    v_mfma_f32_16x16x32_bf16 v[36:39], a[148:151], v[120:123], v[36:39]
    ds_read_b64_tr_b16 a[218:219], v182 offset:17408
    v_mfma_f32_16x16x32_bf16 v[32:35], a[144:147], v[120:123], v[32:35]
    ds_read_b64_tr_b16 a[220:221], v183 offset:16384
    s_waitcnt vmcnt(15)
    v_mfma_f32_16x16x32_bf16 v[48:51], a[144:147], v[124:127], v[48:51]
    s_add_u32 s65, s65, 74752
    buffer_load_dwordx4 v[228:231], v15, s[36:39], s65 offen sc1
    ds_read_b64_tr_b16 a[222:223], v183 offset:17408
    v_mfma_f32_16x16x32_bf16 v[52:55], a[148:151], v[124:127], v[52:55]
    v_mfma_f32_16x16x32_bf16 v[56:59], a[152:155], v[124:127], v[56:59]
    v_mfma_f32_16x16x32_bf16 v[60:63], a[156:159], v[124:127], v[60:63]
    s_waitcnt vmcnt(15)
    v_mfma_f32_16x16x32_bf16 v[76:79], a[156:159], v[128:131], v[76:79]
    s_add_u32 s65, s65, 74752
    buffer_load_dwordx4 v[232:235], v15, s[36:39], s65 offen sc1
    v_mfma_f32_16x16x32_bf16 v[72:75], a[152:155], v[128:131], v[72:75]
    v_mfma_f32_16x16x32_bf16 v[68:71], a[148:151], v[128:131], v[68:71]
    v_mfma_f32_16x16x32_bf16 v[64:67], a[144:147], v[128:131], v[64:67]
    s_waitcnt vmcnt(15)
    v_mfma_f32_16x16x32_bf16 v[80:83], a[144:147], v[132:135], v[80:83]
    buffer_load_dword v6, v14, s[52:55], s27 offen sc1
    v_mfma_f32_16x16x32_bf16 v[84:87], a[148:151], v[132:135], v[84:87]
    s_add_u32 s78, s78, 8192
    v_mfma_f32_16x16x32_bf16 v[88:91], a[152:155], v[132:135], v[88:91]
    s_cmp_eq_u32 s78, 57344
    s_cselect_b32 s78, 0, s78
    v_mfma_f32_16x16x32_bf16 v[92:95], a[156:159], v[132:135], v[92:95]
    s_add_u32 s65, s78, s19
    buffer_load_dwordx4 v[236:239], v15, s[36:39], s65 offen sc1
    s_waitcnt vmcnt(16) lgkmcnt(15)
    v_mfma_f32_16x16x32_bf16 v[16:19], a[160:163], v[136:139], v[16:19]
    s_add_u32 s65, s65, 74752
    v_mfma_f32_16x16x32_bf16 v[20:23], a[164:167], v[136:139], v[20:23]
    buffer_load_dwordx4 v[240:243], v15, s[36:39], s65 offen sc1
    v_mfma_f32_16x16x32_bf16 v[24:27], a[168:171], v[136:139], v[24:27]
    v_mfma_f32_16x16x32_bf16 v[28:31], a[172:175], v[136:139], v[28:31]
    s_waitcnt vmcnt(16)
    v_mfma_f32_16x16x32_bf16 v[44:47], a[172:175], v[140:143], v[44:47]
    s_add_u32 s65, s65, 74752
    buffer_load_dwordx4 v[244:247], v15, s[36:39], s65 offen sc1
    v_mfma_f32_16x16x32_bf16 v[40:43], a[168:171], v[140:143], v[40:43]
    v_mfma_f32_16x16x32_bf16 v[36:39], a[164:167], v[140:143], v[36:39]
    v_mfma_f32_16x16x32_bf16 v[32:35], a[160:163], v[140:143], v[32:35]
    s_waitcnt vmcnt(16)
    v_mfma_f32_16x16x32_bf16 v[48:51], a[160:163], v[144:147], v[48:51]
    s_add_u32 s65, s65, 74752
    buffer_load_dwordx4 v[248:251], v15, s[36:39], s65 offen sc1
    v_mfma_f32_16x16x32_bf16 v[52:55], a[164:167], v[144:147], v[52:55]
    v_mfma_f32_16x16x32_bf16 v[56:59], a[168:171], v[144:147], v[56:59]
    v_mfma_f32_16x16x32_bf16 v[60:63], a[172:175], v[144:147], v[60:63]
    s_waitcnt vmcnt(16)
    v_mfma_f32_16x16x32_bf16 v[76:79], a[172:175], v[148:151], v[76:79]
    s_add_u32 s65, s65, 74752
    buffer_load_dwordx4 v[252:255], v15, s[36:39], s65 offen sc1
    v_mfma_f32_16x16x32_bf16 v[72:75], a[168:171], v[148:151], v[72:75]
    v_mfma_f32_16x16x32_bf16 v[68:71], a[164:167], v[148:151], v[68:71]
    v_mfma_f32_16x16x32_bf16 v[64:67], a[160:163], v[148:151], v[64:67]
    s_waitcnt vmcnt(5)
    v_cmp_gt_u32 vcc, 4, v6
    s_mov_b32 s9, 0x100000
    s_cbranch_vccnz L_poll_o
L_got_o:
    v_mfma_f32_16x16x32_bf16 v[80:83], a[160:163], v[152:155], v[80:83]
    s_mul_i32 s78, s3, 3072
    v_mfma_f32_16x16x32_bf16 v[84:87], a[164:167], v[152:155], v[84:87]
    s_add_u32 s78, s78, s76
    v_mfma_f32_16x16x32_bf16 v[88:91], a[168:171], v[152:155], v[88:91]
    s_add_u32 s78, s78, 57344
    v_mfma_f32_16x16x32_bf16 v[92:95], a[172:175], v[152:155], v[92:95]
    s_mov_b32 s65, s78
    buffer_load_dwordx4 v[96:99], v15, s[36:39], s65 offen sc1
    v_mfma_f32_16x16x32_bf16 v[16:19], a[176:179], v[156:159], v[16:19]
    s_add_u32 s65, s65, 74752
    v_mfma_f32_16x16x32_bf16 v[20:23], a[180:183], v[156:159], v[20:23]
    buffer_load_dwordx4 v[100:103], v15, s[36:39], s65 offen sc1
    v_mfma_f32_16x16x32_bf16 v[24:27], a[184:187], v[156:159], v[24:27]
    v_mfma_f32_16x16x32_bf16 v[28:31], a[188:191], v[156:159], v[28:31]
    v_mfma_f32_16x16x32_bf16 v[44:47], a[188:191], v[160:163], v[44:47]
    s_add_u32 s65, s65, 74752
    buffer_load_dwordx4 v[104:107], v15, s[36:39], s65 offen sc1
    v_mfma_f32_16x16x32_bf16 v[40:43], a[184:187], v[160:163], v[40:43]
    v_mfma_f32_16x16x32_bf16 v[36:39], a[180:183], v[160:163], v[36:39]
    v_mfma_f32_16x16x32_bf16 v[32:35], a[176:179], v[160:163], v[32:35]
    v_mfma_f32_16x16x32_bf16 v[48:51], a[176:179], v[164:167], v[48:51]
    s_add_u32 s65, s65, 74752
    buffer_load_dwordx4 v[108:111], v15, s[36:39], s65 offen sc1
    v_mfma_f32_16x16x32_bf16 v[52:55], a[180:183], v[164:167], v[52:55]
    v_mfma_f32_16x16x32_bf16 v[56:59], a[184:187], v[164:167], v[56:59]
    v_mfma_f32_16x16x32_bf16 v[60:63], a[188:191], v[164:167], v[60:63]
    v_mfma_f32_16x16x32_bf16 v[76:79], a[188:191], v[168:171], v[76:79]
    s_add_u32 s65, s65, 74752
    buffer_load_dwordx4 v[112:115], v15, s[36:39], s65 offen sc1
    v_mfma_f32_16x16x32_bf16 v[72:75], a[184:187], v[168:171], v[72:75]
    v_mfma_f32_16x16x32_bf16 v[68:71], a[180:183], v[168:171], v[68:71]
    v_mfma_f32_16x16x32_bf16 v[64:67], a[176:179], v[168:171], v[64:67]
    v_mfma_f32_16x16x32_bf16 v[80:83], a[176:179], v[172:175], v[80:83]
    s_add_u32 s65, s78, 1024
    buffer_load_dwordx4 v[116:119], v15, s[36:39], s65 offen sc1
    v_mfma_f32_16x16x32_bf16 v[84:87], a[180:183], v[172:175], v[84:87]
    v_mfma_f32_16x16x32_bf16 v[88:91], a[184:187], v[172:175], v[88:91]
    v_mfma_f32_16x16x32_bf16 v[92:95], a[188:191], v[172:175], v[92:95]
    s_waitcnt lgkmcnt(8)
    v_mfma_f32_16x16x32_bf16 v[16:19], a[192:195], v[216:219], v[16:19]
    s_add_u32 s65, s65, 74752
    buffer_load_dwordx4 v[120:123], v15, s[36:39], s65 offen sc1
    v_mfma_f32_16x16x32_bf16 v[20:23], a[196:199], v[216:219], v[20:23]
    v_mfma_f32_16x16x32_bf16 v[24:27], a[200:203], v[216:219], v[24:27]
    v_mfma_f32_16x16x32_bf16 v[28:31], a[204:207], v[216:219], v[28:31]
    v_mfma_f32_16x16x32_bf16 v[44:47], a[204:207], v[220:223], v[44:47]
    s_add_u32 s65, s65, 74752
    buffer_load_dwordx4 v[124:127], v15, s[36:39], s65 offen sc1
    v_mfma_f32_16x16x32_bf16 v[40:43], a[200:203], v[220:223], v[40:43]
    v_mfma_f32_16x16x32_bf16 v[36:39], a[196:199], v[220:223], v[36:39]
    v_mfma_f32_16x16x32_bf16 v[32:35], a[192:195], v[220:223], v[32:35]
    v_mfma_f32_16x16x32_bf16 v[48:51], a[192:195], v[224:227], v[48:51]
    s_add_u32 s65, s65, 74752
    buffer_load_dwordx4 v[128:131], v15, s[36:39], s65 offen sc1
    v_mfma_f32_16x16x32_bf16 v[52:55], a[196:199], v[224:227], v[52:55]
    v_mfma_f32_16x16x32_bf16 v[56:59], a[200:203], v[224:227], v[56:59]
    v_mfma_f32_16x16x32_bf16 v[60:63], a[204:207], v[224:227], v[60:63]
    v_mfma_f32_16x16x32_bf16 v[76:79], a[204:207], v[228:231], v[76:79]
    s_add_u32 s65, s65, 74752
    buffer_load_dwordx4 v[132:135], v15, s[36:39], s65 offen sc1
    v_mfma_f32_16x16x32_bf16 v[72:75], a[200:203], v[228:231], v[72:75]
    v_mfma_f32_16x16x32_bf16 v[68:71], a[196:199], v[228:231], v[68:71]
    v_mfma_f32_16x16x32_bf16 v[64:67], a[192:195], v[228:231], v[64:67]
    v_mfma_f32_16x16x32_bf16 v[80:83], a[192:195], v[232:235], v[80:83]
    s_add_u32 s65, s78, 2048
    buffer_load_dwordx4 v[136:139], v15, s[36:39], s65 offen sc1
    v_mfma_f32_16x16x32_bf16 v[84:87], a[196:199], v[232:235], v[84:87]
    v_mfma_f32_16x16x32_bf16 v[88:91], a[200:203], v[232:235], v[88:91]
    v_mfma_f32_16x16x32_bf16 v[92:95], a[204:207], v[232:235], v[92:95]
    s_waitcnt vmcnt(15) lgkmcnt(0)
    v_mfma_f32_16x16x32_bf16 v[16:19], a[208:211], v[236:239], v[16:19]
    s_add_u32 s65, s65, 74752
    buffer_load_dwordx4 v[140:143], v15, s[36:39], s65 offen sc1
    v_mfma_f32_16x16x32_bf16 v[20:23], a[212:215], v[236:239], v[20:23]
    v_mfma_f32_16x16x32_bf16 v[24:27], a[216:219], v[236:239], v[24:27]
    v_mfma_f32_16x16x32_bf16 v[28:31], a[220:223], v[236:239], v[28:31]
    s_waitcnt vmcnt(15)
    v_mfma_f32_16x16x32_bf16 v[44:47], a[220:223], v[240:243], v[44:47]
    s_add_u32 s65, s65, 74752
    buffer_load_dwordx4 v[144:147], v15, s[36:39], s65 offen sc1
    v_mfma_f32_16x16x32_bf16 v[40:43], a[216:219], v[240:243], v[40:43]
    v_mfma_f32_16x16x32_bf16 v[36:39], a[212:215], v[240:243], v[36:39]
    v_mfma_f32_16x16x32_bf16 v[32:35], a[208:211], v[240:243], v[32:35]
    s_waitcnt vmcnt(15)
    v_mfma_f32_16x16x32_bf16 v[48:51], a[208:211], v[244:247], v[48:51]
    s_add_u32 s65, s65, 74752
    buffer_load_dwordx4 v[148:151], v15, s[36:39], s65 offen sc1
    v_mfma_f32_16x16x32_bf16 v[52:55], a[212:215], v[244:247], v[52:55]
    v_mfma_f32_16x16x32_bf16 v[56:59], a[216:219], v[244:247], v[56:59]
    v_mfma_f32_16x16x32_bf16 v[60:63], a[220:223], v[244:247], v[60:63]
    s_waitcnt vmcnt(15)
    v_mfma_f32_16x16x32_bf16 v[76:79], a[220:223], v[248:251], v[76:79]
    s_add_u32 s65, s65, 74752
    buffer_load_dwordx4 v[152:155], v15, s[36:39], s65 offen sc1
    v_mfma_f32_16x16x32_bf16 v[72:75], a[216:219], v[248:251], v[72:75]
    v_mfma_f32_16x16x32_bf16 v[68:71], a[212:215], v[248:251], v[68:71]
    v_mfma_f32_16x16x32_bf16 v[64:67], a[208:211], v[248:251], v[64:67]
    s_waitcnt vmcnt(15)
    v_mfma_f32_16x16x32_bf16 v[80:83], a[208:211], v[252:255], v[80:83]
    s_add_u32 s65, s78, 3072
    buffer_load_dwordx4 v[156:159], v15, s[36:39], s65 offen sc1
    v_mfma_f32_16x16x32_bf16 v[84:87], a[212:215], v[252:255], v[84:87]
    v_mfma_f32_16x16x32_bf16 v[88:91], a[216:219], v[252:255], v[88:91]
    v_mfma_f32_16x16x32_bf16 v[92:95], a[220:223], v[252:255], v[92:95]
    s_barrier
    s_waitcnt vmcnt(15)
    v_mfma_f32_16x16x32_bf16 v[16:19], a[224:227], v[96:99], v[16:19]
    s_add_u32 s65, s65, 74752
    buffer_load_dwordx4 v[160:163], v15, s[36:39], s65 offen sc1
    v_mfma_f32_16x16x32_bf16 v[20:23], a[228:231], v[96:99], v[20:23]
    v_mfma_f32_16x16x32_bf16 v[24:27], a[232:235], v[96:99], v[24:27]
    v_mfma_f32_16x16x32_bf16 v[28:31], a[236:239], v[96:99], v[28:31]
    s_waitcnt vmcnt(15)
    v_mfma_f32_16x16x32_bf16 v[44:47], a[236:239], v[100:103], v[44:47]
    s_add_u32 s65, s65, 74752
    buffer_load_dwordx4 v[164:167], v15, s[36:39], s65 offen sc1
    v_mfma_f32_16x16x32_bf16 v[40:43], a[232:235], v[100:103], v[40:43]
    v_mfma_f32_16x16x32_bf16 v[36:39], a[228:231], v[100:103], v[36:39]
    v_mfma_f32_16x16x32_bf16 v[32:35], a[224:227], v[100:103], v[32:35]
    s_waitcnt vmcnt(15)
    v_mfma_f32_16x16x32_bf16 v[48:51], a[224:227], v[104:107], v[48:51]
    s_add_u32 s65, s65, 74752
    buffer_load_dwordx4 v[168:171], v15, s[36:39], s65 offen sc1
    v_mfma_f32_16x16x32_bf16 v[52:55], a[228:231], v[104:107], v[52:55]
    v_mfma_f32_16x16x32_bf16 v[56:59], a[232:235], v[104:107], v[56:59]
    v_mfma_f32_16x16x32_bf16 v[60:63], a[236:239], v[104:107], v[60:63]
    s_waitcnt vmcnt(15)
    v_mfma_f32_16x16x32_bf16 v[76:79], a[236:239], v[108:111], v[76:79]
    s_add_u32 s65, s65, 74752
    buffer_load_dwordx4 v[172:175], v15, s[36:39], s65 offen sc1
    v_mfma_f32_16x16x32_bf16 v[72:75], a[232:235], v[108:111], v[72:75]
    v_mfma_f32_16x16x32_bf16 v[68:71], a[228:231], v[108:111], v[68:71]
    v_mfma_f32_16x16x32_bf16 v[64:67], a[224:227], v[108:111], v[64:67]
    s_waitcnt vmcnt(15)
    v_mfma_f32_16x16x32_bf16 v[80:83], a[224:227], v[112:115], v[80:83]
    buffer_load_dword v8, v13, s[52:55], s26 offen offset:0 sc1
    v_mfma_f32_16x16x32_bf16 v[84:87], a[228:231], v[112:115], v[84:87]
    v_mfma_f32_16x16x32_bf16 v[88:91], a[232:235], v[112:115], v[88:91]
    v_mfma_f32_16x16x32_bf16 v[92:95], a[236:239], v[112:115], v[92:95]
    s_waitcnt vmcnt(15)
    v_mfma_f32_16x16x32_bf16 v[16:19], a[240:243], v[116:119], v[16:19]
    buffer_load_dword v9, v13, s[52:55], s26 offen offset:64 sc1
    v_mfma_f32_16x16x32_bf16 v[20:23], a[244:247], v[116:119], v[20:23]
    v_mfma_f32_16x16x32_bf16 v[24:27], a[248:251], v[116:119], v[24:27]
    v_mfma_f32_16x16x32_bf16 v[28:31], a[252:255], v[116:119], v[28:31]
    s_waitcnt vmcnt(15)
    v_mfma_f32_16x16x32_bf16 v[44:47], a[252:255], v[120:123], v[44:47]
    buffer_load_dword v10, v13, s[52:55], s26 offen offset:128 sc1
    v_mfma_f32_16x16x32_bf16 v[40:43], a[248:251], v[120:123], v[40:43]
    v_mfma_f32_16x16x32_bf16 v[36:39], a[244:247], v[120:123], v[36:39]
    v_mfma_f32_16x16x32_bf16 v[32:35], a[240:243], v[120:123], v[32:35]
    s_waitcnt vmcnt(15)
    v_mfma_f32_16x16x32_bf16 v[48:51], a[240:243], v[124:127], v[48:51]
    buffer_load_dword v11, v13, s[52:55], s26 offen offset:192 sc1
    v_mfma_f32_16x16x32_bf16 v[52:55], a[244:247], v[124:127], v[52:55]
    v_mfma_f32_16x16x32_bf16 v[56:59], a[248:251], v[124:127], v[56:59]
    v_mfma_f32_16x16x32_bf16 v[60:63], a[252:255], v[124:127], v[60:63]
    s_waitcnt vmcnt(15)
    v_mfma_f32_16x16x32_bf16 v[76:79], a[252:255], v[128:131], v[76:79]
    buffer_load_dword v12, v13, s[52:55], s26 offen offset:256 sc1
    v_mfma_f32_16x16x32_bf16 v[72:75], a[248:251], v[128:131], v[72:75]
    v_mfma_f32_16x16x32_bf16 v[68:71], a[244:247], v[128:131], v[68:71]
    v_mfma_f32_16x16x32_bf16 v[64:67], a[240:243], v[128:131], v[64:67]
    s_waitcnt vmcnt(15)
    v_mfma_f32_16x16x32_bf16 v[80:83], a[240:243], v[132:135], v[80:83]
    v_mfma_f32_16x16x32_bf16 v[84:87], a[244:247], v[132:135], v[84:87]
    v_mfma_f32_16x16x32_bf16 v[88:91], a[248:251], v[132:135], v[88:91]
    v_mfma_f32_16x16x32_bf16 v[92:95], a[252:255], v[132:135], v[92:95]
    s_waitcnt vmcnt(5)
    v_mfma_f32_16x16x32_bf16 v[20:23], v[188:191], v[136:139], v[20:23]
    v_mfma_f32_16x16x32_bf16 v[20:23], v[204:207], v[156:159], v[20:23]
    v_mfma_f32_16x16x32_bf16 v[36:39], v[188:191], v[140:143], v[36:39]
    v_mfma_f32_16x16x32_bf16 v[36:39], v[204:207], v[160:163], v[36:39]
    v_mfma_f32_16x16x32_bf16 v[52:55], v[188:191], v[144:147], v[52:55]
    v_mfma_f32_16x16x32_bf16 v[52:55], v[204:207], v[164:167], v[52:55]
    v_mfma_f32_16x16x32_bf16 v[68:71], v[188:191], v[148:151], v[68:71]
    v_mfma_f32_16x16x32_bf16 v[68:71], v[204:207], v[168:171], v[68:71]
    v_mfma_f32_16x16x32_bf16 v[84:87], v[188:191], v[152:155], v[84:87]
    v_mfma_f32_16x16x32_bf16 v[84:87], v[204:207], v[172:175], v[84:87]
    v_mfma_f32_16x16x32_bf16 v[24:27], v[192:195], v[136:139], v[24:27]
    ds_write_b128 v1, v[20:23] offset:0
    v_mfma_f32_16x16x32_bf16 v[24:27], v[208:211], v[156:159], v[24:27]
    v_mfma_f32_16x16x32_bf16 v[40:43], v[192:195], v[140:143], v[40:43]
    ds_write_b128 v1, v[36:39] offset:1024
    v_mfma_f32_16x16x32_bf16 v[40:43], v[208:211], v[160:163], v[40:43]
    v_mfma_f32_16x16x32_bf16 v[56:59], v[192:195], v[144:147], v[56:59]
    ds_write_b128 v1, v[52:55] offset:2048
    v_mfma_f32_16x16x32_bf16 v[56:59], v[208:211], v[164:167], v[56:59]
    v_mfma_f32_16x16x32_bf16 v[72:75], v[192:195], v[148:151], v[72:75]
    ds_write_b128 v1, v[68:71] offset:3072
    v_mfma_f32_16x16x32_bf16 v[72:75], v[208:211], v[168:171], v[72:75]
    v_mfma_f32_16x16x32_bf16 v[88:91], v[192:195], v[152:155], v[88:91]
    ds_write_b128 v1, v[84:87] offset:4096
    v_mfma_f32_16x16x32_bf16 v[88:91], v[208:211], v[172:175], v[88:91]
    v_mfma_f32_16x16x32_bf16 v[28:31], v[196:199], v[136:139], v[28:31]
    ds_write_b128 v2, v[24:27] offset:0
    v_mfma_f32_16x16x32_bf16 v[28:31], v[212:215], v[156:159], v[28:31]
    v_mfma_f32_16x16x32_bf16 v[44:47], v[196:199], v[140:143], v[44:47]
    ds_write_b128 v2, v[40:43] offset:1024
    v_mfma_f32_16x16x32_bf16 v[44:47], v[212:215], v[160:163], v[44:47]
    v_mfma_f32_16x16x32_bf16 v[60:63], v[196:199], v[144:147], v[60:63]
    ds_write_b128 v2, v[56:59] offset:2048
    v_mfma_f32_16x16x32_bf16 v[60:63], v[212:215], v[164:167], v[60:63]
    v_mfma_f32_16x16x32_bf16 v[76:79], v[196:199], v[148:151], v[76:79]
    ds_write_b128 v2, v[72:75] offset:3072
    v_mfma_f32_16x16x32_bf16 v[76:79], v[212:215], v[168:171], v[76:79]
    v_mfma_f32_16x16x32_bf16 v[92:95], v[196:199], v[152:155], v[92:95]
    ds_write_b128 v2, v[88:91] offset:4096
    v_mfma_f32_16x16x32_bf16 v[92:95], v[212:215], v[172:175], v[92:95]
    v_mfma_f32_16x16x32_bf16 v[16:19], v[184:187], v[136:139], v[16:19]
    ds_write_b128 v3, v[28:31] offset:0
    v_mfma_f32_16x16x32_bf16 v[16:19], v[200:203], v[156:159], v[16:19]
    v_mfma_f32_16x16x32_bf16 v[32:35], v[184:187], v[140:143], v[32:35]
    ds_write_b128 v3, v[44:47] offset:1024
    v_mfma_f32_16x16x32_bf16 v[32:35], v[200:203], v[160:163], v[32:35]
    v_mfma_f32_16x16x32_bf16 v[48:51], v[184:187], v[144:147], v[48:51]
    ds_write_b128 v3, v[60:63] offset:2048
    v_mfma_f32_16x16x32_bf16 v[48:51], v[200:203], v[164:167], v[48:51]
    v_mfma_f32_16x16x32_bf16 v[64:67], v[184:187], v[148:151], v[64:67]
    ds_write_b128 v3, v[76:79] offset:3072
    v_mfma_f32_16x16x32_bf16 v[64:67], v[200:203], v[168:171], v[64:67]
    v_mfma_f32_16x16x32_bf16 v[80:83], v[184:187], v[152:155], v[80:83]
    ds_write_b128 v3, v[92:95] offset:4096
    v_mfma_f32_16x16x32_bf16 v[80:83], v[200:203], v[172:175], v[80:83]
    s_waitcnt lgkmcnt(0)
    s_barrier
    ds_read_b128 v[96:99], v4 offset:0
    ds_read_b128 v[116:119], v4 offset:5120
    ds_read_b128 v[136:139], v4 offset:10240
    ds_read_b128 v[100:103], v4 offset:1024
    ds_read_b128 v[120:123], v4 offset:6144
    ds_read_b128 v[140:143], v4 offset:11264
    ds_read_b128 v[104:107], v4 offset:2048
    ds_read_b128 v[124:127], v4 offset:7168
    ds_read_b128 v[144:147], v4 offset:12288
    ds_read_b128 v[108:111], v4 offset:3072
    ds_read_b128 v[128:131], v4 offset:8192
    ds_read_b128 v[148:151], v4 offset:13312
    ds_read_b128 v[112:115], v4 offset:4096
    ds_read_b128 v[132:135], v4 offset:9216
    ds_read_b128 v[152:155], v4 offset:14336
    s_waitcnt vmcnt(0)
    s_waitcnt lgkmcnt(12)
    v_pk_add_f32 v[116:117], v[116:117], v[136:137] op_sel:[0,0] op_sel_hi:[1,1]
    v_pk_add_f32 v[118:119], v[118:119], v[138:139] op_sel:[0,0] op_sel_hi:[1,1]
    v_pk_add_f32 v[16:17], v[16:17], v[96:97] op_sel:[0,0] op_sel_hi:[1,1]
    v_pk_add_f32 v[18:19], v[18:19], v[98:99] op_sel:[0,0] op_sel_hi:[1,1]
    v_pk_add_f32 v[16:17], v[16:17], v[116:117] op_sel:[0,0] op_sel_hi:[1,1]
    v_pk_add_f32 v[18:19], v[18:19], v[118:119] op_sel:[0,0] op_sel_hi:[1,1]
    v_pk_mul_f32 v[16:17], v[16:17], v[8:9] op_sel:[0,0] op_sel_hi:[1,0]
    v_pk_mul_f32 v[18:19], v[18:19], v[8:9] op_sel:[0,0] op_sel_hi:[1,0]
    v_cvt_pk_bf16_f32 v20, v16, v17
    v_cvt_pk_bf16_f32 v21, v18, v19
    ds_write_b64 v176, v[20:21] offset:0
    s_waitcnt lgkmcnt(10)
    v_pk_add_f32 v[120:121], v[120:121], v[140:141] op_sel:[0,0] op_sel_hi:[1,1]
    v_pk_add_f32 v[122:123], v[122:123], v[142:143] op_sel:[0,0] op_sel_hi:[1,1]
    v_pk_add_f32 v[32:33], v[32:33], v[100:101] op_sel:[0,0] op_sel_hi:[1,1]
    v_pk_add_f32 v[34:35], v[34:35], v[102:103] op_sel:[0,0] op_sel_hi:[1,1]
    v_pk_add_f32 v[32:33], v[32:33], v[120:121] op_sel:[0,0] op_sel_hi:[1,1]
    v_pk_add_f32 v[34:35], v[34:35], v[122:123] op_sel:[0,0] op_sel_hi:[1,1]
    v_pk_mul_f32 v[32:33], v[32:33], v[8:9] op_sel:[0,1] op_sel_hi:[1,1]
    v_pk_mul_f32 v[34:35], v[34:35], v[8:9] op_sel:[0,1] op_sel_hi:[1,1]
    v_cvt_pk_bf16_f32 v22, v32, v33
    v_cvt_pk_bf16_f32 v23, v34, v35
    ds_write_b64 v176, v[22:23] offset:2048
    s_waitcnt lgkmcnt(8)
    v_pk_add_f32 v[124:125], v[124:125], v[144:145] op_sel:[0,0] op_sel_hi:[1,1]
    v_pk_add_f32 v[126:127], v[126:127], v[146:147] op_sel:[0,0] op_sel_hi:[1,1]
    v_pk_add_f32 v[48:49], v[48:49], v[104:105] op_sel:[0,0] op_sel_hi:[1,1]
    v_pk_add_f32 v[50:51], v[50:51], v[106:107] op_sel:[0,0] op_sel_hi:[1,1]
    v_pk_add_f32 v[48:49], v[48:49], v[124:125] op_sel:[0,0] op_sel_hi:[1,1]
    v_pk_add_f32 v[50:51], v[50:51], v[126:127] op_sel:[0,0] op_sel_hi:[1,1]
    v_pk_mul_f32 v[48:49], v[48:49], v[10:11] op_sel:[0,0] op_sel_hi:[1,0]
    v_pk_mul_f32 v[50:51], v[50:51], v[10:11] op_sel:[0,0] op_sel_hi:[1,0]
    v_cvt_pk_bf16_f32 v52, v48, v49
    v_cvt_pk_bf16_f32 v53, v50, v51
    ds_write_b64 v176, v[52:53] offset:4096
    s_waitcnt lgkmcnt(6)
    v_pk_add_f32 v[128:129], v[128:129], v[148:149] op_sel:[0,0] op_sel_hi:[1,1]
    v_pk_add_f32 v[130:131], v[130:131], v[150:151] op_sel:[0,0] op_sel_hi:[1,1]
    v_pk_add_f32 v[64:65], v[64:65], v[108:109] op_sel:[0,0] op_sel_hi:[1,1]
    v_pk_add_f32 v[66:67], v[66:67], v[110:111] op_sel:[0,0] op_sel_hi:[1,1]
    v_pk_add_f32 v[64:65], v[64:65], v[128:129] op_sel:[0,0] op_sel_hi:[1,1]
    v_pk_add_f32 v[66:67], v[66:67], v[130:131] op_sel:[0,0] op_sel_hi:[1,1]
    v_pk_mul_f32 v[64:65], v[64:65], v[10:11] op_sel:[0,1] op_sel_hi:[1,1]
    v_pk_mul_f32 v[66:67], v[66:67], v[10:11] op_sel:[0,1] op_sel_hi:[1,1]
    v_cvt_pk_bf16_f32 v54, v64, v65
    v_cvt_pk_bf16_f32 v55, v66, v67
    ds_write_b64 v176, v[54:55] offset:6144
    s_waitcnt lgkmcnt(4)
    v_pk_add_f32 v[132:133], v[132:133], v[152:153] op_sel:[0,0] op_sel_hi:[1,1]
    v_pk_add_f32 v[134:135], v[134:135], v[154:155] op_sel:[0,0] op_sel_hi:[1,1]
    v_pk_add_f32 v[80:81], v[80:81], v[112:113] op_sel:[0,0] op_sel_hi:[1,1]
    v_pk_add_f32 v[82:83], v[82:83], v[114:115] op_sel:[0,0] op_sel_hi:[1,1]
    v_pk_add_f32 v[80:81], v[80:81], v[132:133] op_sel:[0,0] op_sel_hi:[1,1]
    v_pk_add_f32 v[82:83], v[82:83], v[134:135] op_sel:[0,0] op_sel_hi:[1,1]
    v_pk_mul_f32 v[80:81], v[80:81], v[12:13] op_sel:[0,0] op_sel_hi:[1,0]
    v_pk_mul_f32 v[82:83], v[82:83], v[12:13] op_sel:[0,0] op_sel_hi:[1,0]
    v_cvt_pk_bf16_f32 v84, v80, v81
    v_cvt_pk_bf16_f32 v85, v82, v83
    ds_write_b64 v176, v[84:85] offset:8192
    s_mov_b32 s10, 7168
    s_mov_b32 s11, 14336
    s_waitcnt lgkmcnt(0)
    s_barrier
    ds_read_b128 v[96:99], v177 offset:0
    ds_read_b128 v[100:103], v177 offset:1024
    ds_read_b128 v[104:107], v177 offset:2048
    s_waitcnt lgkmcnt(2)
    buffer_store_dwordx4 v[96:99], v5, s[40:43], 0 offen sc1
    s_waitcnt lgkmcnt(1)
    buffer_store_dwordx4 v[100:103], v5, s[40:43], s10 offen sc1
    s_waitcnt lgkmcnt(0)
    s_mov_b64 exec, 0xffffffff
    buffer_store_dwordx4 v[104:107], v5, s[40:43], s11 offen sc1
    s_endpgm
L_slow_h:
    s_sub_u32 s9, s9, 1
    s_cbranch_scc1 L_end
    buffer_load_dword v20, off, s[96:99], 0 sc1
    s_waitcnt vmcnt(0)
    v_readfirstlane_b32 s10, v20
    s_nop 3
    s_cmp_lt_u32 s10, 1
    s_cbranch_scc1 L_slow_h
    s_branch L_back_h
L_poll_e:
    s_sub_u32 s9, s9, 1
    s_cbranch_scc1 L_end
    buffer_load_dword v6, off, s[52:55], s94 sc1
    s_waitcnt vmcnt(0)
    v_cmp_gt_u32 vcc, 7, v6
    s_nop 0
    s_cbranch_vccnz L_poll_e
    s_branch L_got_e
L_poll_l:
    s_sub_u32 s9, s9, 1
    s_cbranch_scc1 L_end
    buffer_load_dword v6, off, s[52:55], s94 sc1
    s_waitcnt vmcnt(0)
    v_cmp_gt_u32 vcc, 7, v6
    s_nop 0
    s_cbranch_vccnz L_poll_l
    s_branch L_got_l
L_poll_o:
    s_sub_u32 s9, s9, 1
    s_cbranch_scc1 L_end
    buffer_load_dword v6, v14, s[52:55], s27 offen sc1
    s_waitcnt vmcnt(0)
    v_cmp_gt_u32 vcc, 4, v6
    s_nop 0
    s_cbranch_vccnz L_poll_o
    s_branch L_got_o
L_qkv:
    s_lshl_b32 s10, s10, 1
    s_lshr_b32 s79, 201, s10
    s_and_b32 s79, s79, 3
    s_lshl_b32 s93, s27, 3
    s_add_u32 s93, s93, s11
    s_mov_b32 s27, s93
    s_mul_i32 s27, s27, 2
    s_and_b32 s11, s2, 1
    s_mul_i32 s11, s11, 2
    s_add_u32 s27, s27, s11
    s_mul_i32 s11, s27, 147
    s_lshr_b32 s11, s11, 10
    s_mul_i32 s11, s11, 7
    s_sub_u32 s27, s27, s11
    s_lshl_b32 s56, s27, 7
    v_lshrrev_b32 v17, 4, v0
    v_and_b32 v18, 15, v0
    v_lshrrev_b32 v19, 3, v0
    v_and_b32 v20, 7, v0
    s_mul_i32 s11, s79, 224
    s_cmp_eq_u32 s79, 3
    s_cselect_b32 s11, 640, s11
    s_mul_i32 s26, s3, 21504
    s_add_u32 s11, s11, s26
    s_movk_i32 s27, 2688
    v_mul_u32_u24 v21, s27, v17
    v_add_u32 v21, s11, v21
    s_and_b32 s26, s3, 1
    s_lshl_b32 s26, s26, 3
    v_lshlrev_b32 v22, 1, v17
    v_sub_u32 v22, v18, v22
    v_xor_b32 v22, s26, v22
    v_and_b32 v22, 15, v22
    v_lshl_add_u32 v1, v22, 4, v21
    s_cmp_eq_u32 s79, 3
    s_cselect_b32 s11, 0, 7
    v_lshrrev_b32 v22, 1, v22
    v_cmp_eq_u32 vcc, s11, v22
    v_mov_b32 v22, 1073741824
    s_nop 0
    v_cndmask_b32 v1, v1, v22, vcc
    v_add_u32 v2, 9728, v1
    s_lshl_b32 s69, s3, 11
    s_movk_i32 s27, 896
    v_mul_u32_u24 v21, s27, v19
    v_xor_b32 v22, v17, v20
    v_lshl_add_u32 v21, v22, 4, v21
    s_lshl_b32 s26, s3, 2
    s_lshr_b32 s26, 0x8630, s26
    s_and_b32 s26, s26, 15
    s_and_b32 s27, s26, 1
    s_lshl_b32 s27, s27, 6
    v_xor_b32 v3, s27, v21
    v_xor_b32 v4, 64, v3
    v_mov_b32 v27, v21
    s_lshl_b32 s70, s26, 10
    s_add_u32 s70, s70, 98304
    s_lshl_b32 s26, s26, 3
    s_lshl_b32 s27, s93, 7
    s_add_u32 s26, s26, s27
    s_sub_u32 s26, s26, 16
    s_add_u32 s27, s26, 0
    s_mul_i32 s74, s27, 896
    s_cmp_lt_i32 s27, 0
    s_cselect_b32 s74, 1073741824, s74
    s_add_u32 s27, s26, 8
    s_mul_i32 s75, s27, 896
    s_cmp_lt_i32 s27, 0
    s_cselect_b32 s75, 1073741824, s75
    s_add_u32 s27, s26, 16
    s_mul_i32 s76, s27, 896
    s_add_u32 s77, s70, 2048
    s_lshl_b32 s27, s3, 10
    s_add_u32 s27, s27, 106496
    s_cmp_ge_u32 s3, 2
    s_cselect_b32 s76, 1073741824, s76
    s_cselect_b32 s77, s27, s77
    s_waitcnt lgkmcnt(0)
    s_mov_b32 s32, s6
    s_mov_b32 s33, s7
    s_mov_b32 s34, 1204224
    s_mov_b32 s35, 0x20000
    s_add_u32 m0, s69, 0
    s_mul_i32 s71, s56, 1344
    buffer_load_dwordx4 v1, s[32:35], s71 offen offset:0 lds
    buffer_load_dwordx4 v2, s[32:35], s71 offen offset:1024 lds
    s_add_u32 m0, s69, 8192
    s_add_u32 s71, s71, 896
    buffer_load_dwordx4 v1, s[32:35], s71 offen offset:0 lds
    buffer_load_dwordx4 v2, s[32:35], s71 offen offset:1024 lds
    s_add_u32 m0, s69, 16384
    s_add_u32 s71, s71, 896
    buffer_load_dwordx4 v1, s[32:35], s71 offen offset:0 lds
    buffer_load_dwordx4 v2, s[32:35], s71 offen offset:1024 lds
    s_mov_b32 s28, s4
    s_mov_b32 s29, s5
    s_mov_b32 s30, 1835008
    s_mov_b32 s31, 0x20000
    s_add_u32 m0, s70, 0
    s_add_u32 s65, s74, s56
    buffer_load_dwordx4 v3, s[28:31], s65 offen lds
    s_add_u32 m0, s70, 1024
    s_add_u32 s65, s75, s56
    buffer_load_dwordx4 v4, s[28:31], s65 offen lds
    s_add_u32 m0, s77, 0
    s_add_u32 s65, s76, s56
    buffer_load_dwordx4 v3, s[28:31], s65 offen lds
    v_bfe_u32 v21, v0, 2, 2
    v_lshl_add_u32 v22, v17, 3, v21
    v_and_b32 v26, 1, v17
    v_lshl_add_u32 v21, v26, 2, v21
    v_and_b32 v26, 3, v0
    v_lshlrev_b32 v29, 3, v26
    v_lshl_add_u32 v21, v21, 5, v29
    s_mul_i32 s26, s3, 56
    s_cmp_eq_u32 s79, 3
    s_cselect_b32 s27, 32, 0
    s_add_u32 s26, s26, s27
    v_add_u32 v21, s26, v21
    v_and_b32 v29, 0xff, v21
    v_lshl_add_u32 v5, v22, 8, v29
    v_cmp_eq_u32 vcc, 3, v26
    s_sub_u32 s26, s26, s27
    s_mul_i32 s27, s27, 8
    s_sub_u32 s26, 200, s26
    s_sub_u32 s26, s26, s27
    v_mov_b32 v29, s26
    v_cndmask_b32 v29, 32, v29, vcc
    v_add_u32 v21, v29, v21
    v_and_b32 v29, 0xff, v21
    v_lshl_add_u32 v6, v22, 8, v29
    v_add_u32 v7, 49152, v5
    v_add_u32 v8, 49152, v6
    v_lshrrev_b32 v21, 1, v18
    v_xor_b32 v21, v21, v17
    v_lshlrev_b32 v21, 4, v21
    v_lshl_add_u32 v21, v18, 7, v21
    v_add_u32 v9, 98304, v21
    v_xor_b32 v10, 64, v9
    s_add_u32 s57, s56, 128
    s_cmp_eq_u32 s57, 896
    s_cselect_b32 s57, 0, s57
    s_add_u32 s58, s57, 128
    s_cmp_eq_u32 s58, 896
    s_cselect_b32 s58, 0, s58
    s_add_u32 s59, s58, 128
    s_cmp_eq_u32 s59, 896
    s_cselect_b32 s59, 0, s59
    s_add_u32 s60, s59, 128
    s_cmp_eq_u32 s60, 896
    s_cselect_b32 s60, 0, s60
    s_add_u32 s61, s60, 128
    s_cmp_eq_u32 s61, 896
    s_cselect_b32 s61, 0, s61
    s_add_u32 s62, s61, 128
    s_cmp_eq_u32 s62, 896
    s_cselect_b32 s62, 0, s62
    s_add_u32 m0, s69, 24576
    s_mul_i32 s71, s56, 1344
    s_add_u32 s71, s71, 86016
    buffer_load_dwordx4 v1, s[32:35], s71 offen offset:0 lds
    buffer_load_dwordx4 v2, s[32:35], s71 offen offset:1024 lds
    s_add_u32 m0, s69, 32768
    s_add_u32 s71, s71, 896
    buffer_load_dwordx4 v1, s[32:35], s71 offen offset:0 lds
    buffer_load_dwordx4 v2, s[32:35], s71 offen offset:1024 lds
    s_add_u32 m0, s69, 40960
    s_add_u32 s71, s71, 896
    buffer_load_dwordx4 v1, s[32:35], s71 offen offset:0 lds
    buffer_load_dwordx4 v2, s[32:35], s71 offen offset:1024 lds
    s_add_u32 s36, s24, 131072
    s_addc_u32 s37, s25, 0
    s_mov_b32 s38, 9568256
    s_mov_b32 s39, 0x20000
    s_mov_b32 s96, s22
    s_mov_b32 s97, s23
    s_mov_b32 s98, 256
    s_mov_b32 s99, 0x20000
    v_xor_b32 v28, 64, v27
    v_add_u32 v28, 6144, v28
    s_lshl_b32 s26, s93, 7
    s_lshl_b32 s27, s3, 4
    s_add_u32 s26, s26, s27
    s_add_u32 s26, s26, 64
    s_mul_i32 s78, s26, 896
    s_lshl_b32 s68, s3, 11
    s_add_u32 s68, s68, 122880
    s_waitcnt vmcnt(6) lgkmcnt(0)
    s_barrier
    ds_read_b128 a[168:171], v9 offset:0
    ds_read_b128 a[172:175], v9 offset:2048
    ds_read_b128 a[176:179], v9 offset:4096
    ds_read_b128 a[180:183], v9 offset:6144
    ds_read_b128 a[184:187], v9 offset:8192
    ds_read_b64_tr_b16 a[8:9], v5 offset:8192
    ds_read_b64_tr_b16 a[10:11], v5 offset:9216
    ds_read_b64_tr_b16 a[12:13], v6 offset:8192
    ds_read_b64_tr_b16 a[14:15], v6 offset:9216
    ds_read_b64_tr_b16 a[16:17], v5 offset:16384
    ds_read_b64_tr_b16 a[18:19], v5 offset:17408
    ds_read_b64_tr_b16 a[20:21], v6 offset:16384
    ds_read_b64_tr_b16 a[22:23], v6 offset:17408
    ds_read_b64_tr_b16 a[0:1], v5 offset:0
    ds_read_b64_tr_b16 a[2:3], v5 offset:1024
    ds_read_b64_tr_b16 a[4:5], v6 offset:0
    ds_read_b64_tr_b16 a[6:7], v6 offset:1024
    s_add_u32 m0, s70, 12288
    s_add_u32 s65, s74, s57
    buffer_load_dwordx4 v3, s[28:31], s65 offen lds
    s_add_u32 m0, s70, 13312
    s_add_u32 s65, s75, s57
    buffer_load_dwordx4 v4, s[28:31], s65 offen lds
    s_add_u32 m0, s77, 12288
    s_add_u32 s65, s76, s57
    buffer_load_dwordx4 v3, s[28:31], s65 offen lds
    s_add_u32 m0, s69, 49152
    s_mul_i32 s71, s57, 1344
    buffer_load_dwordx4 v1, s[32:35], s71 offen offset:0 lds
    buffer_load_dwordx4 v2, s[32:35], s71 offen offset:1024 lds
    s_add_u32 m0, s69, 57344
    s_add_u32 s71, s71, 896
    buffer_load_dwordx4 v1, s[32:35], s71 offen offset:0 lds
    buffer_load_dwordx4 v2, s[32:35], s71 offen offset:1024 lds
    s_add_u32 m0, s69, 65536
    s_add_u32 s71, s71, 896
    buffer_load_dwordx4 v1, s[32:35], s71 offen offset:0 lds
    buffer_load_dwordx4 v2, s[32:35], s71 offen offset:1024 lds
    s_waitcnt vmcnt(9) lgkmcnt(0)
    s_barrier
    v_mfma_f32_16x16x32_bf16 v[224:227], a[4:7], a[172:175], 0
    s_add_u32 m0, s69, 73728
    v_mfma_f32_16x16x32_bf16 v[192:195], a[0:3], a[172:175], 0
    s_mul_i32 s71, s57, 1344
    ds_read_b128 a[188:191], v10 offset:0
    v_mfma_f32_16x16x32_bf16 v[196:199], a[0:3], a[176:179], 0
    s_add_u32 s71, s71, 86016
    buffer_load_dwordx4 v1, s[32:35], s71 offen offset:0 lds
    ds_read_b128 a[192:195], v10 offset:2048
    v_mfma_f32_16x16x32_bf16 v[228:231], a[4:7], a[176:179], 0
    v_mfma_f32_16x16x32_bf16 v[232:235], a[4:7], a[180:183], 0
    ds_read_b128 a[196:199], v10 offset:4096
    v_mfma_f32_16x16x32_bf16 v[200:203], a[0:3], a[180:183], 0
    buffer_load_dwordx4 v2, s[32:35], s71 offen offset:1024 lds
    ds_read_b128 a[200:203], v10 offset:6144
    v_mfma_f32_16x16x32_bf16 v[204:207], a[0:3], a[184:187], 0
    s_add_u32 m0, s69, 81920
    v_mfma_f32_16x16x32_bf16 v[236:239], a[4:7], a[184:187], 0
    s_add_u32 s71, s71, 896
    ds_read_b128 a[204:207], v10 offset:8192
    v_mfma_f32_16x16x32_bf16 v[48:51], a[8:11], a[168:171], 0
    buffer_load_dwordx4 v1, s[32:35], s71 offen offset:0 lds
    ds_read_b64_tr_b16 a[32:33], v5 offset:32768
    v_mfma_f32_16x16x32_bf16 v[84:87], a[12:15], a[168:171], 0
    v_mfma_f32_16x16x32_bf16 v[88:91], a[12:15], a[172:175], 0
    ds_read_b64_tr_b16 a[34:35], v5 offset:33792
    v_mfma_f32_16x16x32_bf16 v[52:55], a[8:11], a[172:175], 0
    buffer_load_dwordx4 v2, s[32:35], s71 offen offset:1024 lds
    ds_read_b64_tr_b16 a[36:37], v6 offset:32768
    v_mfma_f32_16x16x32_bf16 v[56:59], a[8:11], a[176:179], 0
    s_add_u32 m0, s69, 90112
    ds_read_b64_tr_b16 a[38:39], v6 offset:33792
    v_mfma_f32_16x16x32_bf16 v[92:95], a[12:15], a[176:179], 0
    s_add_u32 s71, s71, 896
    v_mfma_f32_16x16x32_bf16 v[96:99], a[12:15], a[180:183], 0
    buffer_load_dwordx4 v1, s[32:35], s71 offen offset:0 lds
    ds_read_b64_tr_b16 a[40:41], v5 offset:40960
    v_mfma_f32_16x16x32_bf16 v[60:63], a[8:11], a[180:183], 0
    ds_read_b64_tr_b16 a[42:43], v5 offset:41984
    v_mfma_f32_16x16x32_bf16 v[64:67], a[8:11], a[184:187], 0
    v_mfma_f32_16x16x32_bf16 v[100:103], a[12:15], a[184:187], 0
    buffer_load_dwordx4 v2, s[32:35], s71 offen offset:1024 lds
    ds_read_b64_tr_b16 a[44:45], v6 offset:40960
    v_mfma_f32_16x16x32_bf16 v[120:123], a[168:171], a[16:19], 0
    ds_read_b64_tr_b16 a[46:47], v6 offset:41984
    v_mfma_f32_16x16x32_bf16 v[156:159], a[168:171], a[20:23], 0
    v_mfma_f32_16x16x32_bf16 v[160:163], a[172:175], a[20:23], 0
    ds_read_b64_tr_b16 a[24:25], v5 offset:24576
    v_mfma_f32_16x16x32_bf16 v[124:127], a[172:175], a[16:19], 0
    ds_read_b64_tr_b16 a[26:27], v5 offset:25600
    v_mfma_f32_16x16x32_bf16 v[128:131], a[176:179], a[16:19], 0
    ds_read_b64_tr_b16 a[28:29], v6 offset:24576
    v_mfma_f32_16x16x32_bf16 v[164:167], a[176:179], a[20:23], 0
    v_mfma_f32_16x16x32_bf16 v[168:171], a[180:183], a[20:23], 0
    ds_read_b64_tr_b16 a[30:31], v6 offset:25600
    v_mfma_f32_16x16x32_bf16 v[132:135], a[180:183], a[16:19], 0
    v_mfma_f32_16x16x32_bf16 v[136:139], a[184:187], a[16:19], 0
    v_mfma_f32_16x16x32_bf16 v[172:175], a[184:187], a[20:23], 0
    s_waitcnt vmcnt(6) lgkmcnt(0)
    s_barrier
    v_mfma_f32_16x16x32_bf16 v[224:227], a[28:31], a[192:195], v[224:227]
    s_add_u32 m0, s70, 0
    v_mfma_f32_16x16x32_bf16 v[192:195], a[24:27], a[192:195], v[192:195]
    s_add_u32 s65, s74, s58
    buffer_load_dwordx4 v3, s[28:31], s65 offen lds
    ds_read_b128 a[168:171], v9 offset:12288
    v_mfma_f32_16x16x32_bf16 v[196:199], a[24:27], a[196:199], v[196:199]
    s_add_u32 m0, s70, 1024
    ds_read_b128 a[172:175], v9 offset:14336
    v_mfma_f32_16x16x32_bf16 v[228:231], a[28:31], a[196:199], v[228:231]
    s_add_u32 s65, s75, s58
    v_mfma_f32_16x16x32_bf16 v[232:235], a[28:31], a[200:203], v[232:235]
    buffer_load_dwordx4 v4, s[28:31], s65 offen lds
    ds_read_b128 a[176:179], v9 offset:16384
    v_mfma_f32_16x16x32_bf16 v[200:203], a[24:27], a[200:203], v[200:203]
    s_add_u32 m0, s77, 0
    ds_read_b128 a[180:183], v9 offset:18432
    v_mfma_f32_16x16x32_bf16 v[204:207], a[24:27], a[204:207], v[204:207]
    s_add_u32 s65, s76, s58
    v_mfma_f32_16x16x32_bf16 v[236:239], a[28:31], a[204:207], v[236:239]
    buffer_load_dwordx4 v3, s[28:31], s65 offen lds
    ds_read_b128 a[184:187], v9 offset:20480
    v_mfma_f32_16x16x32_bf16 v[48:51], a[32:35], a[188:191], v[48:51]
    s_add_u32 m0, s69, 0
    ds_read_b64_tr_b16 a[56:57], v7 offset:8192
    v_mfma_f32_16x16x32_bf16 v[84:87], a[36:39], a[188:191], v[84:87]
    s_mul_i32 s71, s58, 1344
    v_mfma_f32_16x16x32_bf16 v[88:91], a[36:39], a[192:195], v[88:91]
    buffer_load_dwordx4 v1, s[32:35], s71 offen offset:0 lds
    ds_read_b64_tr_b16 a[58:59], v7 offset:9216
    v_mfma_f32_16x16x32_bf16 v[52:55], a[32:35], a[192:195], v[52:55]
    ds_read_b64_tr_b16 a[60:61], v8 offset:8192
    v_mfma_f32_16x16x32_bf16 v[56:59], a[32:35], a[196:199], v[56:59]
    ds_read_b64_tr_b16 a[62:63], v8 offset:9216
    v_mfma_f32_16x16x32_bf16 v[92:95], a[36:39], a[196:199], v[92:95]
    buffer_load_dwordx4 v2, s[32:35], s71 offen offset:1024 lds
    v_mfma_f32_16x16x32_bf16 v[96:99], a[36:39], a[200:203], v[96:99]
    s_add_u32 m0, s69, 8192
    ds_read_b64_tr_b16 a[64:65], v7 offset:16384
    v_mfma_f32_16x16x32_bf16 v[60:63], a[32:35], a[200:203], v[60:63]
    s_add_u32 s71, s71, 896
    ds_read_b64_tr_b16 a[66:67], v7 offset:17408
    v_mfma_f32_16x16x32_bf16 v[64:67], a[32:35], a[204:207], v[64:67]
    buffer_load_dwordx4 v1, s[32:35], s71 offen offset:0 lds
    v_mfma_f32_16x16x32_bf16 v[100:103], a[36:39], a[204:207], v[100:103]
    ds_read_b64_tr_b16 a[68:69], v8 offset:16384
    v_mfma_f32_16x16x32_bf16 v[120:123], a[188:191], a[40:43], v[120:123]
    ds_read_b64_tr_b16 a[70:71], v8 offset:17408
    v_mfma_f32_16x16x32_bf16 v[156:159], a[188:191], a[44:47], v[156:159]
    buffer_load_dwordx4 v2, s[32:35], s71 offen offset:1024 lds
    v_mfma_f32_16x16x32_bf16 v[160:163], a[192:195], a[44:47], v[160:163]
    s_add_u32 m0, s69, 16384
    ds_read_b64_tr_b16 a[48:49], v7 offset:0
    v_mfma_f32_16x16x32_bf16 v[124:127], a[192:195], a[40:43], v[124:127]
    s_add_u32 s71, s71, 896
    ds_read_b64_tr_b16 a[50:51], v7 offset:1024
    v_mfma_f32_16x16x32_bf16 v[128:131], a[196:199], a[40:43], v[128:131]
    buffer_load_dwordx4 v1, s[32:35], s71 offen offset:0 lds
    ds_read_b64_tr_b16 a[52:53], v8 offset:0
    v_mfma_f32_16x16x32_bf16 v[164:167], a[196:199], a[44:47], v[164:167]
    v_mfma_f32_16x16x32_bf16 v[168:171], a[200:203], a[44:47], v[168:171]
    ds_read_b64_tr_b16 a[54:55], v8 offset:1024
    v_mfma_f32_16x16x32_bf16 v[132:135], a[200:203], a[40:43], v[132:135]
    buffer_load_dwordx4 v2, s[32:35], s71 offen offset:1024 lds
    v_mfma_f32_16x16x32_bf16 v[136:139], a[204:207], a[40:43], v[136:139]
    v_mfma_f32_16x16x32_bf16 v[172:175], a[204:207], a[44:47], v[172:175]
    s_waitcnt vmcnt(9) lgkmcnt(0)
    s_barrier
    v_mfma_f32_16x16x32_bf16 v[224:227], a[52:55], a[172:175], v[224:227]
    s_add_u32 m0, s69, 24576
    v_mfma_f32_16x16x32_bf16 v[192:195], a[48:51], a[172:175], v[192:195]
    s_mul_i32 s71, s58, 1344
    ds_read_b128 a[188:191], v10 offset:12288
    v_mfma_f32_16x16x32_bf16 v[196:199], a[48:51], a[176:179], v[196:199]
    s_add_u32 s71, s71, 86016
    buffer_load_dwordx4 v1, s[32:35], s71 offen offset:0 lds
    ds_read_b128 a[192:195], v10 offset:14336
    v_mfma_f32_16x16x32_bf16 v[228:231], a[52:55], a[176:179], v[228:231]
    v_mfma_f32_16x16x32_bf16 v[232:235], a[52:55], a[180:183], v[232:235]
    ds_read_b128 a[196:199], v10 offset:16384
    v_mfma_f32_16x16x32_bf16 v[200:203], a[48:51], a[180:183], v[200:203]
    buffer_load_dwordx4 v2, s[32:35], s71 offen offset:1024 lds
    ds_read_b128 a[200:203], v10 offset:18432
    v_mfma_f32_16x16x32_bf16 v[204:207], a[48:51], a[184:187], v[204:207]
    s_add_u32 m0, s69, 32768
    v_mfma_f32_16x16x32_bf16 v[236:239], a[52:55], a[184:187], v[236:239]
    s_add_u32 s71, s71, 896
    ds_read_b128 a[204:207], v10 offset:20480
    v_mfma_f32_16x16x32_bf16 v[48:51], a[56:59], a[168:171], v[48:51]
    buffer_load_dwordx4 v1, s[32:35], s71 offen offset:0 lds
    ds_read_b64_tr_b16 a[80:81], v7 offset:32768
    v_mfma_f32_16x16x32_bf16 v[84:87], a[60:63], a[168:171], v[84:87]
    v_mfma_f32_16x16x32_bf16 v[88:91], a[60:63], a[172:175], v[88:91]
    ds_read_b64_tr_b16 a[82:83], v7 offset:33792
    v_mfma_f32_16x16x32_bf16 v[52:55], a[56:59], a[172:175], v[52:55]
    buffer_load_dwordx4 v2, s[32:35], s71 offen offset:1024 lds
    ds_read_b64_tr_b16 a[84:85], v8 offset:32768
    v_mfma_f32_16x16x32_bf16 v[56:59], a[56:59], a[176:179], v[56:59]
    s_add_u32 m0, s69, 40960
    ds_read_b64_tr_b16 a[86:87], v8 offset:33792
    v_mfma_f32_16x16x32_bf16 v[92:95], a[60:63], a[176:179], v[92:95]
    s_add_u32 s71, s71, 896
    v_mfma_f32_16x16x32_bf16 v[96:99], a[60:63], a[180:183], v[96:99]
    buffer_load_dwordx4 v1, s[32:35], s71 offen offset:0 lds
    ds_read_b64_tr_b16 a[88:89], v7 offset:40960
    v_mfma_f32_16x16x32_bf16 v[60:63], a[56:59], a[180:183], v[60:63]
    ds_read_b64_tr_b16 a[90:91], v7 offset:41984
    v_mfma_f32_16x16x32_bf16 v[64:67], a[56:59], a[184:187], v[64:67]
    v_mfma_f32_16x16x32_bf16 v[100:103], a[60:63], a[184:187], v[100:103]
    buffer_load_dwordx4 v2, s[32:35], s71 offen offset:1024 lds
    ds_read_b64_tr_b16 a[92:93], v8 offset:40960
    v_mfma_f32_16x16x32_bf16 v[120:123], a[168:171], a[64:67], v[120:123]
    s_add_u32 m0, s68, 0
    ds_read_b64_tr_b16 a[94:95], v8 offset:41984
    v_mfma_f32_16x16x32_bf16 v[156:159], a[168:171], a[68:71], v[156:159]
    s_add_u32 s65, s78, s56
    v_mfma_f32_16x16x32_bf16 v[160:163], a[172:175], a[68:71], v[160:163]
    buffer_load_dwordx4 v27, s[28:31], s65 offen offset:0 lds
    ds_read_b64_tr_b16 a[72:73], v7 offset:24576
    v_mfma_f32_16x16x32_bf16 v[124:127], a[172:175], a[64:67], v[124:127]
    ds_read_b64_tr_b16 a[74:75], v7 offset:25600
    v_mfma_f32_16x16x32_bf16 v[128:131], a[176:179], a[64:67], v[128:131]
    ds_read_b64_tr_b16 a[76:77], v8 offset:24576
    v_mfma_f32_16x16x32_bf16 v[164:167], a[176:179], a[68:71], v[164:167]
    buffer_load_dwordx4 v28, s[28:31], s65 offen offset:1024 lds
    v_mfma_f32_16x16x32_bf16 v[168:171], a[180:183], a[68:71], v[168:171]
    ds_read_b64_tr_b16 a[78:79], v8 offset:25600
    v_mfma_f32_16x16x32_bf16 v[132:135], a[180:183], a[64:67], v[132:135]
    v_mfma_f32_16x16x32_bf16 v[136:139], a[184:187], a[64:67], v[136:139]
    v_mfma_f32_16x16x32_bf16 v[172:175], a[184:187], a[68:71], v[172:175]
    s_waitcnt vmcnt(8) lgkmcnt(0)
    s_barrier
    v_mfma_f32_16x16x32_bf16 v[224:227], a[76:79], a[192:195], v[224:227]
    s_add_u32 m0, s70, 12288
    v_mfma_f32_16x16x32_bf16 v[192:195], a[72:75], a[192:195], v[192:195]
    s_add_u32 s65, s74, s59
    buffer_load_dwordx4 v3, s[28:31], s65 offen lds
    ds_read_b128 a[168:171], v9 offset:0
    v_mfma_f32_16x16x32_bf16 v[196:199], a[72:75], a[196:199], v[196:199]
    s_add_u32 m0, s70, 13312
    ds_read_b128 a[172:175], v9 offset:2048
    v_mfma_f32_16x16x32_bf16 v[228:231], a[76:79], a[196:199], v[228:231]
    s_add_u32 s65, s75, s59
    v_mfma_f32_16x16x32_bf16 v[232:235], a[76:79], a[200:203], v[232:235]
    buffer_load_dwordx4 v4, s[28:31], s65 offen lds
    ds_read_b128 a[176:179], v9 offset:4096
    v_mfma_f32_16x16x32_bf16 v[200:203], a[72:75], a[200:203], v[200:203]
    s_add_u32 m0, s77, 12288
    ds_read_b128 a[180:183], v9 offset:6144
    v_mfma_f32_16x16x32_bf16 v[204:207], a[72:75], a[204:207], v[204:207]
    s_add_u32 s65, s76, s59
    v_mfma_f32_16x16x32_bf16 v[236:239], a[76:79], a[204:207], v[236:239]
    buffer_load_dwordx4 v3, s[28:31], s65 offen lds
    ds_read_b128 a[184:187], v9 offset:8192
    v_mfma_f32_16x16x32_bf16 v[48:51], a[80:83], a[188:191], v[48:51]
    s_add_u32 m0, s69, 49152
    ds_read_b64_tr_b16 a[104:105], v5 offset:8192
    v_mfma_f32_16x16x32_bf16 v[84:87], a[84:87], a[188:191], v[84:87]
    s_mul_i32 s71, s59, 1344
    v_mfma_f32_16x16x32_bf16 v[88:91], a[84:87], a[192:195], v[88:91]
    buffer_load_dwordx4 v1, s[32:35], s71 offen offset:0 lds
    ds_read_b64_tr_b16 a[106:107], v5 offset:9216
    v_mfma_f32_16x16x32_bf16 v[52:55], a[80:83], a[192:195], v[52:55]
    ds_read_b64_tr_b16 a[108:109], v6 offset:8192
    v_mfma_f32_16x16x32_bf16 v[56:59], a[80:83], a[196:199], v[56:59]
    ds_read_b64_tr_b16 a[110:111], v6 offset:9216
    v_mfma_f32_16x16x32_bf16 v[92:95], a[84:87], a[196:199], v[92:95]
    buffer_load_dwordx4 v2, s[32:35], s71 offen offset:1024 lds
    v_mfma_f32_16x16x32_bf16 v[96:99], a[84:87], a[200:203], v[96:99]
    s_add_u32 m0, s69, 57344
    ds_read_b64_tr_b16 a[112:113], v5 offset:16384
    v_mfma_f32_16x16x32_bf16 v[60:63], a[80:83], a[200:203], v[60:63]
    s_add_u32 s71, s71, 896
    ds_read_b64_tr_b16 a[114:115], v5 offset:17408
    v_mfma_f32_16x16x32_bf16 v[64:67], a[80:83], a[204:207], v[64:67]
    buffer_load_dwordx4 v1, s[32:35], s71 offen offset:0 lds
    v_mfma_f32_16x16x32_bf16 v[100:103], a[84:87], a[204:207], v[100:103]
    ds_read_b64_tr_b16 a[116:117], v6 offset:16384
    v_mfma_f32_16x16x32_bf16 v[120:123], a[188:191], a[88:91], v[120:123]
    ds_read_b64_tr_b16 a[118:119], v6 offset:17408
    v_mfma_f32_16x16x32_bf16 v[156:159], a[188:191], a[92:95], v[156:159]
    buffer_load_dwordx4 v2, s[32:35], s71 offen offset:1024 lds
    v_mfma_f32_16x16x32_bf16 v[160:163], a[192:195], a[92:95], v[160:163]
    s_add_u32 m0, s69, 65536
    ds_read_b64_tr_b16 a[96:97], v5 offset:0
    v_mfma_f32_16x16x32_bf16 v[124:127], a[192:195], a[88:91], v[124:127]
    s_add_u32 s71, s71, 896
    ds_read_b64_tr_b16 a[98:99], v5 offset:1024
    v_mfma_f32_16x16x32_bf16 v[128:131], a[196:199], a[88:91], v[128:131]
    buffer_load_dwordx4 v1, s[32:35], s71 offen offset:0 lds
    ds_read_b64_tr_b16 a[100:101], v6 offset:0
    v_mfma_f32_16x16x32_bf16 v[164:167], a[196:199], a[92:95], v[164:167]
    v_mfma_f32_16x16x32_bf16 v[168:171], a[200:203], a[92:95], v[168:171]
    ds_read_b64_tr_b16 a[102:103], v6 offset:1024
    v_mfma_f32_16x16x32_bf16 v[132:135], a[200:203], a[88:91], v[132:135]
    buffer_load_dwordx4 v2, s[32:35], s71 offen offset:1024 lds
    v_mfma_f32_16x16x32_bf16 v[136:139], a[204:207], a[88:91], v[136:139]
    v_mfma_f32_16x16x32_bf16 v[172:175], a[204:207], a[92:95], v[172:175]
    s_waitcnt vmcnt(9) lgkmcnt(0)
    s_barrier
    v_mfma_f32_16x16x32_bf16 v[224:227], a[100:103], a[172:175], v[224:227]
    s_add_u32 m0, s69, 73728
    v_mfma_f32_16x16x32_bf16 v[192:195], a[96:99], a[172:175], v[192:195]
    s_mul_i32 s71, s59, 1344
    ds_read_b128 a[188:191], v10 offset:0
    v_mfma_f32_16x16x32_bf16 v[196:199], a[96:99], a[176:179], v[196:199]
    s_add_u32 s71, s71, 86016
    buffer_load_dwordx4 v1, s[32:35], s71 offen offset:0 lds
    ds_read_b128 a[192:195], v10 offset:2048
    v_mfma_f32_16x16x32_bf16 v[228:231], a[100:103], a[176:179], v[228:231]
    ds_read_b128 a[196:199], v10 offset:4096
    v_mfma_f32_16x16x32_bf16 v[232:235], a[100:103], a[180:183], v[232:235]
    ds_read_b128 a[200:203], v10 offset:6144
    v_mfma_f32_16x16x32_bf16 v[200:203], a[96:99], a[180:183], v[200:203]
    buffer_load_dwordx4 v2, s[32:35], s71 offen offset:1024 lds
    ds_read_b128 a[204:207], v10 offset:8192
    v_mfma_f32_16x16x32_bf16 v[204:207], a[96:99], a[184:187], v[204:207]
    s_add_u32 m0, s69, 81920
    ds_read_b64_tr_b16 a[128:129], v5 offset:32768
    v_mfma_f32_16x16x32_bf16 v[236:239], a[100:103], a[184:187], v[236:239]
    s_add_u32 s71, s71, 896
    v_mfma_f32_16x16x32_bf16 v[48:51], a[104:107], a[168:171], v[48:51]
    buffer_load_dwordx4 v1, s[32:35], s71 offen offset:0 lds
    ds_read_b64_tr_b16 a[130:131], v5 offset:33792
    v_mfma_f32_16x16x32_bf16 v[84:87], a[108:111], a[168:171], v[84:87]
    ds_read_b64_tr_b16 a[132:133], v6 offset:32768
    v_mfma_f32_16x16x32_bf16 v[88:91], a[108:111], a[172:175], v[88:91]
    ds_read_b64_tr_b16 a[134:135], v6 offset:33792
    v_mfma_f32_16x16x32_bf16 v[52:55], a[104:107], a[172:175], v[52:55]
    buffer_load_dwordx4 v2, s[32:35], s71 offen offset:1024 lds
    ds_read_b64_tr_b16 a[136:137], v5 offset:40960
    v_mfma_f32_16x16x32_bf16 v[56:59], a[104:107], a[176:179], v[56:59]
    s_add_u32 m0, s69, 90112
    ds_read_b64_tr_b16 a[138:139], v5 offset:41984
    v_mfma_f32_16x16x32_bf16 v[92:95], a[108:111], a[176:179], v[92:95]
    s_add_u32 s71, s71, 896
    ds_read_b64_tr_b16 a[140:141], v6 offset:40960
    v_mfma_f32_16x16x32_bf16 v[96:99], a[108:111], a[180:183], v[96:99]
    buffer_load_dwordx4 v1, s[32:35], s71 offen offset:0 lds
    v_mfma_f32_16x16x32_bf16 v[60:63], a[104:107], a[180:183], v[60:63]
    ds_read_b64_tr_b16 a[142:143], v6 offset:41984
    v_mfma_f32_16x16x32_bf16 v[64:67], a[104:107], a[184:187], v[64:67]
    ds_read_b64_tr_b16 a[120:121], v5 offset:24576
    v_mfma_f32_16x16x32_bf16 v[100:103], a[108:111], a[184:187], v[100:103]
    buffer_load_dwordx4 v2, s[32:35], s71 offen offset:1024 lds
    ds_read_b64_tr_b16 a[122:123], v5 offset:25600
    v_mfma_f32_16x16x32_bf16 v[120:123], a[168:171], a[112:115], v[120:123]
    s_add_u32 m0, s68, 8192
    ds_read_b64_tr_b16 a[124:125], v6 offset:24576
    v_mfma_f32_16x16x32_bf16 v[156:159], a[168:171], a[116:119], v[156:159]
    s_add_u32 s65, s78, s57
    ds_read_b64_tr_b16 a[126:127], v6 offset:25600
    v_mfma_f32_16x16x32_bf16 v[160:163], a[172:175], a[116:119], v[160:163]
    buffer_load_dwordx4 v27, s[28:31], s65 offen offset:0 lds
    ds_read_b128 a[208:211], v9 offset:24576
    v_mfma_f32_16x16x32_bf16 v[124:127], a[172:175], a[112:115], v[124:127]
    v_mfma_f32_16x16x32_bf16 v[128:131], a[176:179], a[112:115], v[128:131]
    ds_read_b128 a[212:215], v9 offset:26624
    v_mfma_f32_16x16x32_bf16 v[164:167], a[176:179], a[116:119], v[164:167]
    buffer_load_dwordx4 v28, s[28:31], s65 offen offset:1024 lds
    ds_read_b128 a[216:219], v9 offset:28672
    v_mfma_f32_16x16x32_bf16 v[168:171], a[180:183], a[116:119], v[168:171]
    ds_read_b128 a[220:223], v9 offset:30720
    v_mfma_f32_16x16x32_bf16 v[132:135], a[180:183], a[112:115], v[132:135]
    v_mfma_f32_16x16x32_bf16 v[136:139], a[184:187], a[112:115], v[136:139]
    v_mfma_f32_16x16x32_bf16 v[172:175], a[184:187], a[116:119], v[172:175]
    s_waitcnt vmcnt(8) lgkmcnt(0)
    s_barrier
    v_mfma_f32_16x16x32_bf16 v[224:227], a[124:127], a[192:195], v[224:227]
    s_add_u32 m0, s70, 0
    v_mfma_f32_16x16x32_bf16 v[192:195], a[120:123], a[192:195], v[192:195]
    s_add_u32 s65, s74, s60
    buffer_load_dwordx4 v3, s[28:31], s65 offen lds
    v_mfma_f32_16x16x32_bf16 v[196:199], a[120:123], a[196:199], v[196:199]
    s_add_u32 m0, s70, 1024
    ds_read_b128 a[168:171], v9 offset:12288
    v_mfma_f32_16x16x32_bf16 v[228:231], a[124:127], a[196:199], v[228:231]
    s_add_u32 s65, s75, s60
    v_mfma_f32_16x16x32_bf16 v[232:235], a[124:127], a[200:203], v[232:235]
    buffer_load_dwordx4 v4, s[28:31], s65 offen lds
    ds_read_b128 a[172:175], v9 offset:14336
    v_mfma_f32_16x16x32_bf16 v[200:203], a[120:123], a[200:203], v[200:203]
    s_add_u32 m0, s77, 0
    v_mfma_f32_16x16x32_bf16 v[204:207], a[120:123], a[204:207], v[204:207]
    s_add_u32 s65, s76, s60
    ds_read_b128 a[176:179], v9 offset:16384
    v_mfma_f32_16x16x32_bf16 v[236:239], a[124:127], a[204:207], v[236:239]
    buffer_load_dwordx4 v3, s[28:31], s65 offen lds
    v_mfma_f32_16x16x32_bf16 v[48:51], a[128:131], a[188:191], v[48:51]
    s_add_u32 m0, s69, 0
    ds_read_b128 a[180:183], v9 offset:18432
    v_mfma_f32_16x16x32_bf16 v[84:87], a[132:135], a[188:191], v[84:87]
    s_mul_i32 s71, s60, 1344
    v_mfma_f32_16x16x32_bf16 v[88:91], a[132:135], a[192:195], v[88:91]
    buffer_load_dwordx4 v1, s[32:35], s71 offen offset:0 lds
    ds_read_b128 a[184:187], v9 offset:20480
    v_mfma_f32_16x16x32_bf16 v[52:55], a[128:131], a[192:195], v[52:55]
    v_mfma_f32_16x16x32_bf16 v[56:59], a[128:131], a[196:199], v[56:59]
    ds_read_b64_tr_b16 a[152:153], v7 offset:8192
    v_mfma_f32_16x16x32_bf16 v[92:95], a[132:135], a[196:199], v[92:95]
    buffer_load_dwordx4 v2, s[32:35], s71 offen offset:1024 lds
    v_mfma_f32_16x16x32_bf16 v[96:99], a[132:135], a[200:203], v[96:99]
    s_add_u32 m0, s69, 8192
    v_mfma_f32_16x16x32_bf16 v[60:63], a[128:131], a[200:203], v[60:63]
    s_add_u32 s71, s71, 896
    ds_read_b64_tr_b16 a[154:155], v7 offset:9216
    v_mfma_f32_16x16x32_bf16 v[64:67], a[128:131], a[204:207], v[64:67]
    buffer_load_dwordx4 v1, s[32:35], s71 offen offset:0 lds
    v_mfma_f32_16x16x32_bf16 v[100:103], a[132:135], a[204:207], v[100:103]
    ds_read_b64_tr_b16 a[156:157], v8 offset:8192
    v_mfma_f32_16x16x32_bf16 v[120:123], a[188:191], a[136:139], v[120:123]
    v_mfma_f32_16x16x32_bf16 v[156:159], a[188:191], a[140:143], v[156:159]
    buffer_load_dwordx4 v2, s[32:35], s71 offen offset:1024 lds
    ds_read_b64_tr_b16 a[158:159], v8 offset:9216
    v_mfma_f32_16x16x32_bf16 v[160:163], a[192:195], a[140:143], v[160:163]
    s_add_u32 m0, s69, 16384
    v_mfma_f32_16x16x32_bf16 v[124:127], a[192:195], a[136:139], v[124:127]
    s_add_u32 s71, s71, 896
    ds_read_b64_tr_b16 a[160:161], v7 offset:16384
    v_mfma_f32_16x16x32_bf16 v[128:131], a[196:199], a[136:139], v[128:131]
    buffer_load_dwordx4 v1, s[32:35], s71 offen offset:0 lds
    v_mfma_f32_16x16x32_bf16 v[164:167], a[196:199], a[140:143], v[164:167]
    ds_read_b64_tr_b16 a[162:163], v7 offset:17408
    v_mfma_f32_16x16x32_bf16 v[168:171], a[200:203], a[140:143], v[168:171]
    v_mfma_f32_16x16x32_bf16 v[132:135], a[200:203], a[136:139], v[132:135]
    buffer_load_dwordx4 v2, s[32:35], s71 offen offset:1024 lds
    ds_read_b64_tr_b16 a[164:165], v8 offset:16384
    v_mfma_f32_16x16x32_bf16 v[136:139], a[204:207], a[136:139], v[136:139]
    v_mfma_f32_16x16x32_bf16 v[172:175], a[204:207], a[140:143], v[172:175]
    ds_read_b64_tr_b16 a[166:167], v8 offset:17408
    v_mfma_f32_16x16x32_bf16 v[240:243], a[4:7], a[208:211], 0
    v_mfma_f32_16x16x32_bf16 v[208:211], a[0:3], a[208:211], 0
    v_mfma_f32_16x16x32_bf16 v[212:215], a[0:3], a[212:215], 0
    ds_read_b64_tr_b16 a[144:145], v7 offset:0
    v_mfma_f32_16x16x32_bf16 v[244:247], a[4:7], a[212:215], 0
    v_mfma_f32_16x16x32_bf16 v[248:251], a[4:7], a[216:219], 0
    ds_read_b64_tr_b16 a[146:147], v7 offset:1024
    v_mfma_f32_16x16x32_bf16 v[216:219], a[0:3], a[216:219], 0
    v_mfma_f32_16x16x32_bf16 v[220:223], a[0:3], a[220:223], 0
    ds_read_b64_tr_b16 a[148:149], v8 offset:0
    v_mfma_f32_16x16x32_bf16 v[252:255], a[4:7], a[220:223], 0
    v_mfma_f32_16x16x32_bf16 v[104:107], a[12:15], a[208:211], 0
    ds_read_b64_tr_b16 a[150:151], v8 offset:1024
    v_mfma_f32_16x16x32_bf16 v[68:71], a[8:11], a[208:211], 0
    v_mfma_f32_16x16x32_bf16 v[72:75], a[8:11], a[212:215], 0
    ds_read_b128 a[224:227], v10 offset:24576
    v_mfma_f32_16x16x32_bf16 v[108:111], a[12:15], a[212:215], 0
    v_mfma_f32_16x16x32_bf16 v[112:115], a[12:15], a[216:219], 0
    ds_read_b128 a[228:231], v10 offset:26624
    v_mfma_f32_16x16x32_bf16 v[76:79], a[8:11], a[216:219], 0
    v_mfma_f32_16x16x32_bf16 v[80:83], a[8:11], a[220:223], 0
    v_mfma_f32_16x16x32_bf16 v[116:119], a[12:15], a[220:223], 0
    ds_read_b128 a[232:235], v10 offset:28672
    v_mfma_f32_16x16x32_bf16 v[176:179], a[208:211], a[20:23], 0
    v_mfma_f32_16x16x32_bf16 v[140:143], a[208:211], a[16:19], 0
    ds_read_b128 a[236:239], v10 offset:30720
    v_mfma_f32_16x16x32_bf16 v[144:147], a[212:215], a[16:19], 0
    v_mfma_f32_16x16x32_bf16 v[180:183], a[212:215], a[20:23], 0
    v_mfma_f32_16x16x32_bf16 v[184:187], a[216:219], a[20:23], 0
    v_mfma_f32_16x16x32_bf16 v[148:151], a[216:219], a[16:19], 0
    v_mfma_f32_16x16x32_bf16 v[152:155], a[220:223], a[16:19], 0
    v_mfma_f32_16x16x32_bf16 v[188:191], a[220:223], a[20:23], 0
    s_waitcnt vmcnt(9) lgkmcnt(0)
    s_barrier
    v_mfma_f32_16x16x32_bf16 v[224:227], a[148:151], a[172:175], v[224:227]
    s_add_u32 m0, s69, 24576
    v_mfma_f32_16x16x32_bf16 v[192:195], a[144:147], a[172:175], v[192:195]
    s_mul_i32 s71, s60, 1344
    v_mfma_f32_16x16x32_bf16 v[196:199], a[144:147], a[176:179], v[196:199]
    s_add_u32 s71, s71, 86016
    buffer_load_dwordx4 v1, s[32:35], s71 offen offset:0 lds
    ds_read_b128 a[188:191], v10 offset:12288
    v_mfma_f32_16x16x32_bf16 v[228:231], a[148:151], a[176:179], v[228:231]
    v_mfma_f32_16x16x32_bf16 v[232:235], a[148:151], a[180:183], v[232:235]
    ds_read_b128 a[192:195], v10 offset:14336
    v_mfma_f32_16x16x32_bf16 v[200:203], a[144:147], a[180:183], v[200:203]
    buffer_load_dwordx4 v2, s[32:35], s71 offen offset:1024 lds
    v_mfma_f32_16x16x32_bf16 v[204:207], a[144:147], a[184:187], v[204:207]
    s_add_u32 m0, s69, 32768
    ds_read_b128 a[196:199], v10 offset:16384
    v_mfma_f32_16x16x32_bf16 v[236:239], a[148:151], a[184:187], v[236:239]
    s_add_u32 s71, s71, 896
    v_mfma_f32_16x16x32_bf16 v[48:51], a[152:155], a[168:171], v[48:51]
    buffer_load_dwordx4 v1, s[32:35], s71 offen offset:0 lds
    ds_read_b128 a[200:203], v10 offset:18432
    v_mfma_f32_16x16x32_bf16 v[84:87], a[156:159], a[168:171], v[84:87]
    v_mfma_f32_16x16x32_bf16 v[88:91], a[156:159], a[172:175], v[88:91]
    ds_read_b128 a[204:207], v10 offset:20480
    v_mfma_f32_16x16x32_bf16 v[52:55], a[152:155], a[172:175], v[52:55]
    buffer_load_dwordx4 v2, s[32:35], s71 offen offset:1024 lds
    v_mfma_f32_16x16x32_bf16 v[56:59], a[152:155], a[176:179], v[56:59]
    s_add_u32 m0, s69, 40960
    ds_read_b64_tr_b16 a[8:9], v7 offset:32768
    v_mfma_f32_16x16x32_bf16 v[92:95], a[156:159], a[176:179], v[92:95]
    s_add_u32 s71, s71, 896
    v_mfma_f32_16x16x32_bf16 v[96:99], a[156:159], a[180:183], v[96:99]
    buffer_load_dwordx4 v1, s[32:35], s71 offen offset:0 lds
    v_mfma_f32_16x16x32_bf16 v[60:63], a[152:155], a[180:183], v[60:63]
    ds_read_b64_tr_b16 a[10:11], v7 offset:33792
    v_mfma_f32_16x16x32_bf16 v[64:67], a[152:155], a[184:187], v[64:67]
    v_mfma_f32_16x16x32_bf16 v[100:103], a[156:159], a[184:187], v[100:103]
    buffer_load_dwordx4 v2, s[32:35], s71 offen offset:1024 lds
    ds_read_b64_tr_b16 a[12:13], v8 offset:32768
    v_mfma_f32_16x16x32_bf16 v[120:123], a[168:171], a[160:163], v[120:123]
    s_add_u32 m0, s68, 0
    v_mfma_f32_16x16x32_bf16 v[156:159], a[168:171], a[164:167], v[156:159]
    s_add_u32 s65, s78, s58
    ds_read_b64_tr_b16 a[14:15], v8 offset:33792
    v_mfma_f32_16x16x32_bf16 v[160:163], a[172:175], a[164:167], v[160:163]
    buffer_load_dwordx4 v27, s[28:31], s65 offen offset:0 lds
    v_mfma_f32_16x16x32_bf16 v[124:127], a[172:175], a[160:163], v[124:127]
    ds_read_b64_tr_b16 a[16:17], v7 offset:40960
    v_mfma_f32_16x16x32_bf16 v[128:131], a[176:179], a[160:163], v[128:131]
    v_mfma_f32_16x16x32_bf16 v[164:167], a[176:179], a[164:167], v[164:167]
    buffer_load_dwordx4 v28, s[28:31], s65 offen offset:1024 lds
    ds_read_b64_tr_b16 a[18:19], v7 offset:41984
    v_mfma_f32_16x16x32_bf16 v[168:171], a[180:183], a[164:167], v[168:171]
    v_mfma_f32_16x16x32_bf16 v[132:135], a[180:183], a[160:163], v[132:135]
    ds_read_b64_tr_b16 a[20:21], v8 offset:40960
    v_mfma_f32_16x16x32_bf16 v[136:139], a[184:187], a[160:163], v[136:139]
    v_mfma_f32_16x16x32_bf16 v[172:175], a[184:187], a[164:167], v[172:175]
    ds_read_b64_tr_b16 a[22:23], v8 offset:41984
    v_mfma_f32_16x16x32_bf16 v[240:243], a[28:31], a[224:227], v[240:243]
    v_mfma_f32_16x16x32_bf16 v[208:211], a[24:27], a[224:227], v[208:211]
    v_mfma_f32_16x16x32_bf16 v[212:215], a[24:27], a[228:231], v[212:215]
    ds_read_b64_tr_b16 a[0:1], v7 offset:24576
    v_mfma_f32_16x16x32_bf16 v[244:247], a[28:31], a[228:231], v[244:247]
    v_mfma_f32_16x16x32_bf16 v[248:251], a[28:31], a[232:235], v[248:251]
    ds_read_b64_tr_b16 a[2:3], v7 offset:25600
    v_mfma_f32_16x16x32_bf16 v[216:219], a[24:27], a[232:235], v[216:219]
    v_mfma_f32_16x16x32_bf16 v[220:223], a[24:27], a[236:239], v[220:223]
    ds_read_b64_tr_b16 a[4:5], v8 offset:24576
    v_mfma_f32_16x16x32_bf16 v[252:255], a[28:31], a[236:239], v[252:255]
    v_mfma_f32_16x16x32_bf16 v[104:107], a[36:39], a[224:227], v[104:107]
    ds_read_b64_tr_b16 a[6:7], v8 offset:25600
    v_mfma_f32_16x16x32_bf16 v[68:71], a[32:35], a[224:227], v[68:71]
    v_mfma_f32_16x16x32_bf16 v[72:75], a[32:35], a[228:231], v[72:75]
    ds_read_b128 a[208:211], v9 offset:32768
    v_mfma_f32_16x16x32_bf16 v[108:111], a[36:39], a[228:231], v[108:111]
    v_mfma_f32_16x16x32_bf16 v[112:115], a[36:39], a[232:235], v[112:115]
    ds_read_b128 a[212:215], v9 offset:34816
    v_mfma_f32_16x16x32_bf16 v[76:79], a[32:35], a[232:235], v[76:79]
    v_mfma_f32_16x16x32_bf16 v[80:83], a[32:35], a[236:239], v[80:83]
    v_mfma_f32_16x16x32_bf16 v[116:119], a[36:39], a[236:239], v[116:119]
    ds_read_b128 a[216:219], v9 offset:36864
    v_mfma_f32_16x16x32_bf16 v[176:179], a[224:227], a[44:47], v[176:179]
    v_mfma_f32_16x16x32_bf16 v[140:143], a[224:227], a[40:43], v[140:143]
    ds_read_b128 a[220:223], v9 offset:38912
    v_mfma_f32_16x16x32_bf16 v[144:147], a[228:231], a[40:43], v[144:147]
    v_mfma_f32_16x16x32_bf16 v[180:183], a[228:231], a[44:47], v[180:183]
    v_mfma_f32_16x16x32_bf16 v[184:187], a[232:235], a[44:47], v[184:187]
    v_mfma_f32_16x16x32_bf16 v[148:151], a[232:235], a[40:43], v[148:151]
    v_mfma_f32_16x16x32_bf16 v[152:155], a[236:239], a[40:43], v[152:155]
    v_mfma_f32_16x16x32_bf16 v[188:191], a[236:239], a[44:47], v[188:191]
    s_waitcnt vmcnt(8) lgkmcnt(0)
    s_barrier
    v_mfma_f32_16x16x32_bf16 v[224:227], a[4:7], a[192:195], v[224:227]
    s_add_u32 m0, s70, 12288
    v_mfma_f32_16x16x32_bf16 v[192:195], a[0:3], a[192:195], v[192:195]
    s_add_u32 s65, s74, s61
    buffer_load_dwordx4 v3, s[28:31], s65 offen lds
    v_mfma_f32_16x16x32_bf16 v[196:199], a[0:3], a[196:199], v[196:199]
    s_add_u32 m0, s70, 13312
    ds_read_b128 a[168:171], v9 offset:0
    v_mfma_f32_16x16x32_bf16 v[228:231], a[4:7], a[196:199], v[228:231]
    s_add_u32 s65, s75, s61
    v_mfma_f32_16x16x32_bf16 v[232:235], a[4:7], a[200:203], v[232:235]
    buffer_load_dwordx4 v4, s[28:31], s65 offen lds
    ds_read_b128 a[172:175], v9 offset:2048
    v_mfma_f32_16x16x32_bf16 v[200:203], a[0:3], a[200:203], v[200:203]
    s_add_u32 m0, s77, 12288
    v_mfma_f32_16x16x32_bf16 v[204:207], a[0:3], a[204:207], v[204:207]
    s_add_u32 s65, s76, s61
    ds_read_b128 a[176:179], v9 offset:4096
    v_mfma_f32_16x16x32_bf16 v[236:239], a[4:7], a[204:207], v[236:239]
    buffer_load_dwordx4 v3, s[28:31], s65 offen lds
    v_mfma_f32_16x16x32_bf16 v[48:51], a[8:11], a[188:191], v[48:51]
    s_add_u32 m0, s69, 49152
    ds_read_b128 a[180:183], v9 offset:6144
    v_mfma_f32_16x16x32_bf16 v[84:87], a[12:15], a[188:191], v[84:87]
    s_mul_i32 s71, s61, 1344
    v_mfma_f32_16x16x32_bf16 v[88:91], a[12:15], a[192:195], v[88:91]
    buffer_load_dwordx4 v1, s[32:35], s71 offen offset:0 lds
    ds_read_b128 a[184:187], v9 offset:8192
    v_mfma_f32_16x16x32_bf16 v[52:55], a[8:11], a[192:195], v[52:55]
    v_mfma_f32_16x16x32_bf16 v[56:59], a[8:11], a[196:199], v[56:59]
    ds_read_b64_tr_b16 a[32:33], v5 offset:8192
    v_mfma_f32_16x16x32_bf16 v[92:95], a[12:15], a[196:199], v[92:95]
    buffer_load_dwordx4 v2, s[32:35], s71 offen offset:1024 lds
    v_mfma_f32_16x16x32_bf16 v[96:99], a[12:15], a[200:203], v[96:99]
    s_add_u32 m0, s69, 57344
    v_mfma_f32_16x16x32_bf16 v[60:63], a[8:11], a[200:203], v[60:63]
    s_add_u32 s71, s71, 896
    ds_read_b64_tr_b16 a[34:35], v5 offset:9216
    v_mfma_f32_16x16x32_bf16 v[64:67], a[8:11], a[204:207], v[64:67]
    buffer_load_dwordx4 v1, s[32:35], s71 offen offset:0 lds
    v_mfma_f32_16x16x32_bf16 v[100:103], a[12:15], a[204:207], v[100:103]
    ds_read_b64_tr_b16 a[36:37], v6 offset:8192
    v_mfma_f32_16x16x32_bf16 v[120:123], a[188:191], a[16:19], v[120:123]
    v_mfma_f32_16x16x32_bf16 v[156:159], a[188:191], a[20:23], v[156:159]
    buffer_load_dwordx4 v2, s[32:35], s71 offen offset:1024 lds
    ds_read_b64_tr_b16 a[38:39], v6 offset:9216
    v_mfma_f32_16x16x32_bf16 v[160:163], a[192:195], a[20:23], v[160:163]
    s_add_u32 m0, s69, 65536
    v_mfma_f32_16x16x32_bf16 v[124:127], a[192:195], a[16:19], v[124:127]
    s_add_u32 s71, s71, 896
    ds_read_b64_tr_b16 a[40:41], v5 offset:16384
    v_mfma_f32_16x16x32_bf16 v[128:131], a[196:199], a[16:19], v[128:131]
    buffer_load_dwordx4 v1, s[32:35], s71 offen offset:0 lds
    v_mfma_f32_16x16x32_bf16 v[164:167], a[196:199], a[20:23], v[164:167]
    ds_read_b64_tr_b16 a[42:43], v5 offset:17408
    v_mfma_f32_16x16x32_bf16 v[168:171], a[200:203], a[20:23], v[168:171]
    v_mfma_f32_16x16x32_bf16 v[132:135], a[200:203], a[16:19], v[132:135]
    buffer_load_dwordx4 v2, s[32:35], s71 offen offset:1024 lds
    ds_read_b64_tr_b16 a[44:45], v6 offset:16384
    v_mfma_f32_16x16x32_bf16 v[136:139], a[204:207], a[16:19], v[136:139]
    v_mfma_f32_16x16x32_bf16 v[172:175], a[204:207], a[20:23], v[172:175]
    ds_read_b64_tr_b16 a[46:47], v6 offset:17408
    v_mfma_f32_16x16x32_bf16 v[240:243], a[52:55], a[208:211], v[240:243]
    v_mfma_f32_16x16x32_bf16 v[208:211], a[48:51], a[208:211], v[208:211]
    v_mfma_f32_16x16x32_bf16 v[212:215], a[48:51], a[212:215], v[212:215]
    ds_read_b64_tr_b16 a[24:25], v5 offset:0
    v_mfma_f32_16x16x32_bf16 v[244:247], a[52:55], a[212:215], v[244:247]
    v_mfma_f32_16x16x32_bf16 v[248:251], a[52:55], a[216:219], v[248:251]
    ds_read_b64_tr_b16 a[26:27], v5 offset:1024
    v_mfma_f32_16x16x32_bf16 v[216:219], a[48:51], a[216:219], v[216:219]
    v_mfma_f32_16x16x32_bf16 v[220:223], a[48:51], a[220:223], v[220:223]
    ds_read_b64_tr_b16 a[28:29], v6 offset:0
    v_mfma_f32_16x16x32_bf16 v[252:255], a[52:55], a[220:223], v[252:255]
    v_mfma_f32_16x16x32_bf16 v[104:107], a[60:63], a[208:211], v[104:107]
    ds_read_b64_tr_b16 a[30:31], v6 offset:1024
    v_mfma_f32_16x16x32_bf16 v[68:71], a[56:59], a[208:211], v[68:71]
    v_mfma_f32_16x16x32_bf16 v[72:75], a[56:59], a[212:215], v[72:75]
    ds_read_b128 a[224:227], v10 offset:32768
    v_mfma_f32_16x16x32_bf16 v[108:111], a[60:63], a[212:215], v[108:111]
    v_mfma_f32_16x16x32_bf16 v[112:115], a[60:63], a[216:219], v[112:115]
    ds_read_b128 a[228:231], v10 offset:34816
    v_mfma_f32_16x16x32_bf16 v[76:79], a[56:59], a[216:219], v[76:79]
    v_mfma_f32_16x16x32_bf16 v[80:83], a[56:59], a[220:223], v[80:83]
    v_mfma_f32_16x16x32_bf16 v[116:119], a[60:63], a[220:223], v[116:119]
    ds_read_b128 a[232:235], v10 offset:36864
    v_mfma_f32_16x16x32_bf16 v[176:179], a[208:211], a[68:71], v[176:179]
    v_mfma_f32_16x16x32_bf16 v[140:143], a[208:211], a[64:67], v[140:143]
    ds_read_b128 a[236:239], v10 offset:38912
    v_mfma_f32_16x16x32_bf16 v[144:147], a[212:215], a[64:67], v[144:147]
    v_mfma_f32_16x16x32_bf16 v[180:183], a[212:215], a[68:71], v[180:183]
    v_mfma_f32_16x16x32_bf16 v[184:187], a[216:219], a[68:71], v[184:187]
    v_mfma_f32_16x16x32_bf16 v[148:151], a[216:219], a[64:67], v[148:151]
    v_mfma_f32_16x16x32_bf16 v[152:155], a[220:223], a[64:67], v[152:155]
    v_mfma_f32_16x16x32_bf16 v[188:191], a[220:223], a[68:71], v[188:191]
    s_waitcnt vmcnt(9) lgkmcnt(0)
    s_barrier
    v_mfma_f32_16x16x32_bf16 v[224:227], a[28:31], a[172:175], v[224:227]
    s_add_u32 m0, s69, 73728
    v_mfma_f32_16x16x32_bf16 v[192:195], a[24:27], a[172:175], v[192:195]
    s_mul_i32 s71, s61, 1344
    v_mfma_f32_16x16x32_bf16 v[196:199], a[24:27], a[176:179], v[196:199]
    s_add_u32 s71, s71, 86016
    buffer_load_dwordx4 v1, s[32:35], s71 offen offset:0 lds
    ds_read_b128 a[188:191], v10 offset:0
    v_mfma_f32_16x16x32_bf16 v[228:231], a[28:31], a[176:179], v[228:231]
    v_mfma_f32_16x16x32_bf16 v[232:235], a[28:31], a[180:183], v[232:235]
    ds_read_b128 a[192:195], v10 offset:2048
    v_mfma_f32_16x16x32_bf16 v[200:203], a[24:27], a[180:183], v[200:203]
    buffer_load_dwordx4 v2, s[32:35], s71 offen offset:1024 lds
    v_mfma_f32_16x16x32_bf16 v[204:207], a[24:27], a[184:187], v[204:207]
    s_add_u32 m0, s69, 81920
    ds_read_b128 a[196:199], v10 offset:4096
    v_mfma_f32_16x16x32_bf16 v[236:239], a[28:31], a[184:187], v[236:239]
    s_add_u32 s71, s71, 896
    v_mfma_f32_16x16x32_bf16 v[48:51], a[32:35], a[168:171], v[48:51]
    buffer_load_dwordx4 v1, s[32:35], s71 offen offset:0 lds
    ds_read_b128 a[200:203], v10 offset:6144
    v_mfma_f32_16x16x32_bf16 v[84:87], a[36:39], a[168:171], v[84:87]
    v_mfma_f32_16x16x32_bf16 v[88:91], a[36:39], a[172:175], v[88:91]
    ds_read_b128 a[204:207], v10 offset:8192
    v_mfma_f32_16x16x32_bf16 v[52:55], a[32:35], a[172:175], v[52:55]
    buffer_load_dwordx4 v2, s[32:35], s71 offen offset:1024 lds
    v_mfma_f32_16x16x32_bf16 v[56:59], a[32:35], a[176:179], v[56:59]
    s_add_u32 m0, s69, 90112
    ds_read_b64_tr_b16 a[56:57], v5 offset:32768
    v_mfma_f32_16x16x32_bf16 v[92:95], a[36:39], a[176:179], v[92:95]
    s_add_u32 s71, s71, 896
    v_mfma_f32_16x16x32_bf16 v[96:99], a[36:39], a[180:183], v[96:99]
    buffer_load_dwordx4 v1, s[32:35], s71 offen offset:0 lds
    v_mfma_f32_16x16x32_bf16 v[60:63], a[32:35], a[180:183], v[60:63]
    ds_read_b64_tr_b16 a[58:59], v5 offset:33792
    v_mfma_f32_16x16x32_bf16 v[64:67], a[32:35], a[184:187], v[64:67]
    v_mfma_f32_16x16x32_bf16 v[100:103], a[36:39], a[184:187], v[100:103]
    buffer_load_dwordx4 v2, s[32:35], s71 offen offset:1024 lds
    ds_read_b64_tr_b16 a[60:61], v6 offset:32768
    v_mfma_f32_16x16x32_bf16 v[120:123], a[168:171], a[40:43], v[120:123]
    s_add_u32 m0, s68, 8192
    v_mfma_f32_16x16x32_bf16 v[156:159], a[168:171], a[44:47], v[156:159]
    s_add_u32 s65, s78, s59
    ds_read_b64_tr_b16 a[62:63], v6 offset:33792
    v_mfma_f32_16x16x32_bf16 v[160:163], a[172:175], a[44:47], v[160:163]
    buffer_load_dwordx4 v27, s[28:31], s65 offen offset:0 lds
    v_mfma_f32_16x16x32_bf16 v[124:127], a[172:175], a[40:43], v[124:127]
    ds_read_b64_tr_b16 a[64:65], v5 offset:40960
    v_mfma_f32_16x16x32_bf16 v[128:131], a[176:179], a[40:43], v[128:131]
    v_mfma_f32_16x16x32_bf16 v[164:167], a[176:179], a[44:47], v[164:167]
    buffer_load_dwordx4 v28, s[28:31], s65 offen offset:1024 lds
    ds_read_b64_tr_b16 a[66:67], v5 offset:41984
    v_mfma_f32_16x16x32_bf16 v[168:171], a[180:183], a[44:47], v[168:171]
    v_mfma_f32_16x16x32_bf16 v[132:135], a[180:183], a[40:43], v[132:135]
    ds_read_b64_tr_b16 a[68:69], v6 offset:40960
    v_mfma_f32_16x16x32_bf16 v[136:139], a[184:187], a[40:43], v[136:139]
    v_mfma_f32_16x16x32_bf16 v[172:175], a[184:187], a[44:47], v[172:175]
    ds_read_b64_tr_b16 a[70:71], v6 offset:41984
    v_mfma_f32_16x16x32_bf16 v[240:243], a[76:79], a[224:227], v[240:243]
    v_mfma_f32_16x16x32_bf16 v[208:211], a[72:75], a[224:227], v[208:211]
    v_mfma_f32_16x16x32_bf16 v[212:215], a[72:75], a[228:231], v[212:215]
    ds_read_b64_tr_b16 a[48:49], v5 offset:24576
    v_mfma_f32_16x16x32_bf16 v[244:247], a[76:79], a[228:231], v[244:247]
    v_mfma_f32_16x16x32_bf16 v[248:251], a[76:79], a[232:235], v[248:251]
    ds_read_b64_tr_b16 a[50:51], v5 offset:25600
    v_mfma_f32_16x16x32_bf16 v[216:219], a[72:75], a[232:235], v[216:219]
    v_mfma_f32_16x16x32_bf16 v[220:223], a[72:75], a[236:239], v[220:223]
    ds_read_b64_tr_b16 a[52:53], v6 offset:24576
    v_mfma_f32_16x16x32_bf16 v[252:255], a[76:79], a[236:239], v[252:255]
    v_mfma_f32_16x16x32_bf16 v[104:107], a[84:87], a[224:227], v[104:107]
    ds_read_b64_tr_b16 a[54:55], v6 offset:25600
    v_mfma_f32_16x16x32_bf16 v[68:71], a[80:83], a[224:227], v[68:71]
    v_mfma_f32_16x16x32_bf16 v[72:75], a[80:83], a[228:231], v[72:75]
    ds_read_b128 a[208:211], v9 offset:24576
    v_mfma_f32_16x16x32_bf16 v[108:111], a[84:87], a[228:231], v[108:111]
    v_mfma_f32_16x16x32_bf16 v[112:115], a[84:87], a[232:235], v[112:115]
    ds_read_b128 a[212:215], v9 offset:26624
    v_mfma_f32_16x16x32_bf16 v[76:79], a[80:83], a[232:235], v[76:79]
    v_mfma_f32_16x16x32_bf16 v[80:83], a[80:83], a[236:239], v[80:83]
    v_mfma_f32_16x16x32_bf16 v[116:119], a[84:87], a[236:239], v[116:119]
    ds_read_b128 a[216:219], v9 offset:28672
    v_mfma_f32_16x16x32_bf16 v[176:179], a[224:227], a[92:95], v[176:179]
    v_mfma_f32_16x16x32_bf16 v[140:143], a[224:227], a[88:91], v[140:143]
    ds_read_b128 a[220:223], v9 offset:30720
    v_mfma_f32_16x16x32_bf16 v[144:147], a[228:231], a[88:91], v[144:147]
    v_mfma_f32_16x16x32_bf16 v[180:183], a[228:231], a[92:95], v[180:183]
    v_mfma_f32_16x16x32_bf16 v[184:187], a[232:235], a[92:95], v[184:187]
    v_mfma_f32_16x16x32_bf16 v[148:151], a[232:235], a[88:91], v[148:151]
    v_mfma_f32_16x16x32_bf16 v[152:155], a[236:239], a[88:91], v[152:155]
    v_mfma_f32_16x16x32_bf16 v[188:191], a[236:239], a[92:95], v[188:191]
    s_waitcnt vmcnt(8) lgkmcnt(0)
    s_barrier
    v_mfma_f32_16x16x32_bf16 v[224:227], a[52:55], a[192:195], v[224:227]
    s_add_u32 m0, s70, 0
    v_mfma_f32_16x16x32_bf16 v[192:195], a[48:51], a[192:195], v[192:195]
    s_add_u32 s65, s74, s62
    buffer_load_dwordx4 v3, s[28:31], s65 offen lds
    v_mfma_f32_16x16x32_bf16 v[196:199], a[48:51], a[196:199], v[196:199]
    s_add_u32 m0, s70, 1024
    ds_read_b128 a[168:171], v9 offset:12288
    v_mfma_f32_16x16x32_bf16 v[228:231], a[52:55], a[196:199], v[228:231]
    s_add_u32 s65, s75, s62
    v_mfma_f32_16x16x32_bf16 v[232:235], a[52:55], a[200:203], v[232:235]
    buffer_load_dwordx4 v4, s[28:31], s65 offen lds
    ds_read_b128 a[172:175], v9 offset:14336
    v_mfma_f32_16x16x32_bf16 v[200:203], a[48:51], a[200:203], v[200:203]
    s_add_u32 m0, s77, 0
    v_mfma_f32_16x16x32_bf16 v[204:207], a[48:51], a[204:207], v[204:207]
    s_add_u32 s65, s76, s62
    ds_read_b128 a[176:179], v9 offset:16384
    v_mfma_f32_16x16x32_bf16 v[236:239], a[52:55], a[204:207], v[236:239]
    buffer_load_dwordx4 v3, s[28:31], s65 offen lds
    v_mfma_f32_16x16x32_bf16 v[48:51], a[56:59], a[188:191], v[48:51]
    s_add_u32 m0, s69, 0
    ds_read_b128 a[180:183], v9 offset:18432
    v_mfma_f32_16x16x32_bf16 v[84:87], a[60:63], a[188:191], v[84:87]
    s_mul_i32 s71, s62, 1344
    v_mfma_f32_16x16x32_bf16 v[88:91], a[60:63], a[192:195], v[88:91]
    buffer_load_dwordx4 v1, s[32:35], s71 offen offset:0 lds
    ds_read_b128 a[184:187], v9 offset:20480
    v_mfma_f32_16x16x32_bf16 v[52:55], a[56:59], a[192:195], v[52:55]
    v_mfma_f32_16x16x32_bf16 v[56:59], a[56:59], a[196:199], v[56:59]
    ds_read_b64_tr_b16 a[80:81], v7 offset:8192
    v_mfma_f32_16x16x32_bf16 v[92:95], a[60:63], a[196:199], v[92:95]
    buffer_load_dwordx4 v2, s[32:35], s71 offen offset:1024 lds
    v_mfma_f32_16x16x32_bf16 v[96:99], a[60:63], a[200:203], v[96:99]
    s_add_u32 m0, s69, 8192
    v_mfma_f32_16x16x32_bf16 v[60:63], a[56:59], a[200:203], v[60:63]
    s_add_u32 s71, s71, 896
    ds_read_b64_tr_b16 a[82:83], v7 offset:9216
    v_mfma_f32_16x16x32_bf16 v[64:67], a[56:59], a[204:207], v[64:67]
    buffer_load_dwordx4 v1, s[32:35], s71 offen offset:0 lds
    v_mfma_f32_16x16x32_bf16 v[100:103], a[60:63], a[204:207], v[100:103]
    ds_read_b64_tr_b16 a[84:85], v8 offset:8192
    v_mfma_f32_16x16x32_bf16 v[120:123], a[188:191], a[64:67], v[120:123]
    v_mfma_f32_16x16x32_bf16 v[156:159], a[188:191], a[68:71], v[156:159]
    buffer_load_dwordx4 v2, s[32:35], s71 offen offset:1024 lds
    ds_read_b64_tr_b16 a[86:87], v8 offset:9216
    v_mfma_f32_16x16x32_bf16 v[160:163], a[192:195], a[68:71], v[160:163]
    s_add_u32 m0, s69, 16384
    v_mfma_f32_16x16x32_bf16 v[124:127], a[192:195], a[64:67], v[124:127]
    s_add_u32 s71, s71, 896
    ds_read_b64_tr_b16 a[88:89], v7 offset:16384
    v_mfma_f32_16x16x32_bf16 v[128:131], a[196:199], a[64:67], v[128:131]
    buffer_load_dwordx4 v1, s[32:35], s71 offen offset:0 lds
    v_mfma_f32_16x16x32_bf16 v[164:167], a[196:199], a[68:71], v[164:167]
    ds_read_b64_tr_b16 a[90:91], v7 offset:17408
    v_mfma_f32_16x16x32_bf16 v[168:171], a[200:203], a[68:71], v[168:171]
    v_mfma_f32_16x16x32_bf16 v[132:135], a[200:203], a[64:67], v[132:135]
    buffer_load_dwordx4 v2, s[32:35], s71 offen offset:1024 lds
    ds_read_b64_tr_b16 a[92:93], v8 offset:16384
    v_mfma_f32_16x16x32_bf16 v[136:139], a[204:207], a[64:67], v[136:139]
    v_mfma_f32_16x16x32_bf16 v[172:175], a[204:207], a[68:71], v[172:175]
    ds_read_b64_tr_b16 a[94:95], v8 offset:17408
    v_mfma_f32_16x16x32_bf16 v[240:243], a[100:103], a[208:211], v[240:243]
    v_mfma_f32_16x16x32_bf16 v[208:211], a[96:99], a[208:211], v[208:211]
    v_mfma_f32_16x16x32_bf16 v[212:215], a[96:99], a[212:215], v[212:215]
    ds_read_b64_tr_b16 a[72:73], v7 offset:0
    v_mfma_f32_16x16x32_bf16 v[244:247], a[100:103], a[212:215], v[244:247]
    v_mfma_f32_16x16x32_bf16 v[248:251], a[100:103], a[216:219], v[248:251]
    ds_read_b64_tr_b16 a[74:75], v7 offset:1024
    v_mfma_f32_16x16x32_bf16 v[216:219], a[96:99], a[216:219], v[216:219]
    v_mfma_f32_16x16x32_bf16 v[220:223], a[96:99], a[220:223], v[220:223]
    ds_read_b64_tr_b16 a[76:77], v8 offset:0
    v_mfma_f32_16x16x32_bf16 v[252:255], a[100:103], a[220:223], v[252:255]
    v_mfma_f32_16x16x32_bf16 v[104:107], a[108:111], a[208:211], v[104:107]
    ds_read_b64_tr_b16 a[78:79], v8 offset:1024
    v_mfma_f32_16x16x32_bf16 v[68:71], a[104:107], a[208:211], v[68:71]
    v_mfma_f32_16x16x32_bf16 v[72:75], a[104:107], a[212:215], v[72:75]
    ds_read_b128 a[224:227], v10 offset:24576
    v_mfma_f32_16x16x32_bf16 v[108:111], a[108:111], a[212:215], v[108:111]
    v_mfma_f32_16x16x32_bf16 v[112:115], a[108:111], a[216:219], v[112:115]
    ds_read_b128 a[228:231], v10 offset:26624
    v_mfma_f32_16x16x32_bf16 v[76:79], a[104:107], a[216:219], v[76:79]
    v_mfma_f32_16x16x32_bf16 v[80:83], a[104:107], a[220:223], v[80:83]
    v_mfma_f32_16x16x32_bf16 v[116:119], a[108:111], a[220:223], v[116:119]
    ds_read_b128 a[232:235], v10 offset:28672
    v_mfma_f32_16x16x32_bf16 v[176:179], a[208:211], a[116:119], v[176:179]
    v_mfma_f32_16x16x32_bf16 v[140:143], a[208:211], a[112:115], v[140:143]
    ds_read_b128 a[236:239], v10 offset:30720
    v_mfma_f32_16x16x32_bf16 v[144:147], a[212:215], a[112:115], v[144:147]
    v_mfma_f32_16x16x32_bf16 v[180:183], a[212:215], a[116:119], v[180:183]
    v_mfma_f32_16x16x32_bf16 v[184:187], a[216:219], a[116:119], v[184:187]
    v_mfma_f32_16x16x32_bf16 v[148:151], a[216:219], a[112:115], v[148:151]
    v_mfma_f32_16x16x32_bf16 v[152:155], a[220:223], a[112:115], v[152:155]
    v_mfma_f32_16x16x32_bf16 v[188:191], a[220:223], a[116:119], v[188:191]
    s_waitcnt vmcnt(9) lgkmcnt(0)
    s_barrier
    v_mfma_f32_16x16x32_bf16 v[224:227], a[76:79], a[172:175], v[224:227]
    s_add_u32 m0, s69, 24576
    v_mfma_f32_16x16x32_bf16 v[192:195], a[72:75], a[172:175], v[192:195]
    s_mul_i32 s71, s62, 1344
    v_mfma_f32_16x16x32_bf16 v[196:199], a[72:75], a[176:179], v[196:199]
    s_add_u32 s71, s71, 86016
    buffer_load_dwordx4 v1, s[32:35], s71 offen offset:0 lds
    ds_read_b128 a[188:191], v10 offset:12288
    v_mfma_f32_16x16x32_bf16 v[228:231], a[76:79], a[176:179], v[228:231]
    v_mfma_f32_16x16x32_bf16 v[232:235], a[76:79], a[180:183], v[232:235]
    ds_read_b128 a[192:195], v10 offset:14336
    v_mfma_f32_16x16x32_bf16 v[200:203], a[72:75], a[180:183], v[200:203]
    buffer_load_dwordx4 v2, s[32:35], s71 offen offset:1024 lds
    v_mfma_f32_16x16x32_bf16 v[204:207], a[72:75], a[184:187], v[204:207]
    s_add_u32 m0, s69, 32768
    ds_read_b128 a[196:199], v10 offset:16384
    v_mfma_f32_16x16x32_bf16 v[236:239], a[76:79], a[184:187], v[236:239]
    s_add_u32 s71, s71, 896
    v_mfma_f32_16x16x32_bf16 v[48:51], a[80:83], a[168:171], v[48:51]
    buffer_load_dwordx4 v1, s[32:35], s71 offen offset:0 lds
    ds_read_b128 a[200:203], v10 offset:18432
    v_mfma_f32_16x16x32_bf16 v[84:87], a[84:87], a[168:171], v[84:87]
    v_mfma_f32_16x16x32_bf16 v[88:91], a[84:87], a[172:175], v[88:91]
    ds_read_b128 a[204:207], v10 offset:20480
    v_mfma_f32_16x16x32_bf16 v[52:55], a[80:83], a[172:175], v[52:55]
    buffer_load_dwordx4 v2, s[32:35], s71 offen offset:1024 lds
    v_mfma_f32_16x16x32_bf16 v[56:59], a[80:83], a[176:179], v[56:59]
    s_add_u32 m0, s69, 40960
    ds_read_b64_tr_b16 a[104:105], v7 offset:32768
    v_mfma_f32_16x16x32_bf16 v[92:95], a[84:87], a[176:179], v[92:95]
    s_add_u32 s71, s71, 896
    v_mfma_f32_16x16x32_bf16 v[96:99], a[84:87], a[180:183], v[96:99]
    buffer_load_dwordx4 v1, s[32:35], s71 offen offset:0 lds
    v_mfma_f32_16x16x32_bf16 v[60:63], a[80:83], a[180:183], v[60:63]
    ds_read_b64_tr_b16 a[106:107], v7 offset:33792
    v_mfma_f32_16x16x32_bf16 v[64:67], a[80:83], a[184:187], v[64:67]
    v_mfma_f32_16x16x32_bf16 v[100:103], a[84:87], a[184:187], v[100:103]
    buffer_load_dwordx4 v2, s[32:35], s71 offen offset:1024 lds
    ds_read_b64_tr_b16 a[108:109], v8 offset:32768
    v_mfma_f32_16x16x32_bf16 v[120:123], a[168:171], a[88:91], v[120:123]
    s_add_u32 m0, s68, 0
    v_mfma_f32_16x16x32_bf16 v[156:159], a[168:171], a[92:95], v[156:159]
    s_add_u32 s65, s78, s60
    ds_read_b64_tr_b16 a[110:111], v8 offset:33792
    v_mfma_f32_16x16x32_bf16 v[160:163], a[172:175], a[92:95], v[160:163]
    buffer_load_dwordx4 v27, s[28:31], s65 offen offset:0 lds
    v_mfma_f32_16x16x32_bf16 v[124:127], a[172:175], a[88:91], v[124:127]
    ds_read_b64_tr_b16 a[112:113], v7 offset:40960
    v_mfma_f32_16x16x32_bf16 v[128:131], a[176:179], a[88:91], v[128:131]
    v_mfma_f32_16x16x32_bf16 v[164:167], a[176:179], a[92:95], v[164:167]
    buffer_load_dwordx4 v28, s[28:31], s65 offen offset:1024 lds
    ds_read_b64_tr_b16 a[114:115], v7 offset:41984
    v_mfma_f32_16x16x32_bf16 v[168:171], a[180:183], a[92:95], v[168:171]
    v_mfma_f32_16x16x32_bf16 v[132:135], a[180:183], a[88:91], v[132:135]
    ds_read_b64_tr_b16 a[116:117], v8 offset:40960
    v_mfma_f32_16x16x32_bf16 v[136:139], a[184:187], a[88:91], v[136:139]
    v_mfma_f32_16x16x32_bf16 v[172:175], a[184:187], a[92:95], v[172:175]
    ds_read_b64_tr_b16 a[118:119], v8 offset:41984
    v_mfma_f32_16x16x32_bf16 v[240:243], a[124:127], a[224:227], v[240:243]
    v_mfma_f32_16x16x32_bf16 v[208:211], a[120:123], a[224:227], v[208:211]
    v_mfma_f32_16x16x32_bf16 v[212:215], a[120:123], a[228:231], v[212:215]
    ds_read_b64_tr_b16 a[96:97], v7 offset:24576
    v_mfma_f32_16x16x32_bf16 v[244:247], a[124:127], a[228:231], v[244:247]
    v_mfma_f32_16x16x32_bf16 v[248:251], a[124:127], a[232:235], v[248:251]
    ds_read_b64_tr_b16 a[98:99], v7 offset:25600
    v_mfma_f32_16x16x32_bf16 v[216:219], a[120:123], a[232:235], v[216:219]
    v_mfma_f32_16x16x32_bf16 v[220:223], a[120:123], a[236:239], v[220:223]
    ds_read_b64_tr_b16 a[100:101], v8 offset:24576
    v_mfma_f32_16x16x32_bf16 v[252:255], a[124:127], a[236:239], v[252:255]
    v_mfma_f32_16x16x32_bf16 v[104:107], a[132:135], a[224:227], v[104:107]
    ds_read_b64_tr_b16 a[102:103], v8 offset:25600
    v_mfma_f32_16x16x32_bf16 v[68:71], a[128:131], a[224:227], v[68:71]
    v_mfma_f32_16x16x32_bf16 v[72:75], a[128:131], a[228:231], v[72:75]
    ds_read_b128 a[208:211], v9 offset:32768
    v_mfma_f32_16x16x32_bf16 v[108:111], a[132:135], a[228:231], v[108:111]
    v_mfma_f32_16x16x32_bf16 v[112:115], a[132:135], a[232:235], v[112:115]
    ds_read_b128 a[212:215], v9 offset:34816
    v_mfma_f32_16x16x32_bf16 v[76:79], a[128:131], a[232:235], v[76:79]
    v_mfma_f32_16x16x32_bf16 v[80:83], a[128:131], a[236:239], v[80:83]
    v_mfma_f32_16x16x32_bf16 v[116:119], a[132:135], a[236:239], v[116:119]
    ds_read_b128 a[216:219], v9 offset:36864
    v_mfma_f32_16x16x32_bf16 v[176:179], a[224:227], a[140:143], v[176:179]
    v_mfma_f32_16x16x32_bf16 v[140:143], a[224:227], a[136:139], v[140:143]
    ds_read_b128 a[220:223], v9 offset:38912
    v_mfma_f32_16x16x32_bf16 v[144:147], a[228:231], a[136:139], v[144:147]
    v_mfma_f32_16x16x32_bf16 v[180:183], a[228:231], a[140:143], v[180:183]
    v_mfma_f32_16x16x32_bf16 v[184:187], a[232:235], a[140:143], v[184:187]
    v_mfma_f32_16x16x32_bf16 v[148:151], a[232:235], a[136:139], v[148:151]
    v_mfma_f32_16x16x32_bf16 v[152:155], a[236:239], a[136:139], v[152:155]
    v_mfma_f32_16x16x32_bf16 v[188:191], a[236:239], a[140:143], v[188:191]
    s_waitcnt vmcnt(8) lgkmcnt(0)
    s_barrier
    v_mfma_f32_16x16x32_bf16 v[224:227], a[100:103], a[192:195], v[224:227]
    v_and_b32 v38, 1, v18
    v_cmp_eq_u32 s[80:81], 1, v38
    v_mfma_f32_16x16x32_bf16 v[192:195], a[96:99], a[192:195], v[192:195]
    v_lshl_add_u32 v38, v17, 2, v38
    v_cmp_le_u32 s[82:83], v38, v18
    v_mfma_f32_16x16x32_bf16 v[196:199], a[96:99], a[196:199], v[196:199]
    ds_read_b128 a[168:171], v9 offset:0
    v_add_u32 v38, 2, v38
    v_mfma_f32_16x16x32_bf16 v[228:231], a[100:103], a[196:199], v[228:231]
    v_cmp_le_u32 s[84:85], v38, v18
    v_mov_b32 v39, 0x0c0c0100
    v_mfma_f32_16x16x32_bf16 v[232:235], a[100:103], a[200:203], v[232:235]
    ds_read_b128 a[172:175], v9 offset:2048
    v_mov_b32 v40, 0x01000c0c
    v_mfma_f32_16x16x32_bf16 v[200:203], a[96:99], a[200:203], v[200:203]
    v_cndmask_b32 v39, v39, v40, s[80:81]
    v_mov_b32 v41, 0x0c0c0302
    v_mfma_f32_16x16x32_bf16 v[204:207], a[96:99], a[204:207], v[204:207]
    ds_read_b128 a[176:179], v9 offset:4096
    v_mov_b32 v40, 0x03020c0c
    v_mfma_f32_16x16x32_bf16 v[236:239], a[100:103], a[204:207], v[236:239]
    v_cndmask_b32 v41, v41, v40, s[80:81]
    v_mov_b32 v40, 0x0c0c0c0c
    v_mfma_f32_16x16x32_bf16 v[48:51], a[104:107], a[188:191], v[48:51]
    ds_read_b128 a[180:183], v9 offset:6144
    v_cndmask_b32 v21, v39, v40, s[82:83]
    v_mfma_f32_16x16x32_bf16 v[84:87], a[108:111], a[188:191], v[84:87]
    v_cndmask_b32 v22, v41, v40, s[84:85]
    v_cndmask_b32 v23, v40, v39, s[82:83]
    v_mfma_f32_16x16x32_bf16 v[88:91], a[108:111], a[192:195], v[88:91]
    ds_read_b128 a[184:187], v9 offset:8192
    v_cndmask_b32 v24, v40, v41, s[84:85]
    v_mfma_f32_16x16x32_bf16 v[52:55], a[104:107], a[192:195], v[52:55]
    v_lshlrev_b32 v26, 4, v0
    v_mfma_f32_16x16x32_bf16 v[56:59], a[104:107], a[196:199], v[56:59]
    s_cmp_eq_u32 s93, 0
    s_cselect_b64 s[86:87], s[82:83], -1
    s_cselect_b64 s[88:89], s[84:85], -1
    v_mfma_f32_16x16x32_bf16 v[92:95], a[108:111], a[196:199], v[92:95]
    s_mov_b32 s92, 0x3e8b97f6
    ds_read_b64_tr_b16 a[128:129], v5 offset:8192
    v_mfma_f32_16x16x32_bf16 v[96:99], a[108:111], a[200:203], v[96:99]
    s_mul_i32 s26, s93, 584
    v_mfma_f32_16x16x32_bf16 v[60:63], a[104:107], a[200:203], v[60:63]
    s_lshl_b32 s27, s79, 2
    ds_read_b64_tr_b16 a[130:131], v5 offset:9216
    v_mfma_f32_16x16x32_bf16 v[64:67], a[104:107], a[204:207], v[64:67]
    s_add_u32 s26, s26, s27
    v_mfma_f32_16x16x32_bf16 v[100:103], a[108:111], a[204:207], v[100:103]
    s_add_u32 s26, s26, s3
    ds_read_b64_tr_b16 a[132:133], v6 offset:8192
    v_mfma_f32_16x16x32_bf16 v[120:123], a[188:191], a[112:115], v[120:123]
    s_add_u32 s26, s26, 56
    v_mfma_f32_16x16x32_bf16 v[156:159], a[188:191], a[116:119], v[156:159]
    s_lshl_b32 s73, s26, 10
    ds_read_b64_tr_b16 a[134:135], v6 offset:9216
    v_mfma_f32_16x16x32_bf16 v[160:163], a[192:195], a[116:119], v[160:163]
    v_mfma_f32_16x16x32_bf16 v[124:127], a[192:195], a[112:115], v[124:127]
    ds_read_b64_tr_b16 a[136:137], v5 offset:16384
    v_mfma_f32_16x16x32_bf16 v[128:131], a[196:199], a[112:115], v[128:131]
    v_mfma_f32_16x16x32_bf16 v[164:167], a[196:199], a[116:119], v[164:167]
    ds_read_b64_tr_b16 a[138:139], v5 offset:17408
    v_mfma_f32_16x16x32_bf16 v[168:171], a[200:203], a[116:119], v[168:171]
    v_mfma_f32_16x16x32_bf16 v[132:135], a[200:203], a[112:115], v[132:135]
    ds_read_b64_tr_b16 a[140:141], v6 offset:16384
    v_mfma_f32_16x16x32_bf16 v[136:139], a[204:207], a[112:115], v[136:139]
    v_mfma_f32_16x16x32_bf16 v[172:175], a[204:207], a[116:119], v[172:175]
    ds_read_b64_tr_b16 a[142:143], v6 offset:17408
    v_mfma_f32_16x16x32_bf16 v[240:243], a[148:151], a[208:211], v[240:243]
    v_mfma_f32_16x16x32_bf16 v[208:211], a[144:147], a[208:211], v[208:211]
    v_mfma_f32_16x16x32_bf16 v[212:215], a[144:147], a[212:215], v[212:215]
    ds_read_b64_tr_b16 a[120:121], v5 offset:0
    v_mfma_f32_16x16x32_bf16 v[244:247], a[148:151], a[212:215], v[244:247]
    v_mfma_f32_16x16x32_bf16 v[248:251], a[148:151], a[216:219], v[248:251]
    ds_read_b64_tr_b16 a[122:123], v5 offset:1024
    v_mfma_f32_16x16x32_bf16 v[216:219], a[144:147], a[216:219], v[216:219]
    v_mfma_f32_16x16x32_bf16 v[220:223], a[144:147], a[220:223], v[220:223]
    ds_read_b64_tr_b16 a[124:125], v6 offset:0
    v_mfma_f32_16x16x32_bf16 v[252:255], a[148:151], a[220:223], v[252:255]
    v_mfma_f32_16x16x32_bf16 v[104:107], a[156:159], a[208:211], v[104:107]
    ds_read_b64_tr_b16 a[126:127], v6 offset:1024
    v_mfma_f32_16x16x32_bf16 v[68:71], a[152:155], a[208:211], v[68:71]
    v_mfma_f32_16x16x32_bf16 v[72:75], a[152:155], a[212:215], v[72:75]
    ds_read_b128 a[224:227], v10 offset:32768
    v_mfma_f32_16x16x32_bf16 v[108:111], a[156:159], a[212:215], v[108:111]
    v_mfma_f32_16x16x32_bf16 v[112:115], a[156:159], a[216:219], v[112:115]
    ds_read_b128 a[228:231], v10 offset:34816
    v_mfma_f32_16x16x32_bf16 v[76:79], a[152:155], a[216:219], v[76:79]
    v_mfma_f32_16x16x32_bf16 v[80:83], a[152:155], a[220:223], v[80:83]
    v_mfma_f32_16x16x32_bf16 v[116:119], a[156:159], a[220:223], v[116:119]
    ds_read_b128 a[232:235], v10 offset:36864
    v_mfma_f32_16x16x32_bf16 v[176:179], a[208:211], a[164:167], v[176:179]
    v_mfma_f32_16x16x32_bf16 v[140:143], a[208:211], a[160:163], v[140:143]
    ds_read_b128 a[236:239], v10 offset:38912
    v_mfma_f32_16x16x32_bf16 v[144:147], a[212:215], a[160:163], v[144:147]
    v_mfma_f32_16x16x32_bf16 v[180:183], a[212:215], a[164:167], v[180:183]
    v_mfma_f32_16x16x32_bf16 v[184:187], a[216:219], a[164:167], v[184:187]
    v_mfma_f32_16x16x32_bf16 v[148:151], a[216:219], a[160:163], v[148:151]
    v_mfma_f32_16x16x32_bf16 v[152:155], a[220:223], a[160:163], v[152:155]
    v_mfma_f32_16x16x32_bf16 v[188:191], a[220:223], a[164:167], v[188:191]
    s_waitcnt vmcnt(0) lgkmcnt(0)
    s_barrier
    v_mfma_f32_16x16x32_bf16 v[224:227], a[124:127], a[172:175], v[224:227]
    s_add_u32 m0, s68, 8192
    v_mfma_f32_16x16x32_bf16 v[192:195], a[120:123], a[172:175], v[192:195]
    s_add_u32 s65, s78, s61
    buffer_load_dwordx4 v27, s[28:31], s65 offen offset:0 lds
    v_mfma_f32_16x16x32_bf16 v[196:199], a[120:123], a[176:179], v[196:199]
    ds_read_b128 a[188:191], v10 offset:0
    v_mfma_f32_16x16x32_bf16 v[228:231], a[124:127], a[176:179], v[228:231]
    v_mfma_f32_16x16x32_bf16 v[232:235], a[124:127], a[180:183], v[232:235]
    buffer_load_dwordx4 v28, s[28:31], s65 offen offset:1024 lds
    ds_read_b128 a[192:195], v10 offset:2048
    v_mfma_f32_16x16x32_bf16 v[200:203], a[120:123], a[180:183], v[200:203]
    v_mfma_f32_16x16x32_bf16 v[204:207], a[120:123], a[184:187], v[204:207]
    ds_read_b128 a[196:199], v10 offset:4096
    v_mfma_f32_16x16x32_bf16 v[236:239], a[124:127], a[184:187], v[236:239]
    v_mfma_f32_16x16x32_bf16 v[48:51], a[128:131], a[168:171], v[48:51]
    ds_read_b128 a[200:203], v10 offset:6144
    v_mfma_f32_16x16x32_bf16 v[84:87], a[132:135], a[168:171], v[84:87]
    v_mfma_f32_16x16x32_bf16 v[88:91], a[132:135], a[172:175], v[88:91]
    ds_read_b128 a[204:207], v10 offset:8192
    v_mfma_f32_16x16x32_bf16 v[52:55], a[128:131], a[172:175], v[52:55]
    v_mfma_f32_16x16x32_bf16 v[56:59], a[128:131], a[176:179], v[56:59]
    ds_read_b64_tr_b16 a[152:153], v5 offset:32768
    v_mfma_f32_16x16x32_bf16 v[92:95], a[132:135], a[176:179], v[92:95]
    v_mfma_f32_16x16x32_bf16 v[96:99], a[132:135], a[180:183], v[96:99]
    v_mfma_f32_16x16x32_bf16 v[60:63], a[128:131], a[180:183], v[60:63]
    ds_read_b64_tr_b16 a[154:155], v5 offset:33792
    v_mfma_f32_16x16x32_bf16 v[64:67], a[128:131], a[184:187], v[64:67]
    v_mfma_f32_16x16x32_bf16 v[100:103], a[132:135], a[184:187], v[100:103]
    ds_read_b64_tr_b16 a[156:157], v6 offset:32768
    v_mfma_f32_16x16x32_bf16 v[120:123], a[168:171], a[136:139], v[120:123]
    v_mfma_f32_16x16x32_bf16 v[156:159], a[168:171], a[140:143], v[156:159]
    ds_read_b64_tr_b16 a[158:159], v6 offset:33792
    v_mfma_f32_16x16x32_bf16 v[160:163], a[172:175], a[140:143], v[160:163]
    v_mfma_f32_16x16x32_bf16 v[124:127], a[172:175], a[136:139], v[124:127]
    ds_read_b64_tr_b16 a[160:161], v5 offset:40960
    v_mfma_f32_16x16x32_bf16 v[128:131], a[176:179], a[136:139], v[128:131]
    v_mfma_f32_16x16x32_bf16 v[164:167], a[176:179], a[140:143], v[164:167]
    ds_read_b64_tr_b16 a[162:163], v5 offset:41984
    v_mfma_f32_16x16x32_bf16 v[168:171], a[180:183], a[140:143], v[168:171]
    v_mfma_f32_16x16x32_bf16 v[132:135], a[180:183], a[136:139], v[132:135]
    ds_read_b64_tr_b16 a[164:165], v6 offset:40960
    v_mfma_f32_16x16x32_bf16 v[136:139], a[184:187], a[136:139], v[136:139]
    v_mfma_f32_16x16x32_bf16 v[172:175], a[184:187], a[140:143], v[172:175]
    ds_read_b64_tr_b16 a[166:167], v6 offset:41984
    v_mfma_f32_16x16x32_bf16 v[240:243], a[4:7], a[224:227], v[240:243]
    v_mfma_f32_16x16x32_bf16 v[208:211], a[0:3], a[224:227], v[208:211]
    v_mfma_f32_16x16x32_bf16 v[212:215], a[0:3], a[228:231], v[212:215]
    ds_read_b64_tr_b16 a[144:145], v5 offset:24576
    v_mfma_f32_16x16x32_bf16 v[244:247], a[4:7], a[228:231], v[244:247]
    v_mfma_f32_16x16x32_bf16 v[248:251], a[4:7], a[232:235], v[248:251]
    ds_read_b64_tr_b16 a[146:147], v5 offset:25600
    v_mfma_f32_16x16x32_bf16 v[216:219], a[0:3], a[232:235], v[216:219]
    v_mfma_f32_16x16x32_bf16 v[220:223], a[0:3], a[236:239], v[220:223]
    ds_read_b64_tr_b16 a[148:149], v6 offset:24576
    v_mfma_f32_16x16x32_bf16 v[252:255], a[4:7], a[236:239], v[252:255]
    v_mfma_f32_16x16x32_bf16 v[104:107], a[12:15], a[224:227], v[104:107]
    ds_read_b64_tr_b16 a[150:151], v6 offset:25600
    v_mfma_f32_16x16x32_bf16 v[68:71], a[8:11], a[224:227], v[68:71]
    v_mfma_f32_16x16x32_bf16 v[72:75], a[8:11], a[228:231], v[72:75]
    ds_read_b128 a[208:211], v9 offset:24576
    v_mfma_f32_16x16x32_bf16 v[108:111], a[12:15], a[228:231], v[108:111]
    v_mfma_f32_16x16x32_bf16 v[112:115], a[12:15], a[232:235], v[112:115]
    ds_read_b128 a[212:215], v9 offset:26624
    v_mfma_f32_16x16x32_bf16 v[76:79], a[8:11], a[232:235], v[76:79]
    v_mfma_f32_16x16x32_bf16 v[80:83], a[8:11], a[236:239], v[80:83]
    v_mfma_f32_16x16x32_bf16 v[116:119], a[12:15], a[236:239], v[116:119]
    ds_read_b128 a[216:219], v9 offset:28672
    v_mfma_f32_16x16x32_bf16 v[176:179], a[224:227], a[20:23], v[176:179]
    v_mfma_f32_16x16x32_bf16 v[140:143], a[224:227], a[16:19], v[140:143]
    ds_read_b128 a[220:223], v9 offset:30720
    v_mfma_f32_16x16x32_bf16 v[144:147], a[228:231], a[16:19], v[144:147]
    v_mfma_f32_16x16x32_bf16 v[180:183], a[228:231], a[20:23], v[180:183]
    v_mfma_f32_16x16x32_bf16 v[184:187], a[232:235], a[20:23], v[184:187]
    v_mfma_f32_16x16x32_bf16 v[148:151], a[232:235], a[16:19], v[148:151]
    v_mfma_f32_16x16x32_bf16 v[152:155], a[236:239], a[16:19], v[152:155]
    v_mfma_f32_16x16x32_bf16 v[188:191], a[236:239], a[20:23], v[188:191]
    s_waitcnt lgkmcnt(0)
    s_barrier
    v_mfma_f32_16x16x32_bf16 v[224:227], a[148:151], a[192:195], v[224:227]
    buffer_load_dword v47, off, s[96:99], 0 offset:128 sc1
    v_mfma_f32_16x16x32_bf16 v[192:195], a[144:147], a[192:195], v[192:195]
    v_mfma_f32_16x16x32_bf16 v[196:199], a[144:147], a[196:199], v[196:199]
    v_mfma_f32_16x16x32_bf16 v[228:231], a[148:151], a[196:199], v[228:231]
    v_mfma_f32_16x16x32_bf16 v[232:235], a[148:151], a[200:203], v[232:235]
    v_mfma_f32_16x16x32_bf16 v[200:203], a[144:147], a[200:203], v[200:203]
    v_mfma_f32_16x16x32_bf16 v[204:207], a[144:147], a[204:207], v[204:207]
    v_mfma_f32_16x16x32_bf16 v[236:239], a[148:151], a[204:207], v[236:239]
    v_mfma_f32_16x16x32_bf16 v[48:51], a[152:155], a[188:191], v[48:51]
    v_mfma_f32_16x16x32_bf16 v[84:87], a[156:159], a[188:191], v[84:87]
    v_cvt_pk_bf16_f32 v192, v192, v193
    v_cvt_pk_bf16_f32 v193, v194, v195
    v_mfma_f32_16x16x32_bf16 v[88:91], a[156:159], a[192:195], v[88:91]
    v_cvt_pk_bf16_f32 v194, v224, v225
    v_cvt_pk_bf16_f32 v195, v226, v227
    v_mfma_f32_16x16x32_bf16 v[52:55], a[152:155], a[192:195], v[52:55]
    ds_read_b128 a[224:227], v10 offset:24576
    v_cvt_pk_bf16_f32 v196, v196, v197
    v_mfma_f32_16x16x32_bf16 v[56:59], a[152:155], a[196:199], v[56:59]
    v_cvt_pk_bf16_f32 v197, v198, v199
    v_cvt_pk_bf16_f32 v198, v228, v229
    v_mfma_f32_16x16x32_bf16 v[92:95], a[156:159], a[196:199], v[92:95]
    v_cvt_pk_bf16_f32 v199, v230, v231
    v_cvt_pk_bf16_f32 v200, v200, v201
    v_mfma_f32_16x16x32_bf16 v[96:99], a[156:159], a[200:203], v[96:99]
    v_cvt_pk_bf16_f32 v201, v202, v203
    v_cvt_pk_bf16_f32 v202, v232, v233
    v_mfma_f32_16x16x32_bf16 v[60:63], a[152:155], a[200:203], v[60:63]
    v_cvt_pk_bf16_f32 v203, v234, v235
    v_cvt_pk_bf16_f32 v204, v204, v205
    v_mfma_f32_16x16x32_bf16 v[64:67], a[152:155], a[204:207], v[64:67]
    v_cvt_pk_bf16_f32 v205, v206, v207
    v_cvt_pk_bf16_f32 v206, v236, v237
    v_mfma_f32_16x16x32_bf16 v[100:103], a[156:159], a[204:207], v[100:103]
    v_cvt_pk_bf16_f32 v207, v238, v239
    v_cvt_pk_bf16_f32 v48, v48, v49
    v_mfma_f32_16x16x32_bf16 v[120:123], a[188:191], a[160:163], v[120:123]
    v_cvt_pk_bf16_f32 v49, v50, v51
    v_cvt_pk_bf16_f32 v50, v84, v85
    v_mfma_f32_16x16x32_bf16 v[156:159], a[188:191], a[164:167], v[156:159]
    v_cvt_pk_bf16_f32 v51, v86, v87
    v_cvt_pk_bf16_f32 v52, v52, v53
    v_mfma_f32_16x16x32_bf16 v[160:163], a[192:195], a[164:167], v[160:163]
    v_cvt_pk_bf16_f32 v53, v54, v55
    v_cvt_pk_bf16_f32 v54, v88, v89
    v_mfma_f32_16x16x32_bf16 v[124:127], a[192:195], a[160:163], v[124:127]
    v_cvt_pk_bf16_f32 v55, v90, v91
    v_cvt_pk_bf16_f32 v56, v56, v57
    v_mfma_f32_16x16x32_bf16 v[128:131], a[196:199], a[160:163], v[128:131]
    ds_read_b128 a[228:231], v10 offset:26624
    v_cvt_pk_bf16_f32 v57, v58, v59
    v_mfma_f32_16x16x32_bf16 v[164:167], a[196:199], a[164:167], v[164:167]
    v_cvt_pk_bf16_f32 v58, v92, v93
    v_cvt_pk_bf16_f32 v59, v94, v95
    v_mfma_f32_16x16x32_bf16 v[168:171], a[200:203], a[164:167], v[168:171]
    v_cvt_pk_bf16_f32 v60, v60, v61
    v_cvt_pk_bf16_f32 v61, v62, v63
    v_mfma_f32_16x16x32_bf16 v[132:135], a[200:203], a[160:163], v[132:135]
    v_cvt_pk_bf16_f32 v62, v96, v97
    v_cvt_pk_bf16_f32 v63, v98, v99
    v_mfma_f32_16x16x32_bf16 v[136:139], a[204:207], a[160:163], v[136:139]
    v_cvt_pk_bf16_f32 v64, v64, v65
    v_cvt_pk_bf16_f32 v65, v66, v67
    v_mfma_f32_16x16x32_bf16 v[172:175], a[204:207], a[164:167], v[172:175]
    v_cvt_pk_bf16_f32 v66, v100, v101
    v_cvt_pk_bf16_f32 v67, v102, v103
    v_mfma_f32_16x16x32_bf16 v[240:243], a[28:31], a[208:211], v[240:243]
    v_cvt_pk_bf16_f32 v84, v120, v121
    v_cvt_pk_bf16_f32 v85, v122, v123
    v_mfma_f32_16x16x32_bf16 v[208:211], a[24:27], a[208:211], v[208:211]
    v_cvt_pk_bf16_f32 v86, v124, v125
    v_cvt_pk_bf16_f32 v87, v126, v127
    v_mfma_f32_16x16x32_bf16 v[212:215], a[24:27], a[212:215], v[212:215]
    v_cvt_pk_bf16_f32 v88, v128, v129
    v_cvt_pk_bf16_f32 v89, v130, v131
    v_mfma_f32_16x16x32_bf16 v[244:247], a[28:31], a[212:215], v[244:247]
    v_cvt_pk_bf16_f32 v90, v132, v133
    v_cvt_pk_bf16_f32 v91, v134, v135
    v_mfma_f32_16x16x32_bf16 v[248:251], a[28:31], a[216:219], v[248:251]
    v_cvt_pk_bf16_f32 v92, v136, v137
    v_cvt_pk_bf16_f32 v93, v138, v139
    v_mfma_f32_16x16x32_bf16 v[216:219], a[24:27], a[216:219], v[216:219]
    ds_read_b128 a[232:235], v10 offset:28672
    v_cvt_pk_bf16_f32 v120, v156, v157
    v_mfma_f32_16x16x32_bf16 v[220:223], a[24:27], a[220:223], v[220:223]
    v_cvt_pk_bf16_f32 v121, v158, v159
    v_cvt_pk_bf16_f32 v122, v160, v161
    v_mfma_f32_16x16x32_bf16 v[252:255], a[28:31], a[220:223], v[252:255]
    v_cvt_pk_bf16_f32 v123, v162, v163
    v_cvt_pk_bf16_f32 v124, v164, v165
    v_mfma_f32_16x16x32_bf16 v[104:107], a[36:39], a[208:211], v[104:107]
    v_cvt_pk_bf16_f32 v125, v166, v167
    v_cvt_pk_bf16_f32 v126, v168, v169
    v_mfma_f32_16x16x32_bf16 v[68:71], a[32:35], a[208:211], v[68:71]
    v_cvt_pk_bf16_f32 v127, v170, v171
    v_cvt_pk_bf16_f32 v128, v172, v173
    v_mfma_f32_16x16x32_bf16 v[72:75], a[32:35], a[212:215], v[72:75]
    v_cvt_pk_bf16_f32 v129, v174, v175
    v_mfma_f32_16x16x32_bf16 v[156:159], v[48:51], v[192:195], 0
    v_mfma_f32_16x16x32_bf16 v[160:163], v[52:55], v[192:195], 0
    v_mfma_f32_16x16x32_bf16 v[164:167], v[52:55], v[196:199], 0
    v_mfma_f32_16x16x32_bf16 v[168:171], v[56:59], v[196:199], 0
    v_mfma_f32_16x16x32_bf16 v[224:227], v[56:59], v[200:203], 0
    v_mfma_f32_16x16x32_bf16 v[228:231], v[60:63], v[200:203], 0
    v_mfma_f32_16x16x32_bf16 v[232:235], v[60:63], v[204:207], 0
    ds_read_b128 a[236:239], v10 offset:30720
    v_mfma_f32_16x16x32_bf16 v[236:239], v[64:67], v[204:207], 0
    v_cndmask_b32 v156, v156, v157, s[80:81]
    v_cndmask_b32 v157, v158, v159, s[80:81]
    v_mfma_f32_16x16x32_bf16 v[108:111], a[36:39], a[212:215], v[108:111]
    v_cndmask_b32 v160, v160, v161, s[80:81]
    v_cndmask_b32 v161, v162, v163, s[80:81]
    v_mfma_f32_16x16x32_bf16 v[112:115], a[36:39], a[216:219], v[112:115]
    v_cndmask_b32 v156, v156, v160, s[82:83]
    v_cndmask_b32 v157, v157, v161, s[84:85]
    v_mfma_f32_16x16x32_bf16 v[76:79], a[32:35], a[216:219], v[76:79]
    v_mov_b32 v159, 0xf149f2ca
    v_cndmask_b32 v156, v159, v156, s[86:87]
    v_mfma_f32_16x16x32_bf16 v[80:83], a[32:35], a[220:223], v[80:83]
    v_cndmask_b32 v157, v159, v157, s[88:89]
    v_max_f32 v158, v156, v157
    v_mfma_f32_16x16x32_bf16 v[116:119], a[36:39], a[220:223], v[116:119]
    v_cndmask_b32 v164, v164, v165, s[80:81]
    v_cndmask_b32 v165, v166, v167, s[80:81]
    v_mfma_f32_16x16x32_bf16 v[176:179], a[208:211], a[44:47], v[176:179]
    v_cndmask_b32 v168, v168, v169, s[80:81]
    v_cndmask_b32 v169, v170, v171, s[80:81]
    v_mfma_f32_16x16x32_bf16 v[140:143], a[208:211], a[40:43], v[140:143]
    v_cndmask_b32 v164, v164, v168, s[82:83]
    v_cndmask_b32 v165, v165, v169, s[84:85]
    v_mfma_f32_16x16x32_bf16 v[144:147], a[212:215], a[40:43], v[144:147]
    v_max_f32 v166, v164, v165
    v_cndmask_b32 v224, v224, v225, s[80:81]
    v_mfma_f32_16x16x32_bf16 v[180:183], a[212:215], a[44:47], v[180:183]
    v_cndmask_b32 v225, v226, v227, s[80:81]
    v_cndmask_b32 v228, v228, v229, s[80:81]
    v_mfma_f32_16x16x32_bf16 v[184:187], a[216:219], a[44:47], v[184:187]
    v_cndmask_b32 v229, v230, v231, s[80:81]
    v_cndmask_b32 v224, v224, v228, s[82:83]
    v_mfma_f32_16x16x32_bf16 v[148:151], a[216:219], a[40:43], v[148:151]
    v_cndmask_b32 v225, v225, v229, s[84:85]
    v_max_f32 v226, v224, v225
    v_mfma_f32_16x16x32_bf16 v[152:155], a[220:223], a[40:43], v[152:155]
    v_cndmask_b32 v232, v232, v233, s[80:81]
    v_cndmask_b32 v233, v234, v235, s[80:81]
    v_mfma_f32_16x16x32_bf16 v[188:191], a[220:223], a[44:47], v[188:191]
    v_cndmask_b32 v236, v236, v237, s[80:81]
    v_cndmask_b32 v237, v238, v239, s[80:81]
    s_waitcnt vmcnt(1) lgkmcnt(0)
    s_barrier
    s_waitcnt vmcnt(0)
    v_readfirstlane_b32 s10, v47
    s_mov_b32 s9, 0x100000
    s_nop 1
    s_cmp_lt_u32 s10, 40
    s_cbranch_scc1 L_slow_o
L_back_o:
    v_mfma_f32_16x16x32_bf16 v[240:243], a[52:55], a[224:227], v[240:243]
    s_add_u32 m0, s68, 0
    v_cndmask_b32 v232, v232, v236, s[82:83]
    v_cndmask_b32 v233, v233, v237, s[84:85]
    v_mfma_f32_16x16x32_bf16 v[208:211], a[48:51], a[224:227], v[208:211]
    s_add_u32 s65, s78, s62
    buffer_load_dwordx4 v27, s[28:31], s65 offen offset:0 lds
    v_max_f32 v234, v232, v233
    v_mfma_f32_16x16x32_bf16 v[212:215], a[48:51], a[228:231], v[212:215]
    v_permlane32_swap_b32 v158, v226
    v_mfma_f32_16x16x32_bf16 v[244:247], a[52:55], a[228:231], v[244:247]
    v_permlane32_swap_b32 v166, v234
    v_mfma_f32_16x16x32_bf16 v[248:251], a[52:55], a[232:235], v[248:251]
    buffer_load_dwordx4 v28, s[28:31], s65 offen offset:1024 lds
    v_max_f32 v158, v158, v226
    v_mfma_f32_16x16x32_bf16 v[216:219], a[48:51], a[232:235], v[216:219]
    s_mov_b32 s52, s24
    ds_read_b128 a[208:211], v9 offset:32768
    v_max_f32 v166, v166, v234
    v_mfma_f32_16x16x32_bf16 v[220:223], a[48:51], a[236:239], v[220:223]
    s_mov_b32 s53, s25
    v_permlane16_swap_b32 v158, v166
    v_mfma_f32_16x16x32_bf16 v[252:255], a[52:55], a[236:239], v[252:255]
    s_mov_b32 s54, 131072
    v_max_f32 v158, v158, v166
    v_mul_f32 v158, s92, v158
    v_mfma_f32_16x16x32_bf16 v[104:107], a[60:63], a[224:227], v[104:107]
    s_mov_b32 s55, 0x20000
    v_mov_b32 v166, v158
    v_mfma_f32_16x16x32_bf16 v[68:71], a[56:59], a[224:227], v[68:71]
    s_lshl_b32 s26, s93, 9
    v_permlane16_swap_b32 v158, v166
    v_mfma_f32_16x16x32_bf16 v[72:75], a[56:59], a[228:231], v[72:75]
    s_add_u32 s26, s26, 8192
    v_lshlrev_b32 v43, 2, v0
    v_mov_b32 v226, v158
    v_mfma_f32_16x16x32_bf16 v[108:111], a[60:63], a[228:231], v[108:111]
    buffer_load_dword v44, v43, s[52:55], s26 offen offset:0 sc1
    ds_read_b128 a[212:215], v9 offset:34816
    v_mfma_f32_16x16x32_bf16 v[112:115], a[60:63], a[232:235], v[112:115]
    v_mov_b32 v234, v166
    v_mfma_f32_16x16x32_bf16 v[76:79], a[56:59], a[232:235], v[76:79]
    v_permlane32_swap_b32 v158, v226
    v_mfma_f32_16x16x32_bf16 v[80:83], a[56:59], a[236:239], v[80:83]
    buffer_load_dword v45, v43, s[52:55], s26 offen offset:256 sc1
    v_mfma_f32_16x16x32_bf16 v[116:119], a[60:63], a[236:239], v[116:119]
    ds_read_b128 a[216:219], v9 offset:36864
    v_mfma_f32_16x16x32_bf16 v[176:179], a[224:227], a[68:71], v[176:179]
    v_permlane32_swap_b32 v166, v234
    v_mfma_f32_16x16x32_bf16 v[140:143], a[224:227], a[64:67], v[140:143]
    v_fma_f32 v156, v156, s92, -v158
    v_fma_f32 v157, v157, s92, -v158
    v_mfma_f32_16x16x32_bf16 v[144:147], a[228:231], a[64:67], v[144:147]
    v_fma_f32 v164, v164, s92, -v166
    v_fma_f32 v165, v165, s92, -v166
    v_mfma_f32_16x16x32_bf16 v[180:183], a[228:231], a[68:71], v[180:183]
    v_fma_f32 v224, v224, s92, -v226
    v_fma_f32 v225, v225, s92, -v226
    v_mfma_f32_16x16x32_bf16 v[184:187], a[232:235], a[68:71], v[184:187]
    ds_read_b128 a[220:223], v9 offset:38912
    v_fma_f32 v232, v232, s92, -v234
    v_mfma_f32_16x16x32_bf16 v[148:151], a[232:235], a[64:67], v[148:151]
    v_fma_f32 v233, v233, s92, -v234
    v_mfma_f32_16x16x32_bf16 v[152:155], a[236:239], a[64:67], v[152:155]
    v_exp_f32 v156, v156
    v_mfma_f32_16x16x32_bf16 v[188:191], a[236:239], a[68:71], v[188:191]
    v_exp_f32 v157, v157
    s_waitcnt lgkmcnt(0)
    s_barrier
    v_mfma_f32_16x16x32_bf16 v[240:243], a[76:79], a[208:211], v[240:243]
    v_exp_f32 v164, v164
    v_mfma_f32_16x16x32_bf16 v[208:211], a[72:75], a[208:211], v[208:211]
    v_exp_f32 v165, v165
    v_mfma_f32_16x16x32_bf16 v[212:215], a[72:75], a[212:215], v[212:215]
    v_exp_f32 v224, v224
    v_mfma_f32_16x16x32_bf16 v[244:247], a[76:79], a[212:215], v[244:247]
    v_exp_f32 v225, v225
    v_mfma_f32_16x16x32_bf16 v[248:251], a[76:79], a[216:219], v[248:251]
    v_exp_f32 v232, v232
    v_mfma_f32_16x16x32_bf16 v[216:219], a[72:75], a[216:219], v[216:219]
    ds_read_b128 a[224:227], v10 offset:32768
    v_mfma_f32_16x16x32_bf16 v[220:223], a[72:75], a[220:223], v[220:223]
    v_exp_f32 v233, v233
    v_mfma_f32_16x16x32_bf16 v[252:255], a[76:79], a[220:223], v[252:255]
    v_add_f32 v158, v156, v157
    v_add_f32 v166, v164, v165
    v_mfma_f32_16x16x32_bf16 v[104:107], a[84:87], a[208:211], v[104:107]
    v_add_f32 v226, v224, v225
    v_add_f32 v234, v232, v233
    v_mfma_f32_16x16x32_bf16 v[68:71], a[80:83], a[208:211], v[68:71]
    v_permlane32_swap_b32 v158, v226
    v_mfma_f32_16x16x32_bf16 v[72:75], a[80:83], a[212:215], v[72:75]
    ds_read_b128 a[228:231], v10 offset:34816
    v_mfma_f32_16x16x32_bf16 v[108:111], a[84:87], a[212:215], v[108:111]
    v_permlane32_swap_b32 v166, v234
    v_mfma_f32_16x16x32_bf16 v[112:115], a[84:87], a[216:219], v[112:115]
    v_add_f32 v158, v158, v226
    v_add_f32 v166, v166, v234
    v_mfma_f32_16x16x32_bf16 v[76:79], a[80:83], a[216:219], v[76:79]
    v_mfma_f32_16x16x32_bf16 v[80:83], a[80:83], a[220:223], v[80:83]
    v_permlane16_swap_b32 v158, v166
    v_mfma_f32_16x16x32_bf16 v[116:119], a[84:87], a[220:223], v[116:119]
    ds_read_b128 a[232:235], v10 offset:36864
    v_add_f32 v158, v158, v166
    v_mfma_f32_16x16x32_bf16 v[176:179], a[208:211], a[92:95], v[176:179]
    v_rcp_f32 v158, v158
    v_mfma_f32_16x16x32_bf16 v[140:143], a[208:211], a[88:91], v[140:143]
    s_waitcnt vmcnt(0)
    v_mul_f32 v158, v158, v44
    v_mov_b32 v166, v158
    v_mfma_f32_16x16x32_bf16 v[144:147], a[212:215], a[88:91], v[144:147]
    v_mfma_f32_16x16x32_bf16 v[180:183], a[212:215], a[92:95], v[180:183]
    v_permlane16_swap_b32 v158, v166
    v_mfma_f32_16x16x32_bf16 v[184:187], a[216:219], a[92:95], v[184:187]
    ds_read_b128 a[236:239], v10 offset:38912
    v_mov_b32 v226, v158
    v_mfma_f32_16x16x32_bf16 v[148:151], a[216:219], a[88:91], v[148:151]
    v_mov_b32 v234, v166
    v_mfma_f32_16x16x32_bf16 v[152:155], a[220:223], a[88:91], v[152:155]
    v_permlane32_swap_b32 v158, v226
    v_mfma_f32_16x16x32_bf16 v[188:191], a[220:223], a[92:95], v[188:191]
    v_permlane32_swap_b32 v166, v234
    s_waitcnt lgkmcnt(0)
    s_barrier
    v_mfma_f32_16x16x32_bf16 v[240:243], a[100:103], a[224:227], v[240:243]
    v_mul_f32 v156, v156, v158
    v_mul_f32 v157, v157, v158
    v_mfma_f32_16x16x32_bf16 v[208:211], a[96:99], a[224:227], v[208:211]
    v_mul_f32 v164, v164, v166
    v_mul_f32 v165, v165, v166
    v_mfma_f32_16x16x32_bf16 v[212:215], a[96:99], a[228:231], v[212:215]
    v_mul_f32 v224, v224, v226
    v_mul_f32 v225, v225, v226
    v_mfma_f32_16x16x32_bf16 v[244:247], a[100:103], a[228:231], v[244:247]
    v_mul_f32 v232, v232, v234
    v_mul_f32 v233, v233, v234
    v_mfma_f32_16x16x32_bf16 v[248:251], a[100:103], a[232:235], v[248:251]
    v_cvt_pk_bf16_f32 v159, v156, v157
    v_cvt_pk_bf16_f32 v167, v164, v165
    v_mfma_f32_16x16x32_bf16 v[216:219], a[96:99], a[232:235], v[216:219]
    ds_read_b128 a[208:211], v9 offset:24576
    v_cvt_pk_bf16_f32 v227, v224, v225
    v_mfma_f32_16x16x32_bf16 v[220:223], a[96:99], a[236:239], v[220:223]
    v_cvt_pk_bf16_f32 v235, v232, v233
    v_perm_b32 v160, v159, v159, v21
    v_mfma_f32_16x16x32_bf16 v[252:255], a[100:103], a[236:239], v[252:255]
    v_perm_b32 v161, v159, v159, v22
    v_perm_b32 v162, v159, v159, v23
    v_mfma_f32_16x16x32_bf16 v[104:107], a[108:111], a[224:227], v[104:107]
    v_perm_b32 v163, v159, v159, v24
    v_perm_b32 v168, v167, v167, v21
    v_mfma_f32_16x16x32_bf16 v[68:71], a[104:107], a[224:227], v[68:71]
    v_perm_b32 v169, v167, v167, v22
    v_perm_b32 v170, v167, v167, v23
    v_mfma_f32_16x16x32_bf16 v[72:75], a[104:107], a[228:231], v[72:75]
    ds_read_b128 a[212:215], v9 offset:26624
    v_perm_b32 v171, v167, v167, v24
    v_mfma_f32_16x16x32_bf16 v[108:111], a[108:111], a[228:231], v[108:111]
    v_perm_b32 v228, v227, v227, v21
    v_perm_b32 v229, v227, v227, v22
    v_mfma_f32_16x16x32_bf16 v[112:115], a[108:111], a[232:235], v[112:115]
    v_perm_b32 v230, v227, v227, v23
    v_perm_b32 v231, v227, v227, v24
    v_mfma_f32_16x16x32_bf16 v[76:79], a[104:107], a[232:235], v[76:79]
    v_perm_b32 v236, v235, v235, v21
    v_perm_b32 v237, v235, v235, v22
    v_mfma_f32_16x16x32_bf16 v[80:83], a[104:107], a[236:239], v[80:83]
    v_perm_b32 v238, v235, v235, v23
    v_perm_b32 v239, v235, v235, v24
    v_mfma_f32_16x16x32_bf16 v[156:159], v[84:87], v[160:163], 0
    ds_read_b128 a[216:219], v9 offset:28672
    v_mfma_f32_16x16x32_bf16 v[192:195], v[120:123], v[160:163], 0
    v_mfma_f32_16x16x32_bf16 v[164:167], v[86:89], v[168:171], 0
    v_mfma_f32_16x16x32_bf16 v[196:199], v[122:125], v[168:171], 0
    v_mfma_f32_16x16x32_bf16 v[224:227], v[88:91], v[228:231], 0
    v_mfma_f32_16x16x32_bf16 v[200:203], v[124:127], v[228:231], 0
    ds_read_b128 a[220:223], v9 offset:30720
    v_mfma_f32_16x16x32_bf16 v[232:235], v[90:93], v[236:239], 0
    v_mfma_f32_16x16x32_bf16 v[204:207], v[126:129], v[236:239], 0
    v_cvt_pk_bf16_f32 v156, v156, v157
    v_cvt_pk_bf16_f32 v157, v158, v159
    v_mfma_f32_16x16x32_bf16 v[116:119], a[108:111], a[236:239], v[116:119]
    v_cvt_pk_bf16_f32 v158, v192, v193
    v_cvt_pk_bf16_f32 v159, v194, v195
    v_mfma_f32_16x16x32_bf16 v[176:179], a[224:227], a[116:119], v[176:179]
    buffer_store_dwordx4 v[156:159], v26, s[36:39], s73 offen sc1
    v_mfma_f32_16x16x32_bf16 v[140:143], a[224:227], a[112:115], v[140:143]
    s_add_u32 s73, s73, 74752
    v_cvt_pk_bf16_f32 v164, v164, v165
    v_cvt_pk_bf16_f32 v165, v166, v167
    v_mfma_f32_16x16x32_bf16 v[144:147], a[228:231], a[112:115], v[144:147]
    v_cvt_pk_bf16_f32 v166, v196, v197
    v_cvt_pk_bf16_f32 v167, v198, v199
    v_mfma_f32_16x16x32_bf16 v[180:183], a[228:231], a[116:119], v[180:183]
    buffer_store_dwordx4 v[164:167], v26, s[36:39], s73 offen sc1
    v_mfma_f32_16x16x32_bf16 v[184:187], a[232:235], a[116:119], v[184:187]
    s_add_u32 s73, s73, 74752
    v_cvt_pk_bf16_f32 v224, v224, v225
    v_cvt_pk_bf16_f32 v225, v226, v227
    v_mfma_f32_16x16x32_bf16 v[148:151], a[232:235], a[112:115], v[148:151]
    v_cvt_pk_bf16_f32 v226, v200, v201
    v_cvt_pk_bf16_f32 v227, v202, v203
    v_mfma_f32_16x16x32_bf16 v[152:155], a[236:239], a[112:115], v[152:155]
    buffer_store_dwordx4 v[224:227], v26, s[36:39], s73 offen sc1
    v_mfma_f32_16x16x32_bf16 v[188:191], a[236:239], a[116:119], v[188:191]
    s_add_u32 s73, s73, 74752
    v_cvt_pk_bf16_f32 v232, v232, v233
    v_cvt_pk_bf16_f32 v233, v234, v235
    s_waitcnt lgkmcnt(0)
    s_barrier
    v_mfma_f32_16x16x32_bf16 v[240:243], a[124:127], a[208:211], v[240:243]
    v_cvt_pk_bf16_f32 v234, v204, v205
    v_cvt_pk_bf16_f32 v235, v206, v207
    v_mfma_f32_16x16x32_bf16 v[208:211], a[120:123], a[208:211], v[208:211]
    buffer_store_dwordx4 v[232:235], v26, s[36:39], s73 offen sc1
    v_mfma_f32_16x16x32_bf16 v[212:215], a[120:123], a[212:215], v[212:215]
    s_add_u32 s73, s73, 74752
    v_mfma_f32_16x16x32_bf16 v[244:247], a[124:127], a[212:215], v[244:247]
    v_mfma_f32_16x16x32_bf16 v[248:251], a[124:127], a[216:219], v[248:251]
    v_mfma_f32_16x16x32_bf16 v[216:219], a[120:123], a[216:219], v[216:219]
    ds_read_b128 a[224:227], v10 offset:24576
    v_mfma_f32_16x16x32_bf16 v[220:223], a[120:123], a[220:223], v[220:223]
    v_mfma_f32_16x16x32_bf16 v[252:255], a[124:127], a[220:223], v[252:255]
    v_mfma_f32_16x16x32_bf16 v[104:107], a[132:135], a[208:211], v[104:107]
    v_mfma_f32_16x16x32_bf16 v[68:71], a[128:131], a[208:211], v[68:71]
    v_mfma_f32_16x16x32_bf16 v[72:75], a[128:131], a[212:215], v[72:75]
    ds_read_b128 a[228:231], v10 offset:26624
    v_mfma_f32_16x16x32_bf16 v[108:111], a[132:135], a[212:215], v[108:111]
    v_mfma_f32_16x16x32_bf16 v[112:115], a[132:135], a[216:219], v[112:115]
    v_mfma_f32_16x16x32_bf16 v[76:79], a[128:131], a[216:219], v[76:79]
    v_mfma_f32_16x16x32_bf16 v[80:83], a[128:131], a[220:223], v[80:83]
    v_mfma_f32_16x16x32_bf16 v[116:119], a[132:135], a[220:223], v[116:119]
    ds_read_b128 a[232:235], v10 offset:28672
    v_mfma_f32_16x16x32_bf16 v[176:179], a[208:211], a[140:143], v[176:179]
    v_mfma_f32_16x16x32_bf16 v[140:143], a[208:211], a[136:139], v[140:143]
    v_mfma_f32_16x16x32_bf16 v[144:147], a[212:215], a[136:139], v[144:147]
    v_mfma_f32_16x16x32_bf16 v[180:183], a[212:215], a[140:143], v[180:183]
    v_mfma_f32_16x16x32_bf16 v[184:187], a[216:219], a[140:143], v[184:187]
    ds_read_b128 a[236:239], v10 offset:30720
    v_mfma_f32_16x16x32_bf16 v[148:151], a[216:219], a[136:139], v[148:151]
    v_mfma_f32_16x16x32_bf16 v[152:155], a[220:223], a[136:139], v[152:155]
    v_mfma_f32_16x16x32_bf16 v[188:191], a[220:223], a[140:143], v[188:191]
    s_waitcnt lgkmcnt(0)
    v_mfma_f32_16x16x32_bf16 v[240:243], a[148:151], a[224:227], v[240:243]
    v_mfma_f32_16x16x32_bf16 v[208:211], a[144:147], a[224:227], v[208:211]
    v_mfma_f32_16x16x32_bf16 v[212:215], a[144:147], a[228:231], v[212:215]
    v_mfma_f32_16x16x32_bf16 v[244:247], a[148:151], a[228:231], v[244:247]
    v_mfma_f32_16x16x32_bf16 v[248:251], a[148:151], a[232:235], v[248:251]
    v_mfma_f32_16x16x32_bf16 v[216:219], a[144:147], a[232:235], v[216:219]
    v_mfma_f32_16x16x32_bf16 v[220:223], a[144:147], a[236:239], v[220:223]
    v_mfma_f32_16x16x32_bf16 v[252:255], a[148:151], a[236:239], v[252:255]
    v_mfma_f32_16x16x32_bf16 v[104:107], a[156:159], a[224:227], v[104:107]
    v_mfma_f32_16x16x32_bf16 v[68:71], a[152:155], a[224:227], v[68:71]
    v_cvt_pk_bf16_f32 v208, v208, v209
    v_cvt_pk_bf16_f32 v209, v210, v211
    v_mfma_f32_16x16x32_bf16 v[72:75], a[152:155], a[228:231], v[72:75]
    v_cvt_pk_bf16_f32 v210, v240, v241
    v_cvt_pk_bf16_f32 v211, v242, v243
    v_mfma_f32_16x16x32_bf16 v[108:111], a[156:159], a[228:231], v[108:111]
    v_cvt_pk_bf16_f32 v212, v212, v213
    v_cvt_pk_bf16_f32 v213, v214, v215
    v_mfma_f32_16x16x32_bf16 v[112:115], a[156:159], a[232:235], v[112:115]
    v_cvt_pk_bf16_f32 v214, v244, v245
    v_cvt_pk_bf16_f32 v215, v246, v247
    v_mfma_f32_16x16x32_bf16 v[76:79], a[152:155], a[232:235], v[76:79]
    v_cvt_pk_bf16_f32 v216, v216, v217
    v_cvt_pk_bf16_f32 v217, v218, v219
    v_mfma_f32_16x16x32_bf16 v[80:83], a[152:155], a[236:239], v[80:83]
    v_cvt_pk_bf16_f32 v218, v248, v249
    v_cvt_pk_bf16_f32 v219, v250, v251
    v_mfma_f32_16x16x32_bf16 v[116:119], a[156:159], a[236:239], v[116:119]
    v_cvt_pk_bf16_f32 v220, v220, v221
    v_cvt_pk_bf16_f32 v221, v222, v223
    v_mfma_f32_16x16x32_bf16 v[176:179], a[224:227], a[164:167], v[176:179]
    v_cvt_pk_bf16_f32 v222, v252, v253
    v_cvt_pk_bf16_f32 v223, v254, v255
    v_mfma_f32_16x16x32_bf16 v[140:143], a[224:227], a[160:163], v[140:143]
    v_cvt_pk_bf16_f32 v68, v68, v69
    v_cvt_pk_bf16_f32 v69, v70, v71
    v_mfma_f32_16x16x32_bf16 v[144:147], a[228:231], a[160:163], v[144:147]
    v_cvt_pk_bf16_f32 v70, v104, v105
    v_cvt_pk_bf16_f32 v71, v106, v107
    v_mfma_f32_16x16x32_bf16 v[180:183], a[228:231], a[164:167], v[180:183]
    v_cvt_pk_bf16_f32 v72, v72, v73
    v_cvt_pk_bf16_f32 v73, v74, v75
    v_mfma_f32_16x16x32_bf16 v[184:187], a[232:235], a[164:167], v[184:187]
    v_cvt_pk_bf16_f32 v74, v108, v109
    v_cvt_pk_bf16_f32 v75, v110, v111
    v_mfma_f32_16x16x32_bf16 v[148:151], a[232:235], a[160:163], v[148:151]
    v_cvt_pk_bf16_f32 v76, v76, v77
    v_cvt_pk_bf16_f32 v77, v78, v79
    v_mfma_f32_16x16x32_bf16 v[152:155], a[236:239], a[160:163], v[152:155]
    v_cvt_pk_bf16_f32 v78, v112, v113
    v_cvt_pk_bf16_f32 v79, v114, v115
    v_mfma_f32_16x16x32_bf16 v[188:191], a[236:239], a[164:167], v[188:191]
    v_cvt_pk_bf16_f32 v80, v80, v81
    v_cvt_pk_bf16_f32 v81, v82, v83
    v_cvt_pk_bf16_f32 v82, v116, v117
    v_cvt_pk_bf16_f32 v83, v118, v119
    v_mfma_f32_16x16x32_bf16 v[156:159], v[64:67], v[208:211], 0
    v_mfma_f32_16x16x32_bf16 v[160:163], v[68:71], v[208:211], 0
    v_mfma_f32_16x16x32_bf16 v[164:167], v[68:71], v[212:215], 0
    v_mfma_f32_16x16x32_bf16 v[168:171], v[72:75], v[212:215], 0
    v_mfma_f32_16x16x32_bf16 v[224:227], v[72:75], v[216:219], 0
    v_mfma_f32_16x16x32_bf16 v[228:231], v[76:79], v[216:219], 0
    v_mfma_f32_16x16x32_bf16 v[232:235], v[76:79], v[220:223], 0
    v_mfma_f32_16x16x32_bf16 v[236:239], v[80:83], v[220:223], 0
    v_cvt_pk_bf16_f32 v94, v140, v141
    v_cndmask_b32 v156, v156, v157, s[80:81]
    v_cndmask_b32 v157, v158, v159, s[80:81]
    v_cndmask_b32 v160, v160, v161, s[80:81]
    v_cndmask_b32 v161, v162, v163, s[80:81]
    v_cndmask_b32 v156, v156, v160, s[82:83]
    v_cndmask_b32 v157, v157, v161, s[84:85]
    v_max_f32 v158, v156, v157
    v_cndmask_b32 v164, v164, v165, s[80:81]
    v_cndmask_b32 v165, v166, v167, s[80:81]
    v_cndmask_b32 v168, v168, v169, s[80:81]
    v_cndmask_b32 v169, v170, v171, s[80:81]
    v_cndmask_b32 v164, v164, v168, s[82:83]
    v_cndmask_b32 v165, v165, v169, s[84:85]
    v_max_f32 v166, v164, v165
    v_cndmask_b32 v224, v224, v225, s[80:81]
    v_cndmask_b32 v225, v226, v227, s[80:81]
    v_cndmask_b32 v228, v228, v229, s[80:81]
    v_cndmask_b32 v229, v230, v231, s[80:81]
    v_cndmask_b32 v224, v224, v228, s[82:83]
    v_cndmask_b32 v225, v225, v229, s[84:85]
    v_max_f32 v226, v224, v225
    v_cndmask_b32 v232, v232, v233, s[80:81]
    v_cndmask_b32 v233, v234, v235, s[80:81]
    v_cndmask_b32 v236, v236, v237, s[80:81]
    v_cndmask_b32 v237, v238, v239, s[80:81]
    v_cndmask_b32 v232, v232, v236, s[82:83]
    v_cndmask_b32 v233, v233, v237, s[84:85]
    v_max_f32 v234, v232, v233
    v_permlane32_swap_b32 v158, v226
    v_cvt_pk_bf16_f32 v95, v142, v143
    v_permlane32_swap_b32 v166, v234
    v_max_f32 v158, v158, v226
    v_max_f32 v166, v166, v234
    v_cvt_pk_bf16_f32 v96, v144, v145
    v_cvt_pk_bf16_f32 v97, v146, v147
    v_permlane16_swap_b32 v158, v166
    v_max_f32 v158, v158, v166
    v_mul_f32 v158, s92, v158
    v_mov_b32 v166, v158
    v_cvt_pk_bf16_f32 v98, v148, v149
    v_cvt_pk_bf16_f32 v99, v150, v151
    v_permlane16_swap_b32 v158, v166
    v_mov_b32 v226, v158
    v_mov_b32 v234, v166
    v_cvt_pk_bf16_f32 v100, v152, v153
    v_permlane32_swap_b32 v158, v226
    v_permlane32_swap_b32 v166, v234
    v_pk_fma_f32 v[156:157], v[156:157], s[92:93], v[158:159] op_sel_hi:[1,0,0] neg_lo:[0,0,1] neg_hi:[0,0,1]
    v_pk_fma_f32 v[164:165], v[164:165], s[92:93], v[166:167] op_sel_hi:[1,0,0] neg_lo:[0,0,1] neg_hi:[0,0,1]
    v_pk_fma_f32 v[224:225], v[224:225], s[92:93], v[226:227] op_sel_hi:[1,0,0] neg_lo:[0,0,1] neg_hi:[0,0,1]
    v_pk_fma_f32 v[232:233], v[232:233], s[92:93], v[234:235] op_sel_hi:[1,0,0] neg_lo:[0,0,1] neg_hi:[0,0,1]
    v_exp_f32 v156, v156
    v_exp_f32 v157, v157
    v_exp_f32 v164, v164
    v_exp_f32 v165, v165
    v_exp_f32 v224, v224
    v_exp_f32 v225, v225
    v_exp_f32 v232, v232
    v_exp_f32 v233, v233
    v_add_f32 v158, v156, v157
    v_add_f32 v166, v164, v165
    v_add_f32 v226, v224, v225
    v_add_f32 v234, v232, v233
    v_cvt_pk_bf16_f32 v101, v154, v155
    v_permlane32_swap_b32 v158, v226
    v_permlane32_swap_b32 v166, v234
    v_add_f32 v158, v158, v226
    v_add_f32 v166, v166, v234
    v_cvt_pk_bf16_f32 v130, v176, v177
    v_cvt_pk_bf16_f32 v131, v178, v179
    v_permlane16_swap_b32 v158, v166
    v_add_f32 v158, v158, v166
    v_rcp_f32 v158, v158
    v_cvt_pk_bf16_f32 v132, v180, v181
    v_cvt_pk_bf16_f32 v133, v182, v183
    v_cvt_pk_bf16_f32 v134, v184, v185
    v_cvt_pk_bf16_f32 v135, v186, v187
    v_cvt_pk_bf16_f32 v136, v188, v189
    v_cvt_pk_bf16_f32 v137, v190, v191
    v_mul_f32 v158, v158, v45
    v_mov_b32 v166, v158
    s_nop 1
    v_permlane16_swap_b32 v158, v166
    v_mov_b32 v226, v158
    v_mov_b32 v234, v166
    s_nop 0
    v_permlane32_swap_b32 v158, v226
    v_permlane32_swap_b32 v166, v234
    v_pk_mul_f32 v[156:157], v[156:157], v[158:159] op_sel:[0,0] op_sel_hi:[1,0]
    v_pk_mul_f32 v[164:165], v[164:165], v[166:167] op_sel:[0,0] op_sel_hi:[1,0]
    v_pk_mul_f32 v[224:225], v[224:225], v[226:227] op_sel:[0,0] op_sel_hi:[1,0]
    v_pk_mul_f32 v[232:233], v[232:233], v[234:235] op_sel:[0,0] op_sel_hi:[1,0]
    v_cvt_pk_bf16_f32 v159, v156, v157
    v_cvt_pk_bf16_f32 v167, v164, v165
    v_cvt_pk_bf16_f32 v227, v224, v225
    v_cvt_pk_bf16_f32 v235, v232, v233
    v_perm_b32 v160, v159, v159, v21
    v_perm_b32 v161, v159, v159, v22
    v_perm_b32 v162, v159, v159, v23
    v_perm_b32 v163, v159, v159, v24
    v_perm_b32 v168, v167, v167, v21
    v_perm_b32 v169, v167, v167, v22
    v_perm_b32 v170, v167, v167, v23
    v_perm_b32 v171, v167, v167, v24
    v_perm_b32 v228, v227, v227, v21
    v_perm_b32 v229, v227, v227, v22
    v_perm_b32 v230, v227, v227, v23
    v_perm_b32 v231, v227, v227, v24
    v_perm_b32 v236, v235, v235, v21
    v_perm_b32 v237, v235, v235, v22
    v_perm_b32 v238, v235, v235, v23
    v_perm_b32 v239, v235, v235, v24
    v_mfma_f32_16x16x32_bf16 v[156:159], v[92:95], v[160:163], 0
    v_mfma_f32_16x16x32_bf16 v[208:211], v[128:131], v[160:163], 0
    v_mfma_f32_16x16x32_bf16 v[164:167], v[94:97], v[168:171], 0
    v_mfma_f32_16x16x32_bf16 v[212:215], v[130:133], v[168:171], 0
    v_mfma_f32_16x16x32_bf16 v[224:227], v[96:99], v[228:231], 0
    v_mfma_f32_16x16x32_bf16 v[216:219], v[132:135], v[228:231], 0
    v_mfma_f32_16x16x32_bf16 v[232:235], v[98:101], v[236:239], 0
    v_mfma_f32_16x16x32_bf16 v[220:223], v[134:137], v[236:239], 0
    s_nop 0
    v_cvt_pk_bf16_f32 v156, v156, v157
    v_cvt_pk_bf16_f32 v157, v158, v159
    v_cvt_pk_bf16_f32 v158, v208, v209
    v_cvt_pk_bf16_f32 v159, v210, v211
    buffer_store_dwordx4 v[156:159], v26, s[36:39], s73 offen sc1
    s_add_u32 s73, s73, 74752
    v_cvt_pk_bf16_f32 v164, v164, v165
    v_cvt_pk_bf16_f32 v165, v166, v167
    v_cvt_pk_bf16_f32 v166, v212, v213
    v_cvt_pk_bf16_f32 v167, v214, v215
    buffer_store_dwordx4 v[164:167], v26, s[36:39], s73 offen sc1
    s_add_u32 s73, s73, 74752
    v_cvt_pk_bf16_f32 v224, v224, v225
    v_cvt_pk_bf16_f32 v225, v226, v227
    v_cvt_pk_bf16_f32 v226, v216, v217
    v_cvt_pk_bf16_f32 v227, v218, v219
    buffer_store_dwordx4 v[224:227], v26, s[36:39], s73 offen sc1
    s_add_u32 s73, s73, 74752
    v_cvt_pk_bf16_f32 v232, v232, v233
    v_cvt_pk_bf16_f32 v233, v234, v235
    v_cvt_pk_bf16_f32 v234, v220, v221
    v_cvt_pk_bf16_f32 v235, v222, v223
    buffer_store_dwordx4 v[232:235], v26, s[36:39], s73 offen sc1
    s_add_u32 s73, s73, 74752
    s_lshl_b32 s26, s93, 2
    s_add_u32 s26, s26, s79
    s_lshl_b32 s26, s26, 7
    s_add_u32 s26, s26, 108544
    v_mov_b32 v1, 1
    s_waitcnt vmcnt(0)
    s_mov_b64 exec, 1
    buffer_atomic_add v1, off, s[52:55], s26 sc1
    s_mov_b64 exec, -1
    s_endpgm
L_slow_o:
    s_sub_u32 s9, s9, 1
    s_cbranch_scc1 L_end
    buffer_load_dword v47, off, s[96:99], 0 offset:128 sc1
    s_waitcnt vmcnt(0)
    v_readfirstlane_b32 s10, v47
    s_nop 3
    s_cmp_lt_u32 s10, 40
    s_cbranch_scc1 L_slow_o
    s_branch L_back_o
L_idle:
    v_lshlrev_b32 v1, 7, v0
    s_lshr_b32 s10, 0x2000000, s64
    s_and_b32 s10, s10, 0xff
    s_add_u32 s10, s10, s11
    s_sub_u32 s10, s10, s26
    s_lshl_b32 s10, s10, 2
    s_add_u32 s10, s10, s3
    s_mul_i32 s11, s27, 20
    s_add_u32 s11, s11, s10
    s_lshl_b32 s11, s11, 13
    s_lshl_b32 s26, s27, 7
    s_add_u32 s26, s26, s10
    s_cmp_lt_u32 s10, 8
    s_cselect_b32 s66, 0, 1073741824
    v_and_b32 v2, 7, v0
    v_lshlrev_b32 v2, 4, v2
    v_lshrrev_b32 v3, 3, v0
    s_movk_i32 s27, 896
    v_mad_u32_u24 v4, v3, s27, v2
    v_lshlrev_b32 v3, 2, v3
    s_mul_i32 s65, s26, 7168
    s_lshl_b32 s26, s26, 5
    v_mov_b32 v38, 0
    s_waitcnt lgkmcnt(0)
    s_mov_b32 s52, s24
    s_mov_b32 s53, s25
    s_mov_b32 s54, 131072
    s_mov_b32 s55, 0x20000
    s_mov_b32 s96, s22
    s_mov_b32 s97, s23
    s_mov_b32 s98, 256
    s_mov_b32 s99, 0x20000
    s_cmp_lg_u32 s11, 0
    s_cbranch_scc1 L_pre
    v_mov_b32 v5, 0
    v_mov_b32 v6, 1
    s_mov_b32 s27, 81920
    buffer_store_dword v5, v1, s[52:55], s27 offen sc1
    s_mov_b32 s27, 90112
    buffer_store_dword v5, v1, s[52:55], s27 offen sc1
    s_mov_b32 s27, 98304
    buffer_store_dword v5, v1, s[52:55], s27 offen sc1
    s_mov_b32 s27, 106496
    buffer_store_dword v5, v1, s[52:55], s27 offen sc1
    s_mov_b32 s27, 114688
    buffer_store_dword v5, v1, s[52:55], s27 offen sc1
    s_waitcnt vmcnt(0)
    s_mov_b64 exec, 1
    buffer_store_dword v6, off, s[96:99], 0 sc1
    s_mov_b64 exec, -1
L_pre:
    s_mov_b32 s44, s16
    s_mov_b32 s45, s17
    s_mov_b32 s46, 1605632
    s_mov_b32 s47, 0x20000
    s_mov_b32 s48, s8
    s_mov_b32 s49, s9
    s_mov_b32 s50, 401408
    s_mov_b32 s51, 0x20000
    s_mov_b32 s28, s4
    s_mov_b32 s29, s5
    s_mov_b32 s30, 1835008
    s_mov_b32 s31, 0x20000
    s_mov_b32 s32, s18
    s_mov_b32 s33, s19
    s_mov_b32 s34, 896
    s_mov_b32 s35, 0x20000
    buffer_load_dwordx4 v[8:11], v2, s[32:35], 0 offen offset:0
    buffer_load_dwordx4 v[12:15], v2, s[32:35], 0 offen offset:128
    buffer_load_dwordx4 v[16:19], v2, s[32:35], 0 offen offset:256
    buffer_load_dwordx4 v[20:23], v2, s[32:35], 0 offen offset:384
    buffer_load_dwordx4 v[24:27], v2, s[32:35], 0 offen offset:512
    buffer_load_dwordx4 v[28:31], v2, s[32:35], 0 offen offset:640
    buffer_load_dwordx4 v[32:35], v2, s[32:35], 0 offen offset:768
    s_waitcnt vmcnt(0)
    s_mov_b32 s10, 0x3f803f80
    s_mov_b32 s72, 0xbfb8aa3b
    v_and_b32 v40, 0xffff, v8
    v_and_b32 v41, 0xffff0000, v8
    v_and_b32 v42, 0xffff, v9
    v_and_b32 v43, 0xffff0000, v9
    v_and_b32 v44, 0xffff, v10
    v_and_b32 v45, 0xffff0000, v10
    v_and_b32 v46, 0xffff, v11
    v_and_b32 v47, 0xffff0000, v11
    v_and_b32 v48, 0xffff, v12
    v_and_b32 v49, 0xffff0000, v12
    v_and_b32 v50, 0xffff, v13
    v_and_b32 v51, 0xffff0000, v13
    v_and_b32 v52, 0xffff, v14
    v_and_b32 v53, 0xffff0000, v14
    v_and_b32 v54, 0xffff, v15
    v_and_b32 v55, 0xffff0000, v15
    v_and_b32 v56, 0xffff, v16
    v_and_b32 v57, 0xffff0000, v16
    v_and_b32 v58, 0xffff, v17
    v_and_b32 v59, 0xffff0000, v17
    v_and_b32 v60, 0xffff, v18
    v_and_b32 v61, 0xffff0000, v18
    v_and_b32 v62, 0xffff, v19
    v_and_b32 v63, 0xffff0000, v19
    v_and_b32 v64, 0xffff, v20
    v_and_b32 v65, 0xffff0000, v20
    v_and_b32 v66, 0xffff, v21
    v_and_b32 v67, 0xffff0000, v21
    v_and_b32 v68, 0xffff, v22
    v_and_b32 v69, 0xffff0000, v22
    v_and_b32 v70, 0xffff, v23
    v_and_b32 v71, 0xffff0000, v23
    v_and_b32 v72, 0xffff, v24
    v_and_b32 v73, 0xffff0000, v24
    v_and_b32 v74, 0xffff, v25
    v_and_b32 v75, 0xffff0000, v25
    v_and_b32 v76, 0xffff, v26
    v_and_b32 v77, 0xffff0000, v26
    v_and_b32 v78, 0xffff, v27
    v_and_b32 v79, 0xffff0000, v27
    v_and_b32 v80, 0xffff, v28
    v_and_b32 v81, 0xffff0000, v28
    v_and_b32 v82, 0xffff, v29
    v_and_b32 v83, 0xffff0000, v29
    v_and_b32 v84, 0xffff, v30
    v_and_b32 v85, 0xffff0000, v30
    v_and_b32 v86, 0xffff, v31
    v_and_b32 v87, 0xffff0000, v31
    v_and_b32 v88, 0xffff, v32
    v_and_b32 v89, 0xffff0000, v32
    v_and_b32 v90, 0xffff, v33
    v_and_b32 v91, 0xffff0000, v33
    v_and_b32 v92, 0xffff, v34
    v_and_b32 v93, 0xffff0000, v34
    v_and_b32 v94, 0xffff, v35
    v_and_b32 v95, 0xffff0000, v35
    buffer_load_dwordx4 v[96:99], v4, s[28:31], s65 offen offset:0
    buffer_load_dwordx4 v[100:103], v4, s[28:31], s65 offen offset:128
    buffer_load_dwordx4 v[104:107], v4, s[28:31], s65 offen offset:256
    buffer_load_dwordx4 v[108:111], v4, s[28:31], s65 offen offset:384
    buffer_load_dwordx4 v[112:115], v4, s[28:31], s65 offen offset:512
    buffer_load_dwordx4 v[116:119], v4, s[28:31], s65 offen offset:640
    buffer_load_dwordx4 v[120:123], v4, s[28:31], s65 offen offset:768
    s_add_u32 s65, s65, 143360
    buffer_load_dwordx4 v[124:127], v4, s[28:31], s65 offen offset:0
    buffer_load_dwordx4 v[128:131], v4, s[28:31], s65 offen offset:128
    buffer_load_dwordx4 v[132:135], v4, s[28:31], s65 offen offset:256
    buffer_load_dwordx4 v[136:139], v4, s[28:31], s65 offen offset:384
    buffer_load_dwordx4 v[140:143], v4, s[28:31], s65 offen offset:512
    buffer_load_dwordx4 v[144:147], v4, s[28:31], s65 offen offset:640
    buffer_load_dwordx4 v[148:151], v4, s[28:31], s65 offen offset:768
    s_add_u32 s65, s65, 143360
    buffer_load_dwordx4 v[152:155], v4, s[28:31], s65 offen offset:0
    buffer_load_dwordx4 v[156:159], v4, s[28:31], s65 offen offset:128
    buffer_load_dwordx4 v[160:163], v4, s[28:31], s65 offen offset:256
    buffer_load_dwordx4 v[164:167], v4, s[28:31], s65 offen offset:384
    buffer_load_dwordx4 v[168:171], v4, s[28:31], s65 offen offset:512
    buffer_load_dwordx4 v[172:175], v4, s[28:31], s65 offen offset:640
    buffer_load_dwordx4 v[176:179], v4, s[28:31], s65 offen offset:768
    s_add_u32 s65, s65, 143360
    s_waitcnt vmcnt(14)
    v_mov_b32 v5, 0
    v_dot2_f32_bf16 v6, v96, v40, 0
    v_dot2_f32_bf16 v7, v96, v41, 0
    v_dot2_f32_bf16 v36, v97, v42, 0
    v_dot2_f32_bf16 v37, v97, v43, 0
    v_dot2_f32_bf16 v180, v98, v44, 0
    v_dot2_f32_bf16 v181, v98, v45, 0
    v_cvt_pk_bf16_f32 v6, v6, v7
    v_dot2_f32_bf16 v182, v99, v46, 0
    v_dot2_f32_bf16 v183, v99, v47, 0
    v_cvt_pk_bf16_f32 v36, v36, v37
    v_dot2c_f32_bf16 v5, s10, v6
    v_dot2_f32_bf16 v6, v100, v48, 0
    v_dot2_f32_bf16 v7, v100, v49, 0
    v_cvt_pk_bf16_f32 v180, v180, v181
    v_dot2c_f32_bf16 v5, s10, v36
    v_dot2_f32_bf16 v36, v101, v50, 0
    v_dot2_f32_bf16 v37, v101, v51, 0
    v_cvt_pk_bf16_f32 v182, v182, v183
    v_dot2c_f32_bf16 v5, s10, v180
    v_dot2_f32_bf16 v180, v102, v52, 0
    v_dot2_f32_bf16 v181, v102, v53, 0
    v_cvt_pk_bf16_f32 v6, v6, v7
    v_dot2c_f32_bf16 v5, s10, v182
    v_dot2_f32_bf16 v182, v103, v54, 0
    v_dot2_f32_bf16 v183, v103, v55, 0
    v_cvt_pk_bf16_f32 v36, v36, v37
    v_dot2c_f32_bf16 v5, s10, v6
    v_dot2_f32_bf16 v6, v104, v56, 0
    v_dot2_f32_bf16 v7, v104, v57, 0
    v_cvt_pk_bf16_f32 v180, v180, v181
    v_dot2c_f32_bf16 v5, s10, v36
    v_dot2_f32_bf16 v36, v105, v58, 0
    v_dot2_f32_bf16 v37, v105, v59, 0
    v_cvt_pk_bf16_f32 v182, v182, v183
    v_dot2c_f32_bf16 v5, s10, v180
    v_dot2_f32_bf16 v180, v106, v60, 0
    v_dot2_f32_bf16 v181, v106, v61, 0
    v_cvt_pk_bf16_f32 v6, v6, v7
    v_dot2c_f32_bf16 v5, s10, v182
    v_dot2_f32_bf16 v182, v107, v62, 0
    v_dot2_f32_bf16 v183, v107, v63, 0
    v_cvt_pk_bf16_f32 v36, v36, v37
    v_dot2c_f32_bf16 v5, s10, v6
    v_dot2_f32_bf16 v6, v108, v64, 0
    v_dot2_f32_bf16 v7, v108, v65, 0
    v_cvt_pk_bf16_f32 v180, v180, v181
    v_dot2c_f32_bf16 v5, s10, v36
    v_dot2_f32_bf16 v36, v109, v66, 0
    v_dot2_f32_bf16 v37, v109, v67, 0
    v_cvt_pk_bf16_f32 v182, v182, v183
    v_dot2c_f32_bf16 v5, s10, v180
    v_dot2_f32_bf16 v180, v110, v68, 0
    v_dot2_f32_bf16 v181, v110, v69, 0
    v_cvt_pk_bf16_f32 v6, v6, v7
    v_dot2c_f32_bf16 v5, s10, v182
    v_dot2_f32_bf16 v182, v111, v70, 0
    v_dot2_f32_bf16 v183, v111, v71, 0
    v_cvt_pk_bf16_f32 v36, v36, v37
    v_dot2c_f32_bf16 v5, s10, v6
    v_dot2_f32_bf16 v6, v112, v72, 0
    v_dot2_f32_bf16 v7, v112, v73, 0
    v_cvt_pk_bf16_f32 v180, v180, v181
    v_dot2c_f32_bf16 v5, s10, v36
    v_dot2_f32_bf16 v36, v113, v74, 0
    v_dot2_f32_bf16 v37, v113, v75, 0
    v_cvt_pk_bf16_f32 v182, v182, v183
    v_dot2c_f32_bf16 v5, s10, v180
    v_dot2_f32_bf16 v180, v114, v76, 0
    v_dot2_f32_bf16 v181, v114, v77, 0
    v_cvt_pk_bf16_f32 v6, v6, v7
    v_dot2c_f32_bf16 v5, s10, v182
    v_dot2_f32_bf16 v182, v115, v78, 0
    v_dot2_f32_bf16 v183, v115, v79, 0
    v_cvt_pk_bf16_f32 v36, v36, v37
    v_dot2c_f32_bf16 v5, s10, v6
    v_dot2_f32_bf16 v6, v116, v80, 0
    v_dot2_f32_bf16 v7, v116, v81, 0
    v_cvt_pk_bf16_f32 v180, v180, v181
    v_dot2c_f32_bf16 v5, s10, v36
    v_dot2_f32_bf16 v36, v117, v82, 0
    v_dot2_f32_bf16 v37, v117, v83, 0
    v_cvt_pk_bf16_f32 v182, v182, v183
    v_dot2c_f32_bf16 v5, s10, v180
    v_dot2_f32_bf16 v180, v118, v84, 0
    v_dot2_f32_bf16 v181, v118, v85, 0
    v_cvt_pk_bf16_f32 v6, v6, v7
    v_dot2c_f32_bf16 v5, s10, v182
    v_dot2_f32_bf16 v182, v119, v86, 0
    v_dot2_f32_bf16 v183, v119, v87, 0
    v_cvt_pk_bf16_f32 v36, v36, v37
    v_dot2c_f32_bf16 v5, s10, v6
    v_dot2_f32_bf16 v6, v120, v88, 0
    v_dot2_f32_bf16 v7, v120, v89, 0
    v_cvt_pk_bf16_f32 v180, v180, v181
    v_dot2c_f32_bf16 v5, s10, v36
    v_dot2_f32_bf16 v36, v121, v90, 0
    v_dot2_f32_bf16 v37, v121, v91, 0
    v_cvt_pk_bf16_f32 v182, v182, v183
    v_dot2c_f32_bf16 v5, s10, v180
    v_dot2_f32_bf16 v180, v122, v92, 0
    v_dot2_f32_bf16 v181, v122, v93, 0
    v_cvt_pk_bf16_f32 v6, v6, v7
    v_dot2c_f32_bf16 v5, s10, v182
    v_dot2_f32_bf16 v182, v123, v94, 0
    v_dot2_f32_bf16 v183, v123, v95, 0
    v_cvt_pk_bf16_f32 v36, v36, v37
    v_dot2c_f32_bf16 v5, s10, v6
    v_cvt_pk_bf16_f32 v180, v180, v181
    v_dot2c_f32_bf16 v5, s10, v36
    v_cvt_pk_bf16_f32 v182, v182, v183
    v_dot2c_f32_bf16 v5, s10, v180
    v_dot2c_f32_bf16 v5, s10, v182
    s_nop 2
    v_add_f32_dpp v5, v5, v5 quad_perm:[1,0,3,2] row_mask:0xf bank_mask:0xf
    s_nop 1
    v_add_f32_dpp v5, v5, v5 quad_perm:[2,3,0,1] row_mask:0xf bank_mask:0xf
    s_nop 1
    v_add_f32_dpp v5, v5, v5 row_half_mirror row_mask:0xf bank_mask:0xf
    v_cmp_eq_u32 vcc, 0, v2
    s_nop 1
    v_cndmask_b32 v38, v38, v5, vcc
    buffer_load_dwordx4 v[96:99], v4, s[28:31], s65 offen offset:0
    buffer_load_dwordx4 v[100:103], v4, s[28:31], s65 offen offset:128
    buffer_load_dwordx4 v[104:107], v4, s[28:31], s65 offen offset:256
    buffer_load_dwordx4 v[108:111], v4, s[28:31], s65 offen offset:384
    buffer_load_dwordx4 v[112:115], v4, s[28:31], s65 offen offset:512
    buffer_load_dwordx4 v[116:119], v4, s[28:31], s65 offen offset:640
    buffer_load_dwordx4 v[120:123], v4, s[28:31], s65 offen offset:768
    s_add_u32 s65, s65, 143360
    s_waitcnt vmcnt(14)
    v_mov_b32 v5, 0
    v_dot2_f32_bf16 v6, v124, v40, 0
    v_dot2_f32_bf16 v7, v124, v41, 0
    v_dot2_f32_bf16 v36, v125, v42, 0
    v_dot2_f32_bf16 v37, v125, v43, 0
    v_dot2_f32_bf16 v180, v126, v44, 0
    v_dot2_f32_bf16 v181, v126, v45, 0
    v_cvt_pk_bf16_f32 v6, v6, v7
    v_dot2_f32_bf16 v182, v127, v46, 0
    v_dot2_f32_bf16 v183, v127, v47, 0
    v_cvt_pk_bf16_f32 v36, v36, v37
    v_dot2c_f32_bf16 v5, s10, v6
    v_dot2_f32_bf16 v6, v128, v48, 0
    v_dot2_f32_bf16 v7, v128, v49, 0
    v_cvt_pk_bf16_f32 v180, v180, v181
    v_dot2c_f32_bf16 v5, s10, v36
    v_dot2_f32_bf16 v36, v129, v50, 0
    v_dot2_f32_bf16 v37, v129, v51, 0
    v_cvt_pk_bf16_f32 v182, v182, v183
    v_dot2c_f32_bf16 v5, s10, v180
    v_dot2_f32_bf16 v180, v130, v52, 0
    v_dot2_f32_bf16 v181, v130, v53, 0
    v_cvt_pk_bf16_f32 v6, v6, v7
    v_dot2c_f32_bf16 v5, s10, v182
    v_dot2_f32_bf16 v182, v131, v54, 0
    v_dot2_f32_bf16 v183, v131, v55, 0
    v_cvt_pk_bf16_f32 v36, v36, v37
    v_dot2c_f32_bf16 v5, s10, v6
    v_dot2_f32_bf16 v6, v132, v56, 0
    v_dot2_f32_bf16 v7, v132, v57, 0
    v_cvt_pk_bf16_f32 v180, v180, v181
    v_dot2c_f32_bf16 v5, s10, v36
    v_dot2_f32_bf16 v36, v133, v58, 0
    v_dot2_f32_bf16 v37, v133, v59, 0
    v_cvt_pk_bf16_f32 v182, v182, v183
    v_dot2c_f32_bf16 v5, s10, v180
    v_dot2_f32_bf16 v180, v134, v60, 0
    v_dot2_f32_bf16 v181, v134, v61, 0
    v_cvt_pk_bf16_f32 v6, v6, v7
    v_dot2c_f32_bf16 v5, s10, v182
    v_dot2_f32_bf16 v182, v135, v62, 0
    v_dot2_f32_bf16 v183, v135, v63, 0
    v_cvt_pk_bf16_f32 v36, v36, v37
    v_dot2c_f32_bf16 v5, s10, v6
    v_dot2_f32_bf16 v6, v136, v64, 0
    v_dot2_f32_bf16 v7, v136, v65, 0
    v_cvt_pk_bf16_f32 v180, v180, v181
    v_dot2c_f32_bf16 v5, s10, v36
    v_dot2_f32_bf16 v36, v137, v66, 0
    v_dot2_f32_bf16 v37, v137, v67, 0
    v_cvt_pk_bf16_f32 v182, v182, v183
    v_dot2c_f32_bf16 v5, s10, v180
    v_dot2_f32_bf16 v180, v138, v68, 0
    v_dot2_f32_bf16 v181, v138, v69, 0
    v_cvt_pk_bf16_f32 v6, v6, v7
    v_dot2c_f32_bf16 v5, s10, v182
    v_dot2_f32_bf16 v182, v139, v70, 0
    v_dot2_f32_bf16 v183, v139, v71, 0
    v_cvt_pk_bf16_f32 v36, v36, v37
    v_dot2c_f32_bf16 v5, s10, v6
    v_dot2_f32_bf16 v6, v140, v72, 0
    v_dot2_f32_bf16 v7, v140, v73, 0
    v_cvt_pk_bf16_f32 v180, v180, v181
    v_dot2c_f32_bf16 v5, s10, v36
    v_dot2_f32_bf16 v36, v141, v74, 0
    v_dot2_f32_bf16 v37, v141, v75, 0
    v_cvt_pk_bf16_f32 v182, v182, v183
    v_dot2c_f32_bf16 v5, s10, v180
    v_dot2_f32_bf16 v180, v142, v76, 0
    v_dot2_f32_bf16 v181, v142, v77, 0
    v_cvt_pk_bf16_f32 v6, v6, v7
    v_dot2c_f32_bf16 v5, s10, v182
    v_dot2_f32_bf16 v182, v143, v78, 0
    v_dot2_f32_bf16 v183, v143, v79, 0
    v_cvt_pk_bf16_f32 v36, v36, v37
    v_dot2c_f32_bf16 v5, s10, v6
    v_dot2_f32_bf16 v6, v144, v80, 0
    v_dot2_f32_bf16 v7, v144, v81, 0
    v_cvt_pk_bf16_f32 v180, v180, v181
    v_dot2c_f32_bf16 v5, s10, v36
    v_dot2_f32_bf16 v36, v145, v82, 0
    v_dot2_f32_bf16 v37, v145, v83, 0
    v_cvt_pk_bf16_f32 v182, v182, v183
    v_dot2c_f32_bf16 v5, s10, v180
    v_dot2_f32_bf16 v180, v146, v84, 0
    v_dot2_f32_bf16 v181, v146, v85, 0
    v_cvt_pk_bf16_f32 v6, v6, v7
    v_dot2c_f32_bf16 v5, s10, v182
    v_dot2_f32_bf16 v182, v147, v86, 0
    v_dot2_f32_bf16 v183, v147, v87, 0
    v_cvt_pk_bf16_f32 v36, v36, v37
    v_dot2c_f32_bf16 v5, s10, v6
    v_dot2_f32_bf16 v6, v148, v88, 0
    v_dot2_f32_bf16 v7, v148, v89, 0
    v_cvt_pk_bf16_f32 v180, v180, v181
    v_dot2c_f32_bf16 v5, s10, v36
    v_dot2_f32_bf16 v36, v149, v90, 0
    v_dot2_f32_bf16 v37, v149, v91, 0
    v_cvt_pk_bf16_f32 v182, v182, v183
    v_dot2c_f32_bf16 v5, s10, v180
    v_dot2_f32_bf16 v180, v150, v92, 0
    v_dot2_f32_bf16 v181, v150, v93, 0
    v_cvt_pk_bf16_f32 v6, v6, v7
    v_dot2c_f32_bf16 v5, s10, v182
    v_dot2_f32_bf16 v182, v151, v94, 0
    v_dot2_f32_bf16 v183, v151, v95, 0
    v_cvt_pk_bf16_f32 v36, v36, v37
    v_dot2c_f32_bf16 v5, s10, v6
    v_cvt_pk_bf16_f32 v180, v180, v181
    v_dot2c_f32_bf16 v5, s10, v36
    v_cvt_pk_bf16_f32 v182, v182, v183
    v_dot2c_f32_bf16 v5, s10, v180
    v_dot2c_f32_bf16 v5, s10, v182
    s_nop 2
    v_add_f32_dpp v5, v5, v5 quad_perm:[1,0,3,2] row_mask:0xf bank_mask:0xf
    s_nop 1
    v_add_f32_dpp v5, v5, v5 quad_perm:[2,3,0,1] row_mask:0xf bank_mask:0xf
    s_nop 1
    v_add_f32_dpp v5, v5, v5 row_half_mirror row_mask:0xf bank_mask:0xf
    v_cmp_eq_u32 vcc, 16, v2
    s_nop 1
    v_cndmask_b32 v38, v38, v5, vcc
    buffer_load_dwordx4 v[124:127], v4, s[28:31], s65 offen offset:0
    buffer_load_dwordx4 v[128:131], v4, s[28:31], s65 offen offset:128
    buffer_load_dwordx4 v[132:135], v4, s[28:31], s65 offen offset:256
    buffer_load_dwordx4 v[136:139], v4, s[28:31], s65 offen offset:384
    buffer_load_dwordx4 v[140:143], v4, s[28:31], s65 offen offset:512
    buffer_load_dwordx4 v[144:147], v4, s[28:31], s65 offen offset:640
    buffer_load_dwordx4 v[148:151], v4, s[28:31], s65 offen offset:768
    s_add_u32 s65, s65, 143360
    s_waitcnt vmcnt(14)
    v_mov_b32 v5, 0
    v_dot2_f32_bf16 v6, v152, v40, 0
    v_dot2_f32_bf16 v7, v152, v41, 0
    v_dot2_f32_bf16 v36, v153, v42, 0
    v_dot2_f32_bf16 v37, v153, v43, 0
    v_dot2_f32_bf16 v180, v154, v44, 0
    v_dot2_f32_bf16 v181, v154, v45, 0
    v_cvt_pk_bf16_f32 v6, v6, v7
    v_dot2_f32_bf16 v182, v155, v46, 0
    v_dot2_f32_bf16 v183, v155, v47, 0
    v_cvt_pk_bf16_f32 v36, v36, v37
    v_dot2c_f32_bf16 v5, s10, v6
    v_dot2_f32_bf16 v6, v156, v48, 0
    v_dot2_f32_bf16 v7, v156, v49, 0
    v_cvt_pk_bf16_f32 v180, v180, v181
    v_dot2c_f32_bf16 v5, s10, v36
    v_dot2_f32_bf16 v36, v157, v50, 0
    v_dot2_f32_bf16 v37, v157, v51, 0
    v_cvt_pk_bf16_f32 v182, v182, v183
    v_dot2c_f32_bf16 v5, s10, v180
    v_dot2_f32_bf16 v180, v158, v52, 0
    v_dot2_f32_bf16 v181, v158, v53, 0
    v_cvt_pk_bf16_f32 v6, v6, v7
    v_dot2c_f32_bf16 v5, s10, v182
    v_dot2_f32_bf16 v182, v159, v54, 0
    v_dot2_f32_bf16 v183, v159, v55, 0
    v_cvt_pk_bf16_f32 v36, v36, v37
    v_dot2c_f32_bf16 v5, s10, v6
    v_dot2_f32_bf16 v6, v160, v56, 0
    v_dot2_f32_bf16 v7, v160, v57, 0
    v_cvt_pk_bf16_f32 v180, v180, v181
    v_dot2c_f32_bf16 v5, s10, v36
    v_dot2_f32_bf16 v36, v161, v58, 0
    v_dot2_f32_bf16 v37, v161, v59, 0
    v_cvt_pk_bf16_f32 v182, v182, v183
    v_dot2c_f32_bf16 v5, s10, v180
    v_dot2_f32_bf16 v180, v162, v60, 0
    v_dot2_f32_bf16 v181, v162, v61, 0
    v_cvt_pk_bf16_f32 v6, v6, v7
    v_dot2c_f32_bf16 v5, s10, v182
    v_dot2_f32_bf16 v182, v163, v62, 0
    v_dot2_f32_bf16 v183, v163, v63, 0
    v_cvt_pk_bf16_f32 v36, v36, v37
    v_dot2c_f32_bf16 v5, s10, v6
    v_dot2_f32_bf16 v6, v164, v64, 0
    v_dot2_f32_bf16 v7, v164, v65, 0
    v_cvt_pk_bf16_f32 v180, v180, v181
    v_dot2c_f32_bf16 v5, s10, v36
    v_dot2_f32_bf16 v36, v165, v66, 0
    v_dot2_f32_bf16 v37, v165, v67, 0
    v_cvt_pk_bf16_f32 v182, v182, v183
    v_dot2c_f32_bf16 v5, s10, v180
    v_dot2_f32_bf16 v180, v166, v68, 0
    v_dot2_f32_bf16 v181, v166, v69, 0
    v_cvt_pk_bf16_f32 v6, v6, v7
    v_dot2c_f32_bf16 v5, s10, v182
    v_dot2_f32_bf16 v182, v167, v70, 0
    v_dot2_f32_bf16 v183, v167, v71, 0
    v_cvt_pk_bf16_f32 v36, v36, v37
    v_dot2c_f32_bf16 v5, s10, v6
    v_dot2_f32_bf16 v6, v168, v72, 0
    v_dot2_f32_bf16 v7, v168, v73, 0
    v_cvt_pk_bf16_f32 v180, v180, v181
    v_dot2c_f32_bf16 v5, s10, v36
    v_dot2_f32_bf16 v36, v169, v74, 0
    v_dot2_f32_bf16 v37, v169, v75, 0
    v_cvt_pk_bf16_f32 v182, v182, v183
    v_dot2c_f32_bf16 v5, s10, v180
    v_dot2_f32_bf16 v180, v170, v76, 0
    v_dot2_f32_bf16 v181, v170, v77, 0
    v_cvt_pk_bf16_f32 v6, v6, v7
    v_dot2c_f32_bf16 v5, s10, v182
    v_dot2_f32_bf16 v182, v171, v78, 0
    v_dot2_f32_bf16 v183, v171, v79, 0
    v_cvt_pk_bf16_f32 v36, v36, v37
    v_dot2c_f32_bf16 v5, s10, v6
    v_dot2_f32_bf16 v6, v172, v80, 0
    v_dot2_f32_bf16 v7, v172, v81, 0
    v_cvt_pk_bf16_f32 v180, v180, v181
    v_dot2c_f32_bf16 v5, s10, v36
    v_dot2_f32_bf16 v36, v173, v82, 0
    v_dot2_f32_bf16 v37, v173, v83, 0
    v_cvt_pk_bf16_f32 v182, v182, v183
    v_dot2c_f32_bf16 v5, s10, v180
    v_dot2_f32_bf16 v180, v174, v84, 0
    v_dot2_f32_bf16 v181, v174, v85, 0
    v_cvt_pk_bf16_f32 v6, v6, v7
    v_dot2c_f32_bf16 v5, s10, v182
    v_dot2_f32_bf16 v182, v175, v86, 0
    v_dot2_f32_bf16 v183, v175, v87, 0
    v_cvt_pk_bf16_f32 v36, v36, v37
    v_dot2c_f32_bf16 v5, s10, v6
    v_dot2_f32_bf16 v6, v176, v88, 0
    v_dot2_f32_bf16 v7, v176, v89, 0
    v_cvt_pk_bf16_f32 v180, v180, v181
    v_dot2c_f32_bf16 v5, s10, v36
    v_dot2_f32_bf16 v36, v177, v90, 0
    v_dot2_f32_bf16 v37, v177, v91, 0
    v_cvt_pk_bf16_f32 v182, v182, v183
    v_dot2c_f32_bf16 v5, s10, v180
    v_dot2_f32_bf16 v180, v178, v92, 0
    v_dot2_f32_bf16 v181, v178, v93, 0
    v_cvt_pk_bf16_f32 v6, v6, v7
    v_dot2c_f32_bf16 v5, s10, v182
    v_dot2_f32_bf16 v182, v179, v94, 0
    v_dot2_f32_bf16 v183, v179, v95, 0
    v_cvt_pk_bf16_f32 v36, v36, v37
    v_dot2c_f32_bf16 v5, s10, v6
    v_cvt_pk_bf16_f32 v180, v180, v181
    v_dot2c_f32_bf16 v5, s10, v36
    v_cvt_pk_bf16_f32 v182, v182, v183
    v_dot2c_f32_bf16 v5, s10, v180
    v_dot2c_f32_bf16 v5, s10, v182
    s_nop 2
    v_add_f32_dpp v5, v5, v5 quad_perm:[1,0,3,2] row_mask:0xf bank_mask:0xf
    s_nop 1
    v_add_f32_dpp v5, v5, v5 quad_perm:[2,3,0,1] row_mask:0xf bank_mask:0xf
    s_nop 1
    v_add_f32_dpp v5, v5, v5 row_half_mirror row_mask:0xf bank_mask:0xf
    v_cmp_eq_u32 vcc, 32, v2
    s_nop 1
    v_cndmask_b32 v38, v38, v5, vcc
    buffer_load_dwordx4 v[152:155], v4, s[28:31], s65 offen offset:0
    buffer_load_dwordx4 v[156:159], v4, s[28:31], s65 offen offset:128
    buffer_load_dwordx4 v[160:163], v4, s[28:31], s65 offen offset:256
    buffer_load_dwordx4 v[164:167], v4, s[28:31], s65 offen offset:384
    buffer_load_dwordx4 v[168:171], v4, s[28:31], s65 offen offset:512
    buffer_load_dwordx4 v[172:175], v4, s[28:31], s65 offen offset:640
    buffer_load_dwordx4 v[176:179], v4, s[28:31], s65 offen offset:768
    s_add_u32 s65, s65, 143360
    s_waitcnt vmcnt(14)
    v_mov_b32 v5, 0
    v_dot2_f32_bf16 v6, v96, v40, 0
    v_dot2_f32_bf16 v7, v96, v41, 0
    v_dot2_f32_bf16 v36, v97, v42, 0
    v_dot2_f32_bf16 v37, v97, v43, 0
    v_dot2_f32_bf16 v180, v98, v44, 0
    v_dot2_f32_bf16 v181, v98, v45, 0
    v_cvt_pk_bf16_f32 v6, v6, v7
    v_dot2_f32_bf16 v182, v99, v46, 0
    v_dot2_f32_bf16 v183, v99, v47, 0
    v_cvt_pk_bf16_f32 v36, v36, v37
    v_dot2c_f32_bf16 v5, s10, v6
    v_dot2_f32_bf16 v6, v100, v48, 0
    v_dot2_f32_bf16 v7, v100, v49, 0
    v_cvt_pk_bf16_f32 v180, v180, v181
    v_dot2c_f32_bf16 v5, s10, v36
    v_dot2_f32_bf16 v36, v101, v50, 0
    v_dot2_f32_bf16 v37, v101, v51, 0
    v_cvt_pk_bf16_f32 v182, v182, v183
    v_dot2c_f32_bf16 v5, s10, v180
    v_dot2_f32_bf16 v180, v102, v52, 0
    v_dot2_f32_bf16 v181, v102, v53, 0
    v_cvt_pk_bf16_f32 v6, v6, v7
    v_dot2c_f32_bf16 v5, s10, v182
    v_dot2_f32_bf16 v182, v103, v54, 0
    v_dot2_f32_bf16 v183, v103, v55, 0
    v_cvt_pk_bf16_f32 v36, v36, v37
    v_dot2c_f32_bf16 v5, s10, v6
    v_dot2_f32_bf16 v6, v104, v56, 0
    v_dot2_f32_bf16 v7, v104, v57, 0
    v_cvt_pk_bf16_f32 v180, v180, v181
    v_dot2c_f32_bf16 v5, s10, v36
    v_dot2_f32_bf16 v36, v105, v58, 0
    v_dot2_f32_bf16 v37, v105, v59, 0
    v_cvt_pk_bf16_f32 v182, v182, v183
    v_dot2c_f32_bf16 v5, s10, v180
    v_dot2_f32_bf16 v180, v106, v60, 0
    v_dot2_f32_bf16 v181, v106, v61, 0
    v_cvt_pk_bf16_f32 v6, v6, v7
    v_dot2c_f32_bf16 v5, s10, v182
    v_dot2_f32_bf16 v182, v107, v62, 0
    v_dot2_f32_bf16 v183, v107, v63, 0
    v_cvt_pk_bf16_f32 v36, v36, v37
    v_dot2c_f32_bf16 v5, s10, v6
    v_dot2_f32_bf16 v6, v108, v64, 0
    v_dot2_f32_bf16 v7, v108, v65, 0
    v_cvt_pk_bf16_f32 v180, v180, v181
    v_dot2c_f32_bf16 v5, s10, v36
    v_dot2_f32_bf16 v36, v109, v66, 0
    v_dot2_f32_bf16 v37, v109, v67, 0
    v_cvt_pk_bf16_f32 v182, v182, v183
    v_dot2c_f32_bf16 v5, s10, v180
    v_dot2_f32_bf16 v180, v110, v68, 0
    v_dot2_f32_bf16 v181, v110, v69, 0
    v_cvt_pk_bf16_f32 v6, v6, v7
    v_dot2c_f32_bf16 v5, s10, v182
    v_dot2_f32_bf16 v182, v111, v70, 0
    v_dot2_f32_bf16 v183, v111, v71, 0
    v_cvt_pk_bf16_f32 v36, v36, v37
    v_dot2c_f32_bf16 v5, s10, v6
    v_dot2_f32_bf16 v6, v112, v72, 0
    v_dot2_f32_bf16 v7, v112, v73, 0
    v_cvt_pk_bf16_f32 v180, v180, v181
    v_dot2c_f32_bf16 v5, s10, v36
    v_dot2_f32_bf16 v36, v113, v74, 0
    v_dot2_f32_bf16 v37, v113, v75, 0
    v_cvt_pk_bf16_f32 v182, v182, v183
    v_dot2c_f32_bf16 v5, s10, v180
    v_dot2_f32_bf16 v180, v114, v76, 0
    v_dot2_f32_bf16 v181, v114, v77, 0
    v_cvt_pk_bf16_f32 v6, v6, v7
    v_dot2c_f32_bf16 v5, s10, v182
    v_dot2_f32_bf16 v182, v115, v78, 0
    v_dot2_f32_bf16 v183, v115, v79, 0
    v_cvt_pk_bf16_f32 v36, v36, v37
    v_dot2c_f32_bf16 v5, s10, v6
    v_dot2_f32_bf16 v6, v116, v80, 0
    v_dot2_f32_bf16 v7, v116, v81, 0
    v_cvt_pk_bf16_f32 v180, v180, v181
    v_dot2c_f32_bf16 v5, s10, v36
    v_dot2_f32_bf16 v36, v117, v82, 0
    v_dot2_f32_bf16 v37, v117, v83, 0
    v_cvt_pk_bf16_f32 v182, v182, v183
    v_dot2c_f32_bf16 v5, s10, v180
    v_dot2_f32_bf16 v180, v118, v84, 0
    v_dot2_f32_bf16 v181, v118, v85, 0
    v_cvt_pk_bf16_f32 v6, v6, v7
    v_dot2c_f32_bf16 v5, s10, v182
    v_dot2_f32_bf16 v182, v119, v86, 0
    v_dot2_f32_bf16 v183, v119, v87, 0
    v_cvt_pk_bf16_f32 v36, v36, v37
    v_dot2c_f32_bf16 v5, s10, v6
    v_dot2_f32_bf16 v6, v120, v88, 0
    v_dot2_f32_bf16 v7, v120, v89, 0
    v_cvt_pk_bf16_f32 v180, v180, v181
    v_dot2c_f32_bf16 v5, s10, v36
    v_dot2_f32_bf16 v36, v121, v90, 0
    v_dot2_f32_bf16 v37, v121, v91, 0
    v_cvt_pk_bf16_f32 v182, v182, v183
    v_dot2c_f32_bf16 v5, s10, v180
    v_dot2_f32_bf16 v180, v122, v92, 0
    v_dot2_f32_bf16 v181, v122, v93, 0
    v_cvt_pk_bf16_f32 v6, v6, v7
    v_dot2c_f32_bf16 v5, s10, v182
    v_dot2_f32_bf16 v182, v123, v94, 0
    v_dot2_f32_bf16 v183, v123, v95, 0
    v_cvt_pk_bf16_f32 v36, v36, v37
    v_dot2c_f32_bf16 v5, s10, v6
    v_cvt_pk_bf16_f32 v180, v180, v181
    v_dot2c_f32_bf16 v5, s10, v36
    v_cvt_pk_bf16_f32 v182, v182, v183
    v_dot2c_f32_bf16 v5, s10, v180
    v_dot2c_f32_bf16 v5, s10, v182
    s_nop 2
    v_add_f32_dpp v5, v5, v5 quad_perm:[1,0,3,2] row_mask:0xf bank_mask:0xf
    s_nop 1
    v_add_f32_dpp v5, v5, v5 quad_perm:[2,3,0,1] row_mask:0xf bank_mask:0xf
    s_nop 1
    v_add_f32_dpp v5, v5, v5 row_half_mirror row_mask:0xf bank_mask:0xf
    v_cmp_eq_u32 vcc, 48, v2
    s_nop 1
    v_cndmask_b32 v38, v38, v5, vcc
    s_add_u32 s65, s65, s66
    buffer_load_dwordx4 v[96:99], v4, s[28:31], s65 offen offset:0
    buffer_load_dwordx4 v[100:103], v4, s[28:31], s65 offen offset:128
    buffer_load_dwordx4 v[104:107], v4, s[28:31], s65 offen offset:256
    buffer_load_dwordx4 v[108:111], v4, s[28:31], s65 offen offset:384
    buffer_load_dwordx4 v[112:115], v4, s[28:31], s65 offen offset:512
    buffer_load_dwordx4 v[116:119], v4, s[28:31], s65 offen offset:640
    buffer_load_dwordx4 v[120:123], v4, s[28:31], s65 offen offset:768
    s_add_u32 s65, s65, 143360
    s_waitcnt vmcnt(14)
    v_mov_b32 v5, 0
    v_dot2_f32_bf16 v6, v124, v40, 0
    v_dot2_f32_bf16 v7, v124, v41, 0
    v_dot2_f32_bf16 v36, v125, v42, 0
    v_dot2_f32_bf16 v37, v125, v43, 0
    v_dot2_f32_bf16 v180, v126, v44, 0
    v_dot2_f32_bf16 v181, v126, v45, 0
    v_cvt_pk_bf16_f32 v6, v6, v7
    v_dot2_f32_bf16 v182, v127, v46, 0
    v_dot2_f32_bf16 v183, v127, v47, 0
    v_cvt_pk_bf16_f32 v36, v36, v37
    v_dot2c_f32_bf16 v5, s10, v6
    v_dot2_f32_bf16 v6, v128, v48, 0
    v_dot2_f32_bf16 v7, v128, v49, 0
    v_cvt_pk_bf16_f32 v180, v180, v181
    v_dot2c_f32_bf16 v5, s10, v36
    v_dot2_f32_bf16 v36, v129, v50, 0
    v_dot2_f32_bf16 v37, v129, v51, 0
    v_cvt_pk_bf16_f32 v182, v182, v183
    v_dot2c_f32_bf16 v5, s10, v180
    v_dot2_f32_bf16 v180, v130, v52, 0
    v_dot2_f32_bf16 v181, v130, v53, 0
    v_cvt_pk_bf16_f32 v6, v6, v7
    v_dot2c_f32_bf16 v5, s10, v182
    v_dot2_f32_bf16 v182, v131, v54, 0
    v_dot2_f32_bf16 v183, v131, v55, 0
    v_cvt_pk_bf16_f32 v36, v36, v37
    v_dot2c_f32_bf16 v5, s10, v6
    v_dot2_f32_bf16 v6, v132, v56, 0
    v_dot2_f32_bf16 v7, v132, v57, 0
    v_cvt_pk_bf16_f32 v180, v180, v181
    v_dot2c_f32_bf16 v5, s10, v36
    v_dot2_f32_bf16 v36, v133, v58, 0
    v_dot2_f32_bf16 v37, v133, v59, 0
    v_cvt_pk_bf16_f32 v182, v182, v183
    v_dot2c_f32_bf16 v5, s10, v180
    v_dot2_f32_bf16 v180, v134, v60, 0
    v_dot2_f32_bf16 v181, v134, v61, 0
    v_cvt_pk_bf16_f32 v6, v6, v7
    v_dot2c_f32_bf16 v5, s10, v182
    v_dot2_f32_bf16 v182, v135, v62, 0
    v_dot2_f32_bf16 v183, v135, v63, 0
    v_cvt_pk_bf16_f32 v36, v36, v37
    v_dot2c_f32_bf16 v5, s10, v6
    v_dot2_f32_bf16 v6, v136, v64, 0
    v_dot2_f32_bf16 v7, v136, v65, 0
    v_cvt_pk_bf16_f32 v180, v180, v181
    v_dot2c_f32_bf16 v5, s10, v36
    v_dot2_f32_bf16 v36, v137, v66, 0
    v_dot2_f32_bf16 v37, v137, v67, 0
    v_cvt_pk_bf16_f32 v182, v182, v183
    v_dot2c_f32_bf16 v5, s10, v180
    v_dot2_f32_bf16 v180, v138, v68, 0
    v_dot2_f32_bf16 v181, v138, v69, 0
    v_cvt_pk_bf16_f32 v6, v6, v7
    v_dot2c_f32_bf16 v5, s10, v182
    v_dot2_f32_bf16 v182, v139, v70, 0
    v_dot2_f32_bf16 v183, v139, v71, 0
    v_cvt_pk_bf16_f32 v36, v36, v37
    v_dot2c_f32_bf16 v5, s10, v6
    v_dot2_f32_bf16 v6, v140, v72, 0
    v_dot2_f32_bf16 v7, v140, v73, 0
    v_cvt_pk_bf16_f32 v180, v180, v181
    v_dot2c_f32_bf16 v5, s10, v36
    v_dot2_f32_bf16 v36, v141, v74, 0
    v_dot2_f32_bf16 v37, v141, v75, 0
    v_cvt_pk_bf16_f32 v182, v182, v183
    v_dot2c_f32_bf16 v5, s10, v180
    v_dot2_f32_bf16 v180, v142, v76, 0
    v_dot2_f32_bf16 v181, v142, v77, 0
    v_cvt_pk_bf16_f32 v6, v6, v7
    v_dot2c_f32_bf16 v5, s10, v182
    v_dot2_f32_bf16 v182, v143, v78, 0
    v_dot2_f32_bf16 v183, v143, v79, 0
    v_cvt_pk_bf16_f32 v36, v36, v37
    v_dot2c_f32_bf16 v5, s10, v6
    v_dot2_f32_bf16 v6, v144, v80, 0
    v_dot2_f32_bf16 v7, v144, v81, 0
    v_cvt_pk_bf16_f32 v180, v180, v181
    v_dot2c_f32_bf16 v5, s10, v36
    v_dot2_f32_bf16 v36, v145, v82, 0
    v_dot2_f32_bf16 v37, v145, v83, 0
    v_cvt_pk_bf16_f32 v182, v182, v183
    v_dot2c_f32_bf16 v5, s10, v180
    v_dot2_f32_bf16 v180, v146, v84, 0
    v_dot2_f32_bf16 v181, v146, v85, 0
    v_cvt_pk_bf16_f32 v6, v6, v7
    v_dot2c_f32_bf16 v5, s10, v182
    v_dot2_f32_bf16 v182, v147, v86, 0
    v_dot2_f32_bf16 v183, v147, v87, 0
    v_cvt_pk_bf16_f32 v36, v36, v37
    v_dot2c_f32_bf16 v5, s10, v6
    v_dot2_f32_bf16 v6, v148, v88, 0
    v_dot2_f32_bf16 v7, v148, v89, 0
    v_cvt_pk_bf16_f32 v180, v180, v181
    v_dot2c_f32_bf16 v5, s10, v36
    v_dot2_f32_bf16 v36, v149, v90, 0
    v_dot2_f32_bf16 v37, v149, v91, 0
    v_cvt_pk_bf16_f32 v182, v182, v183
    v_dot2c_f32_bf16 v5, s10, v180
    v_dot2_f32_bf16 v180, v150, v92, 0
    v_dot2_f32_bf16 v181, v150, v93, 0
    v_cvt_pk_bf16_f32 v6, v6, v7
    v_dot2c_f32_bf16 v5, s10, v182
    v_dot2_f32_bf16 v182, v151, v94, 0
    v_dot2_f32_bf16 v183, v151, v95, 0
    v_cvt_pk_bf16_f32 v36, v36, v37
    v_dot2c_f32_bf16 v5, s10, v6
    v_cvt_pk_bf16_f32 v180, v180, v181
    v_dot2c_f32_bf16 v5, s10, v36
    v_cvt_pk_bf16_f32 v182, v182, v183
    v_dot2c_f32_bf16 v5, s10, v180
    v_dot2c_f32_bf16 v5, s10, v182
    s_nop 2
    v_add_f32_dpp v5, v5, v5 quad_perm:[1,0,3,2] row_mask:0xf bank_mask:0xf
    s_nop 1
    v_add_f32_dpp v5, v5, v5 quad_perm:[2,3,0,1] row_mask:0xf bank_mask:0xf
    s_nop 1
    v_add_f32_dpp v5, v5, v5 row_half_mirror row_mask:0xf bank_mask:0xf
    v_cmp_eq_u32 vcc, 64, v2
    s_nop 1
    v_cndmask_b32 v38, v38, v5, vcc
    s_waitcnt vmcnt(7)
    v_mov_b32 v5, 0
    v_dot2_f32_bf16 v6, v152, v40, 0
    v_dot2_f32_bf16 v7, v152, v41, 0
    v_dot2_f32_bf16 v36, v153, v42, 0
    v_dot2_f32_bf16 v37, v153, v43, 0
    v_dot2_f32_bf16 v180, v154, v44, 0
    v_dot2_f32_bf16 v181, v154, v45, 0
    v_cvt_pk_bf16_f32 v6, v6, v7
    v_dot2_f32_bf16 v182, v155, v46, 0
    v_dot2_f32_bf16 v183, v155, v47, 0
    v_cvt_pk_bf16_f32 v36, v36, v37
    v_dot2c_f32_bf16 v5, s10, v6
    v_dot2_f32_bf16 v6, v156, v48, 0
    v_dot2_f32_bf16 v7, v156, v49, 0
    v_cvt_pk_bf16_f32 v180, v180, v181
    v_dot2c_f32_bf16 v5, s10, v36
    v_dot2_f32_bf16 v36, v157, v50, 0
    v_dot2_f32_bf16 v37, v157, v51, 0
    v_cvt_pk_bf16_f32 v182, v182, v183
    v_dot2c_f32_bf16 v5, s10, v180
    v_dot2_f32_bf16 v180, v158, v52, 0
    v_dot2_f32_bf16 v181, v158, v53, 0
    v_cvt_pk_bf16_f32 v6, v6, v7
    v_dot2c_f32_bf16 v5, s10, v182
    v_dot2_f32_bf16 v182, v159, v54, 0
    v_dot2_f32_bf16 v183, v159, v55, 0
    v_cvt_pk_bf16_f32 v36, v36, v37
    v_dot2c_f32_bf16 v5, s10, v6
    v_dot2_f32_bf16 v6, v160, v56, 0
    v_dot2_f32_bf16 v7, v160, v57, 0
    v_cvt_pk_bf16_f32 v180, v180, v181
    v_dot2c_f32_bf16 v5, s10, v36
    v_dot2_f32_bf16 v36, v161, v58, 0
    v_dot2_f32_bf16 v37, v161, v59, 0
    v_cvt_pk_bf16_f32 v182, v182, v183
    v_dot2c_f32_bf16 v5, s10, v180
    v_dot2_f32_bf16 v180, v162, v60, 0
    v_dot2_f32_bf16 v181, v162, v61, 0
    v_cvt_pk_bf16_f32 v6, v6, v7
    v_dot2c_f32_bf16 v5, s10, v182
    v_dot2_f32_bf16 v182, v163, v62, 0
    v_dot2_f32_bf16 v183, v163, v63, 0
    v_cvt_pk_bf16_f32 v36, v36, v37
    v_dot2c_f32_bf16 v5, s10, v6
    v_dot2_f32_bf16 v6, v164, v64, 0
    v_dot2_f32_bf16 v7, v164, v65, 0
    v_cvt_pk_bf16_f32 v180, v180, v181
    v_dot2c_f32_bf16 v5, s10, v36
    v_dot2_f32_bf16 v36, v165, v66, 0
    v_dot2_f32_bf16 v37, v165, v67, 0
    v_cvt_pk_bf16_f32 v182, v182, v183
    v_dot2c_f32_bf16 v5, s10, v180
    v_dot2_f32_bf16 v180, v166, v68, 0
    v_dot2_f32_bf16 v181, v166, v69, 0
    v_cvt_pk_bf16_f32 v6, v6, v7
    v_dot2c_f32_bf16 v5, s10, v182
    v_dot2_f32_bf16 v182, v167, v70, 0
    v_dot2_f32_bf16 v183, v167, v71, 0
    v_cvt_pk_bf16_f32 v36, v36, v37
    v_dot2c_f32_bf16 v5, s10, v6
    v_dot2_f32_bf16 v6, v168, v72, 0
    v_dot2_f32_bf16 v7, v168, v73, 0
    v_cvt_pk_bf16_f32 v180, v180, v181
    v_dot2c_f32_bf16 v5, s10, v36
    v_dot2_f32_bf16 v36, v169, v74, 0
    v_dot2_f32_bf16 v37, v169, v75, 0
    v_cvt_pk_bf16_f32 v182, v182, v183
    v_dot2c_f32_bf16 v5, s10, v180
    v_dot2_f32_bf16 v180, v170, v76, 0
    v_dot2_f32_bf16 v181, v170, v77, 0
    v_cvt_pk_bf16_f32 v6, v6, v7
    v_dot2c_f32_bf16 v5, s10, v182
    v_dot2_f32_bf16 v182, v171, v78, 0
    v_dot2_f32_bf16 v183, v171, v79, 0
    v_cvt_pk_bf16_f32 v36, v36, v37
    v_dot2c_f32_bf16 v5, s10, v6
    v_dot2_f32_bf16 v6, v172, v80, 0
    v_dot2_f32_bf16 v7, v172, v81, 0
    v_cvt_pk_bf16_f32 v180, v180, v181
    v_dot2c_f32_bf16 v5, s10, v36
    v_dot2_f32_bf16 v36, v173, v82, 0
    v_dot2_f32_bf16 v37, v173, v83, 0
    v_cvt_pk_bf16_f32 v182, v182, v183
    v_dot2c_f32_bf16 v5, s10, v180
    v_dot2_f32_bf16 v180, v174, v84, 0
    v_dot2_f32_bf16 v181, v174, v85, 0
    v_cvt_pk_bf16_f32 v6, v6, v7
    v_dot2c_f32_bf16 v5, s10, v182
    v_dot2_f32_bf16 v182, v175, v86, 0
    v_dot2_f32_bf16 v183, v175, v87, 0
    v_cvt_pk_bf16_f32 v36, v36, v37
    v_dot2c_f32_bf16 v5, s10, v6
    v_dot2_f32_bf16 v6, v176, v88, 0
    v_dot2_f32_bf16 v7, v176, v89, 0
    v_cvt_pk_bf16_f32 v180, v180, v181
    v_dot2c_f32_bf16 v5, s10, v36
    v_dot2_f32_bf16 v36, v177, v90, 0
    v_dot2_f32_bf16 v37, v177, v91, 0
    v_cvt_pk_bf16_f32 v182, v182, v183
    v_dot2c_f32_bf16 v5, s10, v180
    v_dot2_f32_bf16 v180, v178, v92, 0
    v_dot2_f32_bf16 v181, v178, v93, 0
    v_cvt_pk_bf16_f32 v6, v6, v7
    v_dot2c_f32_bf16 v5, s10, v182
    v_dot2_f32_bf16 v182, v179, v94, 0
    v_dot2_f32_bf16 v183, v179, v95, 0
    v_cvt_pk_bf16_f32 v36, v36, v37
    v_dot2c_f32_bf16 v5, s10, v6
    v_cvt_pk_bf16_f32 v180, v180, v181
    v_dot2c_f32_bf16 v5, s10, v36
    v_cvt_pk_bf16_f32 v182, v182, v183
    v_dot2c_f32_bf16 v5, s10, v180
    v_dot2c_f32_bf16 v5, s10, v182
    s_nop 2
    v_add_f32_dpp v5, v5, v5 quad_perm:[1,0,3,2] row_mask:0xf bank_mask:0xf
    s_nop 1
    v_add_f32_dpp v5, v5, v5 quad_perm:[2,3,0,1] row_mask:0xf bank_mask:0xf
    s_nop 1
    v_add_f32_dpp v5, v5, v5 row_half_mirror row_mask:0xf bank_mask:0xf
    v_cmp_eq_u32 vcc, 80, v2
    s_nop 1
    v_cndmask_b32 v38, v38, v5, vcc
    s_waitcnt vmcnt(0)
    v_mov_b32 v5, 0
    v_dot2_f32_bf16 v6, v96, v40, 0
    v_dot2_f32_bf16 v7, v96, v41, 0
    v_dot2_f32_bf16 v36, v97, v42, 0
    v_dot2_f32_bf16 v37, v97, v43, 0
    v_dot2_f32_bf16 v180, v98, v44, 0
    v_dot2_f32_bf16 v181, v98, v45, 0
    v_cvt_pk_bf16_f32 v6, v6, v7
    v_dot2_f32_bf16 v182, v99, v46, 0
    v_dot2_f32_bf16 v183, v99, v47, 0
    v_cvt_pk_bf16_f32 v36, v36, v37
    v_dot2c_f32_bf16 v5, s10, v6
    v_dot2_f32_bf16 v6, v100, v48, 0
    v_dot2_f32_bf16 v7, v100, v49, 0
    v_cvt_pk_bf16_f32 v180, v180, v181
    v_dot2c_f32_bf16 v5, s10, v36
    v_dot2_f32_bf16 v36, v101, v50, 0
    v_dot2_f32_bf16 v37, v101, v51, 0
    v_cvt_pk_bf16_f32 v182, v182, v183
    v_dot2c_f32_bf16 v5, s10, v180
    v_dot2_f32_bf16 v180, v102, v52, 0
    v_dot2_f32_bf16 v181, v102, v53, 0
    v_cvt_pk_bf16_f32 v6, v6, v7
    v_dot2c_f32_bf16 v5, s10, v182
    v_dot2_f32_bf16 v182, v103, v54, 0
    v_dot2_f32_bf16 v183, v103, v55, 0
    v_cvt_pk_bf16_f32 v36, v36, v37
    v_dot2c_f32_bf16 v5, s10, v6
    v_dot2_f32_bf16 v6, v104, v56, 0
    v_dot2_f32_bf16 v7, v104, v57, 0
    v_cvt_pk_bf16_f32 v180, v180, v181
    v_dot2c_f32_bf16 v5, s10, v36
    v_dot2_f32_bf16 v36, v105, v58, 0
    v_dot2_f32_bf16 v37, v105, v59, 0
    v_cvt_pk_bf16_f32 v182, v182, v183
    v_dot2c_f32_bf16 v5, s10, v180
    v_dot2_f32_bf16 v180, v106, v60, 0
    v_dot2_f32_bf16 v181, v106, v61, 0
    v_cvt_pk_bf16_f32 v6, v6, v7
    v_dot2c_f32_bf16 v5, s10, v182
    v_dot2_f32_bf16 v182, v107, v62, 0
    v_dot2_f32_bf16 v183, v107, v63, 0
    v_cvt_pk_bf16_f32 v36, v36, v37
    v_dot2c_f32_bf16 v5, s10, v6
    v_dot2_f32_bf16 v6, v108, v64, 0
    v_dot2_f32_bf16 v7, v108, v65, 0
    v_cvt_pk_bf16_f32 v180, v180, v181
    v_dot2c_f32_bf16 v5, s10, v36
    v_dot2_f32_bf16 v36, v109, v66, 0
    v_dot2_f32_bf16 v37, v109, v67, 0
    v_cvt_pk_bf16_f32 v182, v182, v183
    v_dot2c_f32_bf16 v5, s10, v180
    v_dot2_f32_bf16 v180, v110, v68, 0
    v_dot2_f32_bf16 v181, v110, v69, 0
    v_cvt_pk_bf16_f32 v6, v6, v7
    v_dot2c_f32_bf16 v5, s10, v182
    v_dot2_f32_bf16 v182, v111, v70, 0
    v_dot2_f32_bf16 v183, v111, v71, 0
    v_cvt_pk_bf16_f32 v36, v36, v37
    v_dot2c_f32_bf16 v5, s10, v6
    v_dot2_f32_bf16 v6, v112, v72, 0
    v_dot2_f32_bf16 v7, v112, v73, 0
    v_cvt_pk_bf16_f32 v180, v180, v181
    v_dot2c_f32_bf16 v5, s10, v36
    v_dot2_f32_bf16 v36, v113, v74, 0
    v_dot2_f32_bf16 v37, v113, v75, 0
    v_cvt_pk_bf16_f32 v182, v182, v183
    v_dot2c_f32_bf16 v5, s10, v180
    v_dot2_f32_bf16 v180, v114, v76, 0
    v_dot2_f32_bf16 v181, v114, v77, 0
    v_cvt_pk_bf16_f32 v6, v6, v7
    v_dot2c_f32_bf16 v5, s10, v182
    v_dot2_f32_bf16 v182, v115, v78, 0
    v_dot2_f32_bf16 v183, v115, v79, 0
    v_cvt_pk_bf16_f32 v36, v36, v37
    v_dot2c_f32_bf16 v5, s10, v6
    v_dot2_f32_bf16 v6, v116, v80, 0
    v_dot2_f32_bf16 v7, v116, v81, 0
    v_cvt_pk_bf16_f32 v180, v180, v181
    v_dot2c_f32_bf16 v5, s10, v36
    v_dot2_f32_bf16 v36, v117, v82, 0
    v_dot2_f32_bf16 v37, v117, v83, 0
    v_cvt_pk_bf16_f32 v182, v182, v183
    v_dot2c_f32_bf16 v5, s10, v180
    v_dot2_f32_bf16 v180, v118, v84, 0
    v_dot2_f32_bf16 v181, v118, v85, 0
    v_cvt_pk_bf16_f32 v6, v6, v7
    v_dot2c_f32_bf16 v5, s10, v182
    v_dot2_f32_bf16 v182, v119, v86, 0
    v_dot2_f32_bf16 v183, v119, v87, 0
    v_cvt_pk_bf16_f32 v36, v36, v37
    v_dot2c_f32_bf16 v5, s10, v6
    v_dot2_f32_bf16 v6, v120, v88, 0
    v_dot2_f32_bf16 v7, v120, v89, 0
    v_cvt_pk_bf16_f32 v180, v180, v181
    v_dot2c_f32_bf16 v5, s10, v36
    v_dot2_f32_bf16 v36, v121, v90, 0
    v_dot2_f32_bf16 v37, v121, v91, 0
    v_cvt_pk_bf16_f32 v182, v182, v183
    v_dot2c_f32_bf16 v5, s10, v180
    v_dot2_f32_bf16 v180, v122, v92, 0
    v_dot2_f32_bf16 v181, v122, v93, 0
    v_cvt_pk_bf16_f32 v6, v6, v7
    v_dot2c_f32_bf16 v5, s10, v182
    v_dot2_f32_bf16 v182, v123, v94, 0
    v_dot2_f32_bf16 v183, v123, v95, 0
    v_cvt_pk_bf16_f32 v36, v36, v37
    v_dot2c_f32_bf16 v5, s10, v6
    v_cvt_pk_bf16_f32 v180, v180, v181
    v_dot2c_f32_bf16 v5, s10, v36
    v_cvt_pk_bf16_f32 v182, v182, v183
    v_dot2c_f32_bf16 v5, s10, v180
    v_dot2c_f32_bf16 v5, s10, v182
    s_nop 2
    v_add_f32_dpp v5, v5, v5 quad_perm:[1,0,3,2] row_mask:0xf bank_mask:0xf
    s_nop 1
    v_add_f32_dpp v5, v5, v5 quad_perm:[2,3,0,1] row_mask:0xf bank_mask:0xf
    s_nop 1
    v_add_f32_dpp v5, v5, v5 row_half_mirror row_mask:0xf bank_mask:0xf
    v_cmp_eq_u32 vcc, 96, v2
    s_nop 1
    v_cndmask_b32 v38, v38, v5, vcc
    v_cvt_pk_bf16_f32 v38, v38, v38
    v_and_b32 v38, 0xffff0000, v38
    v_mul_f32 v38, s72, v38
    v_exp_f32 v38, v38
    s_nop 0
    v_add_f32 v38, 1.0, v38
    v_rcp_f32 v39, v38
    s_nop 0
    v_cvt_pk_bf16_f32 v39, v39, v39
    v_and_b32 v39, 0xffff0000, v39
    v_sub_f32 v6, 1.0, v39
    v_cvt_pk_bf16_f32 v6, v6, v6
    v_and_b32 v6, 0xffff0000, v6
    v_max_f32 v6, 0xda24260, v6
    v_rcp_f32 v38, v6
    s_nop 0
    v_mul_f32 v39, v39, v38
    v_mad_u32_u24 v3, v2, 40, v3
    s_cmp_eq_u32 s66, 0
    s_cselect_b32 s27, 7, 6
    s_lshl_b32 s27, s27, 4
    v_cmp_gt_u32 vcc, s27, v2
    s_add_u32 s27, s26, 8192
    s_and_saveexec_b64 s[4:5], vcc
    buffer_store_dword v6, v3, s[52:55], s26 offen sc1
    buffer_store_dword v39, v3, s[52:55], s27 offen sc1
    v_mov_b32 v5, 1
    s_waitcnt vmcnt(0)
    s_mov_b64 exec, 1
    buffer_atomic_add v5, off, s[96:99], 0 offset:128 sc1
L_end:
    s_endpgm
.section .rodata,"a"
.p2align 6
.amdhsa_kernel gated_mix__sliding_local_dilated__swiglu_ffn__prompt_kernel
  .amdhsa_next_free_vgpr 512
  .amdhsa_next_free_sgpr 102
  .amdhsa_accum_offset 256
  .amdhsa_group_segment_fixed_size 0
  .amdhsa_kernarg_size 88
  .amdhsa_user_sgpr_count 2
  .amdhsa_user_sgpr_kernarg_segment_ptr 1
  .amdhsa_system_sgpr_workgroup_id_x 1
.end_amdhsa_kernel
```
